```python
import torch

def _softmax(x, axis=-1):
    return torch.softmax(x, dim=axis)

def _gelu(x):
    return torch.nn.functional.gelu(x, approximate='tanh')

def _silu(x):
    return torch.nn.functional.silu(x)

def _sigmoid(x):
    return torch.sigmoid(x)

def _layernorm(x, axis=-1, eps=1e-05):
    m = x.mean(dim=axis, keepdim=True)
    v = x.var(dim=axis, keepdim=True, unbiased=False)
    return (x - m) / torch.sqrt(v + eps)

def _scatter_add(tgt, idx, src, axis=0):
    return tgt.clone().index_add_(axis, idx, src)

def _segment_sum(src, seg, n):
    out = torch.zeros((n,) + src.shape[1:], dtype=src.dtype)
    return out.index_add_(0, seg, src)

def _pad(x, pw):
    flat = tuple((v for pair in reversed(pw) for v in pair))
    return torch.nn.functional.pad(x, flat)
kernel_name = 'gated_mix__softmax_full_mha__mixer_gmlp__prompt'

def setup_inputs():

    _w = lambda a: (lambda t: t.to(torch.bfloat16) if t.is_floating_point() else t)(torch.as_tensor(a))

    def _A_setup():
        B, S, D = (1, 2048, 576)
        return {'x': _w((lambda *s: torch.randn(*s, dtype=torch.bfloat16) * 0.05)(B, S, D)), 'wqkv': _w((lambda *s: torch.randn(*s, dtype=torch.bfloat16) * 1.6)(D, 3 * D)), 'wo': _w((lambda *s: torch.randn(*s, dtype=torch.bfloat16) * 0.1)(D, D))}
    _A_in = _A_setup()

    def _B_setup():
        B, S, D, F = (1, 2048, 576, 4608)
        Fh = F // 2
        return {'x': _w((lambda *s: torch.randn(*s, dtype=torch.bfloat16) * 0.05)(B, S, D)), 'w_in': _w((lambda *s: torch.randn(*s, dtype=torch.bfloat16) * 1.6)(D, 2 * Fh)), 'w_sp': _w(0.01 * (lambda *s: torch.randn(*s, dtype=torch.bfloat16) * 1.6)(S, S)), 'b_sp': _w(1.0 + 0.01 * (lambda *s: torch.randn(*s, dtype=torch.bfloat16) * 0.05)(S)), 'w_out': _w((lambda *s: torch.randn(*s, dtype=torch.bfloat16) * 0.05)(Fh, D))}
    _B_in = _B_setup()
    return {'A_x': _A_in['x'], 'A_wqkv': _A_in['wqkv'], 'A_wo': _A_in['wo'], 'B_x': _B_in['x'], 'B_w_in': _B_in['w_in'], 'B_w_sp': _B_in['w_sp'], 'B_b_sp': _B_in['b_sp'], 'B_w_out': _B_in['w_out'], 'gate_w': _w((lambda *s: torch.randn(*s, dtype=torch.bfloat16) * 0.05)(576) * 16.0)}

def reference(A_x, A_wqkv, A_wo, B_x, B_w_in, B_w_sp, B_b_sp, B_w_out, gate_w):

    def _A_ref(x, wqkv, wo):
        B, S, D = x.shape
        H = 32
        Dh = D // H
        qkv = (lambda x, *d: x.permute(*d))((x @ wqkv).reshape(B, S, 3, H, Dh), 2, 0, 3, 1, 4)
        q, k, v = (qkv[0], qkv[1], qkv[2])
        scale = Dh ** (-0.5)
        scores = torch.einsum('bhqd,bhkd->bhqk', q, k) * scale
        p = _softmax(scores, axis=-1)
        o = torch.einsum('bhqk,bhkd->bhqd', p, v)
        return (lambda x, *d: x.permute(*d))(o, 0, 2, 1, 3).reshape(B, S, D) @ wo

    def _B_ref(x, w_in, w_sp, b_sp, w_out):
        B, S, D = x.shape
        F = w_in.shape[-1]
        Fh = F // 2
        z = _gelu(torch.einsum('bsd,df->bsf', x, w_in))
        z1 = z[..., :Fh].clone()
        z2 = _layernorm(z[..., Fh:], axis=-1)
        g = torch.einsum('ts,bsf->btf', w_sp, z2) + b_sp[None, :, None]
        return torch.einsum('bsf,fd->bsd', z1 * g, w_out)
    x = A_x
    g = _sigmoid((x * gate_w).sum(-1, keepdims=True))
    a = _A_ref(x, A_wqkv, A_wo)
    b = _B_ref(x, B_w_in, B_w_sp, B_b_sp, B_w_out)
    return g * a + (1 - g) * b
```

```asm
; @launch kernel=fused_kernel grid=(512,1,1) block=(256,1,1) lds=81920
.amdgcn_target "amdgcn-amd-amdhsa--gfx950"
.text
.globl fused_kernel
.p2align 8
.type fused_kernel,@function
fused_kernel:
    s_cmp_ge_u32 s2, 512
    s_cbranch_scc1 Ldone_1
    s_load_dwordx2 s[32:33], s[0:1], 80
    v_lshrrev_b32 v1, 6, v0
    s_nop 0
    v_readfirstlane_b32 s24, v1
    s_nop 1
    s_cmp_ge_u32 s2, 256
    s_cbranch_scc1 LA_2
    s_cmp_ge_u32 s2, 192
    s_cbranch_scc1 Lv_3
    s_mov_b32 s31, s2
    s_load_dwordx2 s[80:81], s[0:1], 0
    s_load_dwordx2 s[82:83], s[0:1], 32
    s_load_dwordx2 s[84:85], s[0:1], 88
    s_and_b32 s4, s31, 3
    s_lshr_b32 s5, s31, 3
    s_and_b32 s38, s5, 3
    s_lshl_b32 s6, s38, 2
    s_add_u32 s40, s4, s6
    s_bfe_u32 s6, s31, 0x10002
    s_mul_i32 s6, s6, 6
    s_lshr_b32 s39, s5, 2
    s_add_u32 s41, s6, s39
    s_add_u32 s41, s41, 12
    s_waitcnt lgkmcnt(0)
    s_mov_b32 s8, s80
    s_mov_b32 s9, s81
    s_and_b32 s9, s9, 0xffff
    s_mov_b32 s10, 2359296
    s_mov_b32 s11, 0x20000
    s_mov_b32 s12, s82
    s_mov_b32 s13, s83
    s_and_b32 s13, s13, 0xffff
    s_mov_b32 s14, 5308416
    s_mov_b32 s15, 0x20000
    s_add_u32 s16, s84, 51380224
    s_addc_u32 s17, s85, 0
    s_and_b32 s17, s17, 0xffff
    s_mov_b32 s18, 18874368
    s_mov_b32 s19, 0x20000
    v_and_b32 v2, 63, v0
    v_lshrrev_b32 v3, 3, v2
    s_lshl_b32 s4, s24, 5
    v_add_u32 v3, s4, v3
    s_mov_b32 s5, 1152
    v_mul_lo_u32 v3, v3, s5
    v_lshrrev_b32 v4, 4, v2
    v_and_b32 v5, 7, v2
    v_xor_b32 v6, v5, v4
    v_lshlrev_b32 v6, 4, v6
    v_add_u32 v232, v3, v6
    v_xor_b32 v6, 64, v6
    v_add_u32 v233, v3, v6
    v_add_u32 v234, 16384, v232
    v_add_u32 v233, 8192, v233
    v_add_u32 v235, 16384, v233
    v_and_b32 v3, 15, v2
    v_lshrrev_b32 v5, 1, v3
    v_xor_b32 v5, v5, v4
    v_lshlrev_b32 v5, 4, v5
    v_lshlrev_b32 v3, 7, v3
    v_add_u32 v3, v3, v5
    s_lshl_b32 s4, s24, 13
    s_add_u32 s27, s4, 49152
    v_add_u32 v239, s27, v3
    v_xor_b32 v240, 64, v239
    v_and_b32 v2, 63, v0
    s_mul_i32 s28, s24, 3072
    s_lshl_b32 s4, s24, 3
    s_mov_b32 s5, 9216
    v_add_u32 v3, 0, v2
    v_mul_u32_u24 v4, 2731, v3
    v_lshrrev_b32 v4, 16, v4
    v_mul_u32_u24 v5, 24, v4
    v_sub_u32 v5, v3, v5
    v_add_u32 v4, s4, v4
    v_bfe_u32 v3, v4, 1, 1
    v_bfe_u32 v6, v4, 3, 1
    v_lshl_or_b32 v3, v6, 1, v3
    v_lshlrev_b32 v3, 1, v3
    v_xor_b32 v5, v5, v3
    v_mul_lo_u32 v4, v4, s5
    v_lshl_add_u32 v4, v5, 4, v4
    v_mov_b32 v236, v4
    v_add_u32 v3, 64, v2
    v_mul_u32_u24 v4, 2731, v3
    v_lshrrev_b32 v4, 16, v4
    v_mul_u32_u24 v5, 24, v4
    v_sub_u32 v5, v3, v5
    v_add_u32 v4, s4, v4
    v_bfe_u32 v3, v4, 1, 1
    v_bfe_u32 v6, v4, 3, 1
    v_lshl_or_b32 v3, v6, 1, v3
    v_lshlrev_b32 v3, 1, v3
    v_xor_b32 v5, v5, v3
    v_mul_lo_u32 v4, v4, s5
    v_lshl_add_u32 v4, v5, 4, v4
    v_subrev_u32 v237, 1024, v4
    v_add_u32 v3, 128, v2
    v_mul_u32_u24 v4, 2731, v3
    v_lshrrev_b32 v4, 16, v4
    v_mul_u32_u24 v5, 24, v4
    v_sub_u32 v5, v3, v5
    v_add_u32 v4, s4, v4
    v_bfe_u32 v3, v4, 1, 1
    v_bfe_u32 v6, v4, 3, 1
    v_lshl_or_b32 v3, v6, 1, v3
    v_lshlrev_b32 v3, 1, v3
    v_xor_b32 v5, v5, v3
    v_mul_lo_u32 v4, v4, s5
    v_lshl_add_u32 v4, v5, 4, v4
    v_subrev_u32 v238, 2048, v4
    v_lshrrev_b32 v3, 4, v2
    v_bfe_u32 v4, v2, 2, 2
    v_lshl_add_u32 v5, v3, 3, v4
    v_mul_u32_u24 v5, 384, v5
    v_and_b32 v6, 3, v2
    v_lshl_add_u32 v5, v6, 3, v5
    v_lshrrev_b32 v4, 1, v4
    v_and_b32 v3, 1, v3
    v_lshl_or_b32 v4, v3, 1, v4
    v_xor_b32 v3, 0, v4
    v_lshl_add_u32 v241, v3, 5, v5
    v_xor_b32 v3, 1, v4
    v_lshl_add_u32 v242, v3, 5, v5
    v_xor_b32 v3, 2, v4
    v_lshl_add_u32 v243, v3, 5, v5
    v_xor_b32 v3, 3, v4
    v_lshl_add_u32 v244, v3, 5, v5
    s_mul_i32 s25, s40, 147456
    s_mul_i32 s26, s41, 384
    s_add_u32 m0, s28, 0
    s_nop 0
    buffer_load_dwordx4 v236, s[12:15], s26 offen lds
    buffer_load_dwordx4 v237, s[12:15], s26 offen offset:1024 lds
    buffer_load_dwordx4 v238, s[12:15], s26 offen offset:2048 lds
    s_add_u32 s26, s26, 294912
    s_add_u32 m0, s27, 0
    s_nop 0
    buffer_load_dwordx4 v232, s[8:11], s25 offen lds
    buffer_load_dwordx4 v233, s[8:11], s25 offen offset:1024 lds
    buffer_load_dwordx4 v234, s[8:11], s25 offen offset:2048 lds
    buffer_load_dwordx4 v235, s[8:11], s25 offen offset:3072 lds
    s_add_u32 s25, s25, 128
    s_add_u32 m0, s28, 12288
    s_nop 0
    buffer_load_dwordx4 v236, s[12:15], s26 offen lds
    buffer_load_dwordx4 v237, s[12:15], s26 offen offset:1024 lds
    buffer_load_dwordx4 v238, s[12:15], s26 offen offset:2048 lds
    s_add_u32 s26, s26, 294912
    s_add_u32 m0, s28, 24576
    s_nop 0
    buffer_load_dwordx4 v236, s[12:15], s26 offen lds
    buffer_load_dwordx4 v237, s[12:15], s26 offen offset:1024 lds
    buffer_load_dwordx4 v238, s[12:15], s26 offen offset:2048 lds
    s_add_u32 s26, s26, 294912
    s_add_u32 m0, s27, 4096
    s_nop 0
    buffer_load_dwordx4 v232, s[8:11], s25 offen lds
    buffer_load_dwordx4 v233, s[8:11], s25 offen offset:1024 lds
    buffer_load_dwordx4 v234, s[8:11], s25 offen offset:2048 lds
    buffer_load_dwordx4 v235, s[8:11], s25 offen offset:3072 lds
    s_add_u32 s25, s25, 128
    s_add_u32 m0, s28, 36864
    s_nop 0
    buffer_load_dwordx4 v236, s[12:15], s26 offen lds
    buffer_load_dwordx4 v237, s[12:15], s26 offen offset:1024 lds
    buffer_load_dwordx4 v238, s[12:15], s26 offen offset:2048 lds
    s_add_u32 s26, s26, 294912
    v_mov_b32 v8, 0
    v_mov_b32 v9, 0
    v_mov_b32 v10, 0
    v_mov_b32 v11, 0
    v_mov_b32 v12, 0
    v_mov_b32 v13, 0
    v_mov_b32 v14, 0
    v_mov_b32 v15, 0
    v_mov_b32 v16, 0
    v_mov_b32 v17, 0
    v_mov_b32 v18, 0
    v_mov_b32 v19, 0
    v_mov_b32 v20, 0
    v_mov_b32 v21, 0
    v_mov_b32 v22, 0
    v_mov_b32 v23, 0
    v_mov_b32 v24, 0
    v_mov_b32 v25, 0
    v_mov_b32 v26, 0
    v_mov_b32 v27, 0
    v_mov_b32 v28, 0
    v_mov_b32 v29, 0
    v_mov_b32 v30, 0
    v_mov_b32 v31, 0
    v_mov_b32 v32, 0
    v_mov_b32 v33, 0
    v_mov_b32 v34, 0
    v_mov_b32 v35, 0
    v_mov_b32 v36, 0
    v_mov_b32 v37, 0
    v_mov_b32 v38, 0
    v_mov_b32 v39, 0
    v_mov_b32 v40, 0
    v_mov_b32 v41, 0
    v_mov_b32 v42, 0
    v_mov_b32 v43, 0
    v_mov_b32 v44, 0
    v_mov_b32 v45, 0
    v_mov_b32 v46, 0
    v_mov_b32 v47, 0
    v_mov_b32 v48, 0
    v_mov_b32 v49, 0
    v_mov_b32 v50, 0
    v_mov_b32 v51, 0
    v_mov_b32 v52, 0
    v_mov_b32 v53, 0
    v_mov_b32 v54, 0
    v_mov_b32 v55, 0
    v_mov_b32 v56, 0
    v_mov_b32 v57, 0
    v_mov_b32 v58, 0
    v_mov_b32 v59, 0
    v_mov_b32 v60, 0
    v_mov_b32 v61, 0
    v_mov_b32 v62, 0
    v_mov_b32 v63, 0
    v_mov_b32 v64, 0
    v_mov_b32 v65, 0
    v_mov_b32 v66, 0
    v_mov_b32 v67, 0
    v_mov_b32 v68, 0
    v_mov_b32 v69, 0
    v_mov_b32 v70, 0
    v_mov_b32 v71, 0
    v_mov_b32 v72, 0
    v_mov_b32 v73, 0
    v_mov_b32 v74, 0
    v_mov_b32 v75, 0
    v_mov_b32 v76, 0
    v_mov_b32 v77, 0
    v_mov_b32 v78, 0
    v_mov_b32 v79, 0
    v_mov_b32 v80, 0
    v_mov_b32 v81, 0
    v_mov_b32 v82, 0
    v_mov_b32 v83, 0
    v_mov_b32 v84, 0
    v_mov_b32 v85, 0
    v_mov_b32 v86, 0
    v_mov_b32 v87, 0
    v_mov_b32 v88, 0
    v_mov_b32 v89, 0
    v_mov_b32 v90, 0
    v_mov_b32 v91, 0
    v_mov_b32 v92, 0
    v_mov_b32 v93, 0
    v_mov_b32 v94, 0
    v_mov_b32 v95, 0
    v_mov_b32 v96, 0
    v_mov_b32 v97, 0
    v_mov_b32 v98, 0
    v_mov_b32 v99, 0
    v_mov_b32 v100, 0
    v_mov_b32 v101, 0
    v_mov_b32 v102, 0
    v_mov_b32 v103, 0
    s_waitcnt vmcnt(13)
    s_barrier
    ds_read_b128 v[200:203], v239 offset:0
    ds_read_b128 v[204:207], v239 offset:2048
    ds_read_b128 v[208:211], v240 offset:0
    ds_read_b128 v[212:215], v240 offset:2048
    ds_read_b64_tr_b16 v[104:105], v241 offset:0
    ds_read_b64_tr_b16 v[106:107], v241 offset:1536
    ds_read_b64_tr_b16 v[108:109], v242 offset:0
    ds_read_b64_tr_b16 v[110:111], v242 offset:1536
    ds_read_b64_tr_b16 v[112:113], v243 offset:0
    ds_read_b64_tr_b16 v[114:115], v243 offset:1536
    ds_read_b64_tr_b16 v[116:117], v244 offset:0
    ds_read_b64_tr_b16 v[118:119], v244 offset:1536
    ds_read_b64_tr_b16 v[120:121], v241 offset:128
    ds_read_b64_tr_b16 v[122:123], v241 offset:1664
    ds_read_b64_tr_b16 v[124:125], v242 offset:128
    ds_read_b64_tr_b16 v[126:127], v242 offset:1664
    ds_read_b64_tr_b16 v[128:129], v243 offset:128
    ds_read_b64_tr_b16 v[130:131], v243 offset:1664
    ds_read_b64_tr_b16 v[132:133], v244 offset:128
    ds_read_b64_tr_b16 v[134:135], v244 offset:1664
    ds_read_b64_tr_b16 v[136:137], v241 offset:256
    ds_read_b64_tr_b16 v[138:139], v241 offset:1792
    ds_read_b64_tr_b16 v[140:141], v242 offset:256
    ds_read_b64_tr_b16 v[142:143], v242 offset:1792
    ds_read_b64_tr_b16 v[144:145], v243 offset:256
    ds_read_b64_tr_b16 v[146:147], v243 offset:1792
    ds_read_b64_tr_b16 v[148:149], v244 offset:256
    ds_read_b64_tr_b16 v[150:151], v244 offset:1792
    s_mov_b32 s30, 3
Lk_10:
    s_waitcnt vmcnt(10) lgkmcnt(0)
    s_barrier
    v_mfma_f32_16x16x32_bf16 v[8:11], v[200:203], v[104:107], v[8:11]
    ds_read_b64_tr_b16 v[152:153], v241 offset:12288
    s_add_u32 m0, s28, 0
    v_mfma_f32_16x16x32_bf16 v[56:59], v[204:207], v[104:107], v[56:59]
    buffer_load_dwordx4 v236, s[12:15], s26 offen lds
    ds_read_b64_tr_b16 v[154:155], v241 offset:13824
    v_mfma_f32_16x16x32_bf16 v[12:15], v[200:203], v[108:111], v[12:15]
    ds_read_b64_tr_b16 v[156:157], v242 offset:12288
    ds_read_b64_tr_b16 v[158:159], v242 offset:13824
    v_mfma_f32_16x16x32_bf16 v[60:63], v[204:207], v[108:111], v[60:63]
    ds_read_b64_tr_b16 v[160:161], v243 offset:12288
    ds_read_b64_tr_b16 v[162:163], v243 offset:13824
    v_mfma_f32_16x16x32_bf16 v[16:19], v[200:203], v[112:115], v[16:19]
    buffer_load_dwordx4 v237, s[12:15], s26 offen offset:1024 lds
    ds_read_b64_tr_b16 v[164:165], v244 offset:12288
    v_mfma_f32_16x16x32_bf16 v[64:67], v[204:207], v[112:115], v[64:67]
    ds_read_b64_tr_b16 v[166:167], v244 offset:13824
    ds_read_b64_tr_b16 v[168:169], v241 offset:12416
    v_mfma_f32_16x16x32_bf16 v[20:23], v[200:203], v[116:119], v[20:23]
    ds_read_b64_tr_b16 v[170:171], v241 offset:13952
    ds_read_b64_tr_b16 v[172:173], v242 offset:12416
    v_mfma_f32_16x16x32_bf16 v[68:71], v[204:207], v[116:119], v[68:71]
    buffer_load_dwordx4 v238, s[12:15], s26 offen offset:2048 lds
    s_add_u32 s26, s26, 294912
    v_mfma_f32_16x16x32_bf16 v[24:27], v[200:203], v[120:123], v[24:27]
    ds_read_b64_tr_b16 v[174:175], v242 offset:13952
    ds_read_b64_tr_b16 v[176:177], v243 offset:12416
    v_mfma_f32_16x16x32_bf16 v[72:75], v[204:207], v[120:123], v[72:75]
    ds_read_b64_tr_b16 v[178:179], v243 offset:13952
    s_add_u32 m0, s27, 0
    v_mfma_f32_16x16x32_bf16 v[28:31], v[200:203], v[124:127], v[28:31]
    buffer_load_dwordx4 v232, s[8:11], s25 offen lds
    ds_read_b64_tr_b16 v[180:181], v244 offset:12416
    v_mfma_f32_16x16x32_bf16 v[76:79], v[204:207], v[124:127], v[76:79]
    ds_read_b64_tr_b16 v[182:183], v244 offset:13952
    ds_read_b64_tr_b16 v[184:185], v241 offset:12544
    v_mfma_f32_16x16x32_bf16 v[32:35], v[200:203], v[128:131], v[32:35]
    ds_read_b64_tr_b16 v[186:187], v241 offset:14080
    ds_read_b64_tr_b16 v[188:189], v242 offset:12544
    v_mfma_f32_16x16x32_bf16 v[80:83], v[204:207], v[128:131], v[80:83]
    ds_read_b64_tr_b16 v[190:191], v242 offset:14080
    ds_read_b64_tr_b16 v[192:193], v243 offset:12544
    v_mfma_f32_16x16x32_bf16 v[36:39], v[200:203], v[132:135], v[36:39]
    buffer_load_dwordx4 v233, s[8:11], s25 offen offset:1024 lds
    ds_read_b64_tr_b16 v[194:195], v243 offset:14080
    v_mfma_f32_16x16x32_bf16 v[84:87], v[204:207], v[132:135], v[84:87]
    ds_read_b64_tr_b16 v[196:197], v244 offset:12544
    ds_read_b64_tr_b16 v[198:199], v244 offset:14080
    v_mfma_f32_16x16x32_bf16 v[40:43], v[200:203], v[136:139], v[40:43]
    v_mfma_f32_16x16x32_bf16 v[88:91], v[204:207], v[136:139], v[88:91]
    buffer_load_dwordx4 v234, s[8:11], s25 offen offset:2048 lds
    v_mfma_f32_16x16x32_bf16 v[44:47], v[200:203], v[140:143], v[44:47]
    v_mfma_f32_16x16x32_bf16 v[92:95], v[204:207], v[140:143], v[92:95]
    v_mfma_f32_16x16x32_bf16 v[48:51], v[200:203], v[144:147], v[48:51]
    buffer_load_dwordx4 v235, s[8:11], s25 offen offset:3072 lds
    s_add_u32 s25, s25, 128
    v_mfma_f32_16x16x32_bf16 v[96:99], v[204:207], v[144:147], v[96:99]
    v_mfma_f32_16x16x32_bf16 v[52:55], v[200:203], v[148:151], v[52:55]
    v_mfma_f32_16x16x32_bf16 v[100:103], v[204:207], v[148:151], v[100:103]
    s_waitcnt vmcnt(10) lgkmcnt(0)
    s_barrier
    v_mfma_f32_16x16x32_bf16 v[8:11], v[208:211], v[152:155], v[8:11]
    ds_read_b128 v[216:219], v239 offset:4096
    s_add_u32 m0, s28, 12288
    v_mfma_f32_16x16x32_bf16 v[56:59], v[212:215], v[152:155], v[56:59]
    buffer_load_dwordx4 v236, s[12:15], s26 offen lds
    ds_read_b128 v[220:223], v239 offset:6144
    v_mfma_f32_16x16x32_bf16 v[12:15], v[208:211], v[156:159], v[12:15]
    ds_read_b128 v[224:227], v240 offset:4096
    ds_read_b128 v[228:231], v240 offset:6144
    v_mfma_f32_16x16x32_bf16 v[60:63], v[212:215], v[156:159], v[60:63]
    ds_read_b64_tr_b16 v[104:105], v241 offset:24576
    ds_read_b64_tr_b16 v[106:107], v241 offset:26112
    v_mfma_f32_16x16x32_bf16 v[16:19], v[208:211], v[160:163], v[16:19]
    ds_read_b64_tr_b16 v[108:109], v242 offset:24576
    ds_read_b64_tr_b16 v[110:111], v242 offset:26112
    v_mfma_f32_16x16x32_bf16 v[64:67], v[212:215], v[160:163], v[64:67]
    ds_read_b64_tr_b16 v[112:113], v243 offset:24576
    ds_read_b64_tr_b16 v[114:115], v243 offset:26112
    v_mfma_f32_16x16x32_bf16 v[20:23], v[208:211], v[164:167], v[20:23]
    ds_read_b64_tr_b16 v[116:117], v244 offset:24576
    ds_read_b64_tr_b16 v[118:119], v244 offset:26112
    v_mfma_f32_16x16x32_bf16 v[68:71], v[212:215], v[164:167], v[68:71]
    ds_read_b64_tr_b16 v[120:121], v241 offset:24704
    ds_read_b64_tr_b16 v[122:123], v241 offset:26240
    v_mfma_f32_16x16x32_bf16 v[24:27], v[208:211], v[168:171], v[24:27]
    buffer_load_dwordx4 v237, s[12:15], s26 offen offset:1024 lds
    ds_read_b64_tr_b16 v[124:125], v242 offset:24704
    v_mfma_f32_16x16x32_bf16 v[72:75], v[212:215], v[168:171], v[72:75]
    ds_read_b64_tr_b16 v[126:127], v242 offset:26240
    ds_read_b64_tr_b16 v[128:129], v243 offset:24704
    v_mfma_f32_16x16x32_bf16 v[28:31], v[208:211], v[172:175], v[28:31]
    ds_read_b64_tr_b16 v[130:131], v243 offset:26240
    ds_read_b64_tr_b16 v[132:133], v244 offset:24704
    v_mfma_f32_16x16x32_bf16 v[76:79], v[212:215], v[172:175], v[76:79]
    ds_read_b64_tr_b16 v[134:135], v244 offset:26240
    ds_read_b64_tr_b16 v[136:137], v241 offset:24832
    v_mfma_f32_16x16x32_bf16 v[32:35], v[208:211], v[176:179], v[32:35]
    ds_read_b64_tr_b16 v[138:139], v241 offset:26368
    ds_read_b64_tr_b16 v[140:141], v242 offset:24832
    v_mfma_f32_16x16x32_bf16 v[80:83], v[212:215], v[176:179], v[80:83]
    ds_read_b64_tr_b16 v[142:143], v242 offset:26368
    ds_read_b64_tr_b16 v[144:145], v243 offset:24832
    v_mfma_f32_16x16x32_bf16 v[36:39], v[208:211], v[180:183], v[36:39]
    ds_read_b64_tr_b16 v[146:147], v243 offset:26368
    ds_read_b64_tr_b16 v[148:149], v244 offset:24832
    v_mfma_f32_16x16x32_bf16 v[84:87], v[212:215], v[180:183], v[84:87]
    ds_read_b64_tr_b16 v[150:151], v244 offset:26368
    v_mfma_f32_16x16x32_bf16 v[40:43], v[208:211], v[184:187], v[40:43]
    buffer_load_dwordx4 v238, s[12:15], s26 offen offset:2048 lds
    s_add_u32 s26, s26, 294912
    v_mfma_f32_16x16x32_bf16 v[88:91], v[212:215], v[184:187], v[88:91]
    v_mfma_f32_16x16x32_bf16 v[44:47], v[208:211], v[188:191], v[44:47]
    v_mfma_f32_16x16x32_bf16 v[92:95], v[212:215], v[188:191], v[92:95]
    v_mfma_f32_16x16x32_bf16 v[48:51], v[208:211], v[192:195], v[48:51]
    v_mfma_f32_16x16x32_bf16 v[96:99], v[212:215], v[192:195], v[96:99]
    v_mfma_f32_16x16x32_bf16 v[52:55], v[208:211], v[196:199], v[52:55]
    v_mfma_f32_16x16x32_bf16 v[100:103], v[212:215], v[196:199], v[100:103]
    s_waitcnt vmcnt(10) lgkmcnt(0)
    s_barrier
    v_mfma_f32_16x16x32_bf16 v[8:11], v[216:219], v[104:107], v[8:11]
    ds_read_b64_tr_b16 v[152:153], v241 offset:36864
    s_add_u32 m0, s28, 24576
    v_mfma_f32_16x16x32_bf16 v[56:59], v[220:223], v[104:107], v[56:59]
    buffer_load_dwordx4 v236, s[12:15], s26 offen lds
    ds_read_b64_tr_b16 v[154:155], v241 offset:38400
    v_mfma_f32_16x16x32_bf16 v[12:15], v[216:219], v[108:111], v[12:15]
    ds_read_b64_tr_b16 v[156:157], v242 offset:36864
    ds_read_b64_tr_b16 v[158:159], v242 offset:38400
    v_mfma_f32_16x16x32_bf16 v[60:63], v[220:223], v[108:111], v[60:63]
    ds_read_b64_tr_b16 v[160:161], v243 offset:36864
    ds_read_b64_tr_b16 v[162:163], v243 offset:38400
    v_mfma_f32_16x16x32_bf16 v[16:19], v[216:219], v[112:115], v[16:19]
    buffer_load_dwordx4 v237, s[12:15], s26 offen offset:1024 lds
    ds_read_b64_tr_b16 v[164:165], v244 offset:36864
    v_mfma_f32_16x16x32_bf16 v[64:67], v[220:223], v[112:115], v[64:67]
    ds_read_b64_tr_b16 v[166:167], v244 offset:38400
    ds_read_b64_tr_b16 v[168:169], v241 offset:36992
    v_mfma_f32_16x16x32_bf16 v[20:23], v[216:219], v[116:119], v[20:23]
    ds_read_b64_tr_b16 v[170:171], v241 offset:38528
    ds_read_b64_tr_b16 v[172:173], v242 offset:36992
    v_mfma_f32_16x16x32_bf16 v[68:71], v[220:223], v[116:119], v[68:71]
    buffer_load_dwordx4 v238, s[12:15], s26 offen offset:2048 lds
    s_add_u32 s26, s26, 294912
    v_mfma_f32_16x16x32_bf16 v[24:27], v[216:219], v[120:123], v[24:27]
    ds_read_b64_tr_b16 v[174:175], v242 offset:38528
    ds_read_b64_tr_b16 v[176:177], v243 offset:36992
    v_mfma_f32_16x16x32_bf16 v[72:75], v[220:223], v[120:123], v[72:75]
    ds_read_b64_tr_b16 v[178:179], v243 offset:38528
    s_add_u32 m0, s27, 4096
    v_mfma_f32_16x16x32_bf16 v[28:31], v[216:219], v[124:127], v[28:31]
    buffer_load_dwordx4 v232, s[8:11], s25 offen lds
    ds_read_b64_tr_b16 v[180:181], v244 offset:36992
    v_mfma_f32_16x16x32_bf16 v[76:79], v[220:223], v[124:127], v[76:79]
    ds_read_b64_tr_b16 v[182:183], v244 offset:38528
    ds_read_b64_tr_b16 v[184:185], v241 offset:37120
    v_mfma_f32_16x16x32_bf16 v[32:35], v[216:219], v[128:131], v[32:35]
    ds_read_b64_tr_b16 v[186:187], v241 offset:38656
    ds_read_b64_tr_b16 v[188:189], v242 offset:37120
    v_mfma_f32_16x16x32_bf16 v[80:83], v[220:223], v[128:131], v[80:83]
    ds_read_b64_tr_b16 v[190:191], v242 offset:38656
    ds_read_b64_tr_b16 v[192:193], v243 offset:37120
    v_mfma_f32_16x16x32_bf16 v[36:39], v[216:219], v[132:135], v[36:39]
    buffer_load_dwordx4 v233, s[8:11], s25 offen offset:1024 lds
    ds_read_b64_tr_b16 v[194:195], v243 offset:38656
    v_mfma_f32_16x16x32_bf16 v[84:87], v[220:223], v[132:135], v[84:87]
    ds_read_b64_tr_b16 v[196:197], v244 offset:37120
    ds_read_b64_tr_b16 v[198:199], v244 offset:38656
    v_mfma_f32_16x16x32_bf16 v[40:43], v[216:219], v[136:139], v[40:43]
    v_mfma_f32_16x16x32_bf16 v[88:91], v[220:223], v[136:139], v[88:91]
    buffer_load_dwordx4 v234, s[8:11], s25 offen offset:2048 lds
    v_mfma_f32_16x16x32_bf16 v[44:47], v[216:219], v[140:143], v[44:47]
    v_mfma_f32_16x16x32_bf16 v[92:95], v[220:223], v[140:143], v[92:95]
    v_mfma_f32_16x16x32_bf16 v[48:51], v[216:219], v[144:147], v[48:51]
    buffer_load_dwordx4 v235, s[8:11], s25 offen offset:3072 lds
    s_add_u32 s25, s25, 128
    v_mfma_f32_16x16x32_bf16 v[96:99], v[220:223], v[144:147], v[96:99]
    v_mfma_f32_16x16x32_bf16 v[52:55], v[216:219], v[148:151], v[52:55]
    v_mfma_f32_16x16x32_bf16 v[100:103], v[220:223], v[148:151], v[100:103]
    s_waitcnt vmcnt(10) lgkmcnt(0)
    s_barrier
    v_mfma_f32_16x16x32_bf16 v[8:11], v[224:227], v[152:155], v[8:11]
    ds_read_b128 v[200:203], v239 offset:0
    s_add_u32 m0, s28, 36864
    v_mfma_f32_16x16x32_bf16 v[56:59], v[228:231], v[152:155], v[56:59]
    buffer_load_dwordx4 v236, s[12:15], s26 offen lds
    ds_read_b128 v[204:207], v239 offset:2048
    v_mfma_f32_16x16x32_bf16 v[12:15], v[224:227], v[156:159], v[12:15]
    ds_read_b128 v[208:211], v240 offset:0
    ds_read_b128 v[212:215], v240 offset:2048
    v_mfma_f32_16x16x32_bf16 v[60:63], v[228:231], v[156:159], v[60:63]
    ds_read_b64_tr_b16 v[104:105], v241 offset:0
    ds_read_b64_tr_b16 v[106:107], v241 offset:1536
    v_mfma_f32_16x16x32_bf16 v[16:19], v[224:227], v[160:163], v[16:19]
    ds_read_b64_tr_b16 v[108:109], v242 offset:0
    ds_read_b64_tr_b16 v[110:111], v242 offset:1536
    v_mfma_f32_16x16x32_bf16 v[64:67], v[228:231], v[160:163], v[64:67]
    ds_read_b64_tr_b16 v[112:113], v243 offset:0
    ds_read_b64_tr_b16 v[114:115], v243 offset:1536
    v_mfma_f32_16x16x32_bf16 v[20:23], v[224:227], v[164:167], v[20:23]
    ds_read_b64_tr_b16 v[116:117], v244 offset:0
    ds_read_b64_tr_b16 v[118:119], v244 offset:1536
    v_mfma_f32_16x16x32_bf16 v[68:71], v[228:231], v[164:167], v[68:71]
    ds_read_b64_tr_b16 v[120:121], v241 offset:128
    ds_read_b64_tr_b16 v[122:123], v241 offset:1664
    v_mfma_f32_16x16x32_bf16 v[24:27], v[224:227], v[168:171], v[24:27]
    buffer_load_dwordx4 v237, s[12:15], s26 offen offset:1024 lds
    ds_read_b64_tr_b16 v[124:125], v242 offset:128
    v_mfma_f32_16x16x32_bf16 v[72:75], v[228:231], v[168:171], v[72:75]
    ds_read_b64_tr_b16 v[126:127], v242 offset:1664
    ds_read_b64_tr_b16 v[128:129], v243 offset:128
    v_mfma_f32_16x16x32_bf16 v[28:31], v[224:227], v[172:175], v[28:31]
    ds_read_b64_tr_b16 v[130:131], v243 offset:1664
    ds_read_b64_tr_b16 v[132:133], v244 offset:128
    v_mfma_f32_16x16x32_bf16 v[76:79], v[228:231], v[172:175], v[76:79]
    ds_read_b64_tr_b16 v[134:135], v244 offset:1664
    ds_read_b64_tr_b16 v[136:137], v241 offset:256
    v_mfma_f32_16x16x32_bf16 v[32:35], v[224:227], v[176:179], v[32:35]
    ds_read_b64_tr_b16 v[138:139], v241 offset:1792
    ds_read_b64_tr_b16 v[140:141], v242 offset:256
    v_mfma_f32_16x16x32_bf16 v[80:83], v[228:231], v[176:179], v[80:83]
    ds_read_b64_tr_b16 v[142:143], v242 offset:1792
    ds_read_b64_tr_b16 v[144:145], v243 offset:256
    v_mfma_f32_16x16x32_bf16 v[36:39], v[224:227], v[180:183], v[36:39]
    ds_read_b64_tr_b16 v[146:147], v243 offset:1792
    ds_read_b64_tr_b16 v[148:149], v244 offset:256
    v_mfma_f32_16x16x32_bf16 v[84:87], v[228:231], v[180:183], v[84:87]
    ds_read_b64_tr_b16 v[150:151], v244 offset:1792
    v_mfma_f32_16x16x32_bf16 v[40:43], v[224:227], v[184:187], v[40:43]
    buffer_load_dwordx4 v238, s[12:15], s26 offen offset:2048 lds
    s_add_u32 s26, s26, 294912
    v_mfma_f32_16x16x32_bf16 v[88:91], v[228:231], v[184:187], v[88:91]
    v_mfma_f32_16x16x32_bf16 v[44:47], v[224:227], v[188:191], v[44:47]
    v_mfma_f32_16x16x32_bf16 v[92:95], v[228:231], v[188:191], v[92:95]
    v_mfma_f32_16x16x32_bf16 v[48:51], v[224:227], v[192:195], v[48:51]
    v_mfma_f32_16x16x32_bf16 v[96:99], v[228:231], v[192:195], v[96:99]
    v_mfma_f32_16x16x32_bf16 v[52:55], v[224:227], v[196:199], v[52:55]
    v_mfma_f32_16x16x32_bf16 v[100:103], v[228:231], v[196:199], v[100:103]
    s_sub_u32 s30, s30, 1
    s_cmp_lg_u32 s30, 0
    s_cbranch_scc1 Lk_10
    s_waitcnt vmcnt(10) lgkmcnt(0)
    s_barrier
    v_mfma_f32_16x16x32_bf16 v[8:11], v[200:203], v[104:107], v[8:11]
    ds_read_b64_tr_b16 v[152:153], v241 offset:12288
    s_add_u32 m0, s28, 0
    v_mfma_f32_16x16x32_bf16 v[56:59], v[204:207], v[104:107], v[56:59]
    buffer_load_dwordx4 v236, s[12:15], s26 offen lds
    ds_read_b64_tr_b16 v[154:155], v241 offset:13824
    v_mfma_f32_16x16x32_bf16 v[12:15], v[200:203], v[108:111], v[12:15]
    ds_read_b64_tr_b16 v[156:157], v242 offset:12288
    ds_read_b64_tr_b16 v[158:159], v242 offset:13824
    v_mfma_f32_16x16x32_bf16 v[60:63], v[204:207], v[108:111], v[60:63]
    ds_read_b64_tr_b16 v[160:161], v243 offset:12288
    ds_read_b64_tr_b16 v[162:163], v243 offset:13824
    v_mfma_f32_16x16x32_bf16 v[16:19], v[200:203], v[112:115], v[16:19]
    buffer_load_dwordx4 v237, s[12:15], s26 offen offset:1024 lds
    ds_read_b64_tr_b16 v[164:165], v244 offset:12288
    v_mfma_f32_16x16x32_bf16 v[64:67], v[204:207], v[112:115], v[64:67]
    ds_read_b64_tr_b16 v[166:167], v244 offset:13824
    ds_read_b64_tr_b16 v[168:169], v241 offset:12416
    v_mfma_f32_16x16x32_bf16 v[20:23], v[200:203], v[116:119], v[20:23]
    ds_read_b64_tr_b16 v[170:171], v241 offset:13952
    ds_read_b64_tr_b16 v[172:173], v242 offset:12416
    v_mfma_f32_16x16x32_bf16 v[68:71], v[204:207], v[116:119], v[68:71]
    buffer_load_dwordx4 v238, s[12:15], s26 offen offset:2048 lds
    s_add_u32 s26, s26, 294912
    v_mfma_f32_16x16x32_bf16 v[24:27], v[200:203], v[120:123], v[24:27]
    ds_read_b64_tr_b16 v[174:175], v242 offset:13952
    ds_read_b64_tr_b16 v[176:177], v243 offset:12416
    v_mfma_f32_16x16x32_bf16 v[72:75], v[204:207], v[120:123], v[72:75]
    ds_read_b64_tr_b16 v[178:179], v243 offset:13952
    s_add_u32 m0, s27, 0
    v_mfma_f32_16x16x32_bf16 v[28:31], v[200:203], v[124:127], v[28:31]
    buffer_load_dwordx4 v232, s[8:11], s25 offen lds
    ds_read_b64_tr_b16 v[180:181], v244 offset:12416
    v_mfma_f32_16x16x32_bf16 v[76:79], v[204:207], v[124:127], v[76:79]
    ds_read_b64_tr_b16 v[182:183], v244 offset:13952
    ds_read_b64_tr_b16 v[184:185], v241 offset:12544
    v_mfma_f32_16x16x32_bf16 v[32:35], v[200:203], v[128:131], v[32:35]
    ds_read_b64_tr_b16 v[186:187], v241 offset:14080
    ds_read_b64_tr_b16 v[188:189], v242 offset:12544
    v_mfma_f32_16x16x32_bf16 v[80:83], v[204:207], v[128:131], v[80:83]
    ds_read_b64_tr_b16 v[190:191], v242 offset:14080
    ds_read_b64_tr_b16 v[192:193], v243 offset:12544
    v_mfma_f32_16x16x32_bf16 v[36:39], v[200:203], v[132:135], v[36:39]
    buffer_load_dwordx4 v233, s[8:11], s25 offen offset:1024 lds
    ds_read_b64_tr_b16 v[194:195], v243 offset:14080
    v_mfma_f32_16x16x32_bf16 v[84:87], v[204:207], v[132:135], v[84:87]
    ds_read_b64_tr_b16 v[196:197], v244 offset:12544
    ds_read_b64_tr_b16 v[198:199], v244 offset:14080
    v_mfma_f32_16x16x32_bf16 v[40:43], v[200:203], v[136:139], v[40:43]
    v_mfma_f32_16x16x32_bf16 v[88:91], v[204:207], v[136:139], v[88:91]
    buffer_load_dwordx4 v234, s[8:11], s25 offen offset:2048 lds
    v_mfma_f32_16x16x32_bf16 v[44:47], v[200:203], v[140:143], v[44:47]
    v_mfma_f32_16x16x32_bf16 v[92:95], v[204:207], v[140:143], v[92:95]
    v_mfma_f32_16x16x32_bf16 v[48:51], v[200:203], v[144:147], v[48:51]
    buffer_load_dwordx4 v235, s[8:11], s25 offen offset:3072 lds
    s_add_u32 s25, s25, 128
    v_mfma_f32_16x16x32_bf16 v[96:99], v[204:207], v[144:147], v[96:99]
    v_mfma_f32_16x16x32_bf16 v[52:55], v[200:203], v[148:151], v[52:55]
    v_mfma_f32_16x16x32_bf16 v[100:103], v[204:207], v[148:151], v[100:103]
    s_waitcnt vmcnt(10) lgkmcnt(0)
    s_barrier
    v_mfma_f32_16x16x32_bf16 v[8:11], v[208:211], v[152:155], v[8:11]
    ds_read_b128 v[216:219], v239 offset:4096
    s_add_u32 m0, s28, 12288
    v_mfma_f32_16x16x32_bf16 v[56:59], v[212:215], v[152:155], v[56:59]
    buffer_load_dwordx4 v236, s[12:15], s26 offen lds
    ds_read_b128 v[220:223], v239 offset:6144
    v_mfma_f32_16x16x32_bf16 v[12:15], v[208:211], v[156:159], v[12:15]
    ds_read_b128 v[224:227], v240 offset:4096
    ds_read_b128 v[228:231], v240 offset:6144
    v_mfma_f32_16x16x32_bf16 v[60:63], v[212:215], v[156:159], v[60:63]
    ds_read_b64_tr_b16 v[104:105], v241 offset:24576
    ds_read_b64_tr_b16 v[106:107], v241 offset:26112
    v_mfma_f32_16x16x32_bf16 v[16:19], v[208:211], v[160:163], v[16:19]
    ds_read_b64_tr_b16 v[108:109], v242 offset:24576
    ds_read_b64_tr_b16 v[110:111], v242 offset:26112
    v_mfma_f32_16x16x32_bf16 v[64:67], v[212:215], v[160:163], v[64:67]
    ds_read_b64_tr_b16 v[112:113], v243 offset:24576
    ds_read_b64_tr_b16 v[114:115], v243 offset:26112
    v_mfma_f32_16x16x32_bf16 v[20:23], v[208:211], v[164:167], v[20:23]
    ds_read_b64_tr_b16 v[116:117], v244 offset:24576
    ds_read_b64_tr_b16 v[118:119], v244 offset:26112
    v_mfma_f32_16x16x32_bf16 v[68:71], v[212:215], v[164:167], v[68:71]
    ds_read_b64_tr_b16 v[120:121], v241 offset:24704
    ds_read_b64_tr_b16 v[122:123], v241 offset:26240
    v_mfma_f32_16x16x32_bf16 v[24:27], v[208:211], v[168:171], v[24:27]
    buffer_load_dwordx4 v237, s[12:15], s26 offen offset:1024 lds
    ds_read_b64_tr_b16 v[124:125], v242 offset:24704
    v_mfma_f32_16x16x32_bf16 v[72:75], v[212:215], v[168:171], v[72:75]
    ds_read_b64_tr_b16 v[126:127], v242 offset:26240
    ds_read_b64_tr_b16 v[128:129], v243 offset:24704
    v_mfma_f32_16x16x32_bf16 v[28:31], v[208:211], v[172:175], v[28:31]
    ds_read_b64_tr_b16 v[130:131], v243 offset:26240
    ds_read_b64_tr_b16 v[132:133], v244 offset:24704
    v_mfma_f32_16x16x32_bf16 v[76:79], v[212:215], v[172:175], v[76:79]
    ds_read_b64_tr_b16 v[134:135], v244 offset:26240
    ds_read_b64_tr_b16 v[136:137], v241 offset:24832
    v_mfma_f32_16x16x32_bf16 v[32:35], v[208:211], v[176:179], v[32:35]
    ds_read_b64_tr_b16 v[138:139], v241 offset:26368
    ds_read_b64_tr_b16 v[140:141], v242 offset:24832
    v_mfma_f32_16x16x32_bf16 v[80:83], v[212:215], v[176:179], v[80:83]
    ds_read_b64_tr_b16 v[142:143], v242 offset:26368
    ds_read_b64_tr_b16 v[144:145], v243 offset:24832
    v_mfma_f32_16x16x32_bf16 v[36:39], v[208:211], v[180:183], v[36:39]
    ds_read_b64_tr_b16 v[146:147], v243 offset:26368
    ds_read_b64_tr_b16 v[148:149], v244 offset:24832
    v_mfma_f32_16x16x32_bf16 v[84:87], v[212:215], v[180:183], v[84:87]
    ds_read_b64_tr_b16 v[150:151], v244 offset:26368
    v_mfma_f32_16x16x32_bf16 v[40:43], v[208:211], v[184:187], v[40:43]
    buffer_load_dwordx4 v238, s[12:15], s26 offen offset:2048 lds
    s_add_u32 s26, s26, 294912
    v_mfma_f32_16x16x32_bf16 v[88:91], v[212:215], v[184:187], v[88:91]
    v_mfma_f32_16x16x32_bf16 v[44:47], v[208:211], v[188:191], v[44:47]
    v_mfma_f32_16x16x32_bf16 v[92:95], v[212:215], v[188:191], v[92:95]
    v_mfma_f32_16x16x32_bf16 v[48:51], v[208:211], v[192:195], v[48:51]
    v_mfma_f32_16x16x32_bf16 v[96:99], v[212:215], v[192:195], v[96:99]
    v_mfma_f32_16x16x32_bf16 v[52:55], v[208:211], v[196:199], v[52:55]
    v_mfma_f32_16x16x32_bf16 v[100:103], v[212:215], v[196:199], v[100:103]
    s_waitcnt vmcnt(10) lgkmcnt(0)
    s_barrier
    v_mfma_f32_16x16x32_bf16 v[8:11], v[216:219], v[104:107], v[8:11]
    ds_read_b64_tr_b16 v[152:153], v241 offset:36864
    ds_read_b64_tr_b16 v[154:155], v241 offset:38400
    v_mfma_f32_16x16x32_bf16 v[56:59], v[220:223], v[104:107], v[56:59]
    ds_read_b64_tr_b16 v[156:157], v242 offset:36864
    ds_read_b64_tr_b16 v[158:159], v242 offset:38400
    v_mfma_f32_16x16x32_bf16 v[12:15], v[216:219], v[108:111], v[12:15]
    ds_read_b64_tr_b16 v[160:161], v243 offset:36864
    ds_read_b64_tr_b16 v[162:163], v243 offset:38400
    v_mfma_f32_16x16x32_bf16 v[60:63], v[220:223], v[108:111], v[60:63]
    ds_read_b64_tr_b16 v[164:165], v244 offset:36864
    ds_read_b64_tr_b16 v[166:167], v244 offset:38400
    v_mfma_f32_16x16x32_bf16 v[16:19], v[216:219], v[112:115], v[16:19]
    ds_read_b64_tr_b16 v[168:169], v241 offset:36992
    ds_read_b64_tr_b16 v[170:171], v241 offset:38528
    v_mfma_f32_16x16x32_bf16 v[64:67], v[220:223], v[112:115], v[64:67]
    ds_read_b64_tr_b16 v[172:173], v242 offset:36992
    ds_read_b64_tr_b16 v[174:175], v242 offset:38528
    v_mfma_f32_16x16x32_bf16 v[20:23], v[216:219], v[116:119], v[20:23]
    ds_read_b64_tr_b16 v[176:177], v243 offset:36992
    ds_read_b64_tr_b16 v[178:179], v243 offset:38528
    v_mfma_f32_16x16x32_bf16 v[68:71], v[220:223], v[116:119], v[68:71]
    ds_read_b64_tr_b16 v[180:181], v244 offset:36992
    ds_read_b64_tr_b16 v[182:183], v244 offset:38528
    v_mfma_f32_16x16x32_bf16 v[24:27], v[216:219], v[120:123], v[24:27]
    ds_read_b64_tr_b16 v[184:185], v241 offset:37120
    ds_read_b64_tr_b16 v[186:187], v241 offset:38656
    v_mfma_f32_16x16x32_bf16 v[72:75], v[220:223], v[120:123], v[72:75]
    ds_read_b64_tr_b16 v[188:189], v242 offset:37120
    ds_read_b64_tr_b16 v[190:191], v242 offset:38656
    v_mfma_f32_16x16x32_bf16 v[28:31], v[216:219], v[124:127], v[28:31]
    ds_read_b64_tr_b16 v[192:193], v243 offset:37120
    ds_read_b64_tr_b16 v[194:195], v243 offset:38656
    v_mfma_f32_16x16x32_bf16 v[76:79], v[220:223], v[124:127], v[76:79]
    ds_read_b64_tr_b16 v[196:197], v244 offset:37120
    ds_read_b64_tr_b16 v[198:199], v244 offset:38656
    v_mfma_f32_16x16x32_bf16 v[32:35], v[216:219], v[128:131], v[32:35]
    v_mfma_f32_16x16x32_bf16 v[80:83], v[220:223], v[128:131], v[80:83]
    v_mfma_f32_16x16x32_bf16 v[36:39], v[216:219], v[132:135], v[36:39]
    v_mfma_f32_16x16x32_bf16 v[84:87], v[220:223], v[132:135], v[84:87]
    v_mfma_f32_16x16x32_bf16 v[40:43], v[216:219], v[136:139], v[40:43]
    v_mfma_f32_16x16x32_bf16 v[88:91], v[220:223], v[136:139], v[88:91]
    v_mfma_f32_16x16x32_bf16 v[44:47], v[216:219], v[140:143], v[44:47]
    v_mfma_f32_16x16x32_bf16 v[92:95], v[220:223], v[140:143], v[92:95]
    v_mfma_f32_16x16x32_bf16 v[48:51], v[216:219], v[144:147], v[48:51]
    v_mfma_f32_16x16x32_bf16 v[96:99], v[220:223], v[144:147], v[96:99]
    v_mfma_f32_16x16x32_bf16 v[52:55], v[216:219], v[148:151], v[52:55]
    v_mfma_f32_16x16x32_bf16 v[100:103], v[220:223], v[148:151], v[100:103]
    s_waitcnt vmcnt(3) lgkmcnt(0)
    s_barrier
    v_mfma_f32_16x16x32_bf16 v[8:11], v[224:227], v[152:155], v[8:11]
    ds_read_b128 v[200:203], v239 offset:0
    ds_read_b128 v[204:207], v239 offset:2048
    v_mfma_f32_16x16x32_bf16 v[56:59], v[228:231], v[152:155], v[56:59]
    ds_read_b128 v[208:211], v240 offset:0
    ds_read_b128 v[212:215], v240 offset:2048
    v_mfma_f32_16x16x32_bf16 v[12:15], v[224:227], v[156:159], v[12:15]
    ds_read_b64_tr_b16 v[104:105], v241 offset:0
    ds_read_b64_tr_b16 v[106:107], v241 offset:1536
    v_mfma_f32_16x16x32_bf16 v[60:63], v[228:231], v[156:159], v[60:63]
    ds_read_b64_tr_b16 v[108:109], v242 offset:0
    ds_read_b64_tr_b16 v[110:111], v242 offset:1536
    v_mfma_f32_16x16x32_bf16 v[16:19], v[224:227], v[160:163], v[16:19]
    ds_read_b64_tr_b16 v[112:113], v243 offset:0
    ds_read_b64_tr_b16 v[114:115], v243 offset:1536
    v_mfma_f32_16x16x32_bf16 v[64:67], v[228:231], v[160:163], v[64:67]
    ds_read_b64_tr_b16 v[116:117], v244 offset:0
    ds_read_b64_tr_b16 v[118:119], v244 offset:1536
    v_mfma_f32_16x16x32_bf16 v[20:23], v[224:227], v[164:167], v[20:23]
    ds_read_b64_tr_b16 v[120:121], v241 offset:128
    ds_read_b64_tr_b16 v[122:123], v241 offset:1664
    v_mfma_f32_16x16x32_bf16 v[68:71], v[228:231], v[164:167], v[68:71]
    ds_read_b64_tr_b16 v[124:125], v242 offset:128
    ds_read_b64_tr_b16 v[126:127], v242 offset:1664
    v_mfma_f32_16x16x32_bf16 v[24:27], v[224:227], v[168:171], v[24:27]
    ds_read_b64_tr_b16 v[128:129], v243 offset:128
    ds_read_b64_tr_b16 v[130:131], v243 offset:1664
    v_mfma_f32_16x16x32_bf16 v[72:75], v[228:231], v[168:171], v[72:75]
    ds_read_b64_tr_b16 v[132:133], v244 offset:128
    ds_read_b64_tr_b16 v[134:135], v244 offset:1664
    v_mfma_f32_16x16x32_bf16 v[28:31], v[224:227], v[172:175], v[28:31]
    ds_read_b64_tr_b16 v[136:137], v241 offset:256
    ds_read_b64_tr_b16 v[138:139], v241 offset:1792
    v_mfma_f32_16x16x32_bf16 v[76:79], v[228:231], v[172:175], v[76:79]
    ds_read_b64_tr_b16 v[140:141], v242 offset:256
    ds_read_b64_tr_b16 v[142:143], v242 offset:1792
    v_mfma_f32_16x16x32_bf16 v[32:35], v[224:227], v[176:179], v[32:35]
    ds_read_b64_tr_b16 v[144:145], v243 offset:256
    ds_read_b64_tr_b16 v[146:147], v243 offset:1792
    v_mfma_f32_16x16x32_bf16 v[80:83], v[228:231], v[176:179], v[80:83]
    ds_read_b64_tr_b16 v[148:149], v244 offset:256
    ds_read_b64_tr_b16 v[150:151], v244 offset:1792
    v_mfma_f32_16x16x32_bf16 v[36:39], v[224:227], v[180:183], v[36:39]
    v_mfma_f32_16x16x32_bf16 v[84:87], v[228:231], v[180:183], v[84:87]
    v_mfma_f32_16x16x32_bf16 v[40:43], v[224:227], v[184:187], v[40:43]
    v_mfma_f32_16x16x32_bf16 v[88:91], v[228:231], v[184:187], v[88:91]
    v_mfma_f32_16x16x32_bf16 v[44:47], v[224:227], v[188:191], v[44:47]
    v_mfma_f32_16x16x32_bf16 v[92:95], v[228:231], v[188:191], v[92:95]
    v_mfma_f32_16x16x32_bf16 v[48:51], v[224:227], v[192:195], v[48:51]
    v_mfma_f32_16x16x32_bf16 v[96:99], v[228:231], v[192:195], v[96:99]
    v_mfma_f32_16x16x32_bf16 v[52:55], v[224:227], v[196:199], v[52:55]
    v_mfma_f32_16x16x32_bf16 v[100:103], v[228:231], v[196:199], v[100:103]
    s_waitcnt vmcnt(0) lgkmcnt(0)
    s_barrier
    v_mfma_f32_16x16x32_bf16 v[8:11], v[200:203], v[104:107], v[8:11]
    ds_read_b64_tr_b16 v[152:153], v241 offset:12288
    ds_read_b64_tr_b16 v[154:155], v241 offset:13824
    v_mfma_f32_16x16x32_bf16 v[56:59], v[204:207], v[104:107], v[56:59]
    ds_read_b64_tr_b16 v[156:157], v242 offset:12288
    ds_read_b64_tr_b16 v[158:159], v242 offset:13824
    v_mfma_f32_16x16x32_bf16 v[12:15], v[200:203], v[108:111], v[12:15]
    ds_read_b64_tr_b16 v[160:161], v243 offset:12288
    ds_read_b64_tr_b16 v[162:163], v243 offset:13824
    v_mfma_f32_16x16x32_bf16 v[60:63], v[204:207], v[108:111], v[60:63]
    ds_read_b64_tr_b16 v[164:165], v244 offset:12288
    ds_read_b64_tr_b16 v[166:167], v244 offset:13824
    v_mfma_f32_16x16x32_bf16 v[16:19], v[200:203], v[112:115], v[16:19]
    ds_read_b64_tr_b16 v[168:169], v241 offset:12416
    ds_read_b64_tr_b16 v[170:171], v241 offset:13952
    v_mfma_f32_16x16x32_bf16 v[64:67], v[204:207], v[112:115], v[64:67]
    ds_read_b64_tr_b16 v[172:173], v242 offset:12416
    ds_read_b64_tr_b16 v[174:175], v242 offset:13952
    v_mfma_f32_16x16x32_bf16 v[20:23], v[200:203], v[116:119], v[20:23]
    ds_read_b64_tr_b16 v[176:177], v243 offset:12416
    ds_read_b64_tr_b16 v[178:179], v243 offset:13952
    v_mfma_f32_16x16x32_bf16 v[68:71], v[204:207], v[116:119], v[68:71]
    ds_read_b64_tr_b16 v[180:181], v244 offset:12416
    ds_read_b64_tr_b16 v[182:183], v244 offset:13952
    v_mfma_f32_16x16x32_bf16 v[24:27], v[200:203], v[120:123], v[24:27]
    ds_read_b64_tr_b16 v[184:185], v241 offset:12544
    ds_read_b64_tr_b16 v[186:187], v241 offset:14080
    v_mfma_f32_16x16x32_bf16 v[72:75], v[204:207], v[120:123], v[72:75]
    ds_read_b64_tr_b16 v[188:189], v242 offset:12544
    ds_read_b64_tr_b16 v[190:191], v242 offset:14080
    v_mfma_f32_16x16x32_bf16 v[28:31], v[200:203], v[124:127], v[28:31]
    ds_read_b64_tr_b16 v[192:193], v243 offset:12544
    ds_read_b64_tr_b16 v[194:195], v243 offset:14080
    v_mfma_f32_16x16x32_bf16 v[76:79], v[204:207], v[124:127], v[76:79]
    ds_read_b64_tr_b16 v[196:197], v244 offset:12544
    ds_read_b64_tr_b16 v[198:199], v244 offset:14080
    v_mfma_f32_16x16x32_bf16 v[32:35], v[200:203], v[128:131], v[32:35]
    v_mfma_f32_16x16x32_bf16 v[80:83], v[204:207], v[128:131], v[80:83]
    v_mfma_f32_16x16x32_bf16 v[36:39], v[200:203], v[132:135], v[36:39]
    v_mfma_f32_16x16x32_bf16 v[84:87], v[204:207], v[132:135], v[84:87]
    v_mfma_f32_16x16x32_bf16 v[40:43], v[200:203], v[136:139], v[40:43]
    v_mfma_f32_16x16x32_bf16 v[88:91], v[204:207], v[136:139], v[88:91]
    v_mfma_f32_16x16x32_bf16 v[44:47], v[200:203], v[140:143], v[44:47]
    v_mfma_f32_16x16x32_bf16 v[92:95], v[204:207], v[140:143], v[92:95]
    v_mfma_f32_16x16x32_bf16 v[48:51], v[200:203], v[144:147], v[48:51]
    v_mfma_f32_16x16x32_bf16 v[96:99], v[204:207], v[144:147], v[96:99]
    v_mfma_f32_16x16x32_bf16 v[52:55], v[200:203], v[148:151], v[52:55]
    v_mfma_f32_16x16x32_bf16 v[100:103], v[204:207], v[148:151], v[100:103]
    s_waitcnt vmcnt(0) lgkmcnt(0)
    s_barrier
    v_mfma_f32_16x16x32_bf16 v[8:11], v[208:211], v[152:155], v[8:11]
    v_mfma_f32_16x16x32_bf16 v[56:59], v[212:215], v[152:155], v[56:59]
    v_mfma_f32_16x16x32_bf16 v[12:15], v[208:211], v[156:159], v[12:15]
    v_mfma_f32_16x16x32_bf16 v[60:63], v[212:215], v[156:159], v[60:63]
    v_mfma_f32_16x16x32_bf16 v[16:19], v[208:211], v[160:163], v[16:19]
    v_mfma_f32_16x16x32_bf16 v[64:67], v[212:215], v[160:163], v[64:67]
    v_mfma_f32_16x16x32_bf16 v[20:23], v[208:211], v[164:167], v[20:23]
    v_mfma_f32_16x16x32_bf16 v[68:71], v[212:215], v[164:167], v[68:71]
    v_mfma_f32_16x16x32_bf16 v[24:27], v[208:211], v[168:171], v[24:27]
    v_mfma_f32_16x16x32_bf16 v[72:75], v[212:215], v[168:171], v[72:75]
    v_mfma_f32_16x16x32_bf16 v[28:31], v[208:211], v[172:175], v[28:31]
    v_mfma_f32_16x16x32_bf16 v[76:79], v[212:215], v[172:175], v[76:79]
    v_mfma_f32_16x16x32_bf16 v[32:35], v[208:211], v[176:179], v[32:35]
    v_mfma_f32_16x16x32_bf16 v[80:83], v[212:215], v[176:179], v[80:83]
    v_mfma_f32_16x16x32_bf16 v[36:39], v[208:211], v[180:183], v[36:39]
    v_mfma_f32_16x16x32_bf16 v[84:87], v[212:215], v[180:183], v[84:87]
    v_mfma_f32_16x16x32_bf16 v[40:43], v[208:211], v[184:187], v[40:43]
    v_mfma_f32_16x16x32_bf16 v[88:91], v[212:215], v[184:187], v[88:91]
    v_mfma_f32_16x16x32_bf16 v[44:47], v[208:211], v[188:191], v[44:47]
    v_mfma_f32_16x16x32_bf16 v[92:95], v[212:215], v[188:191], v[92:95]
    v_mfma_f32_16x16x32_bf16 v[48:51], v[208:211], v[192:195], v[48:51]
    v_mfma_f32_16x16x32_bf16 v[96:99], v[212:215], v[192:195], v[96:99]
    v_mfma_f32_16x16x32_bf16 v[52:55], v[208:211], v[196:199], v[52:55]
    v_mfma_f32_16x16x32_bf16 v[100:103], v[212:215], v[196:199], v[100:103]
    s_setprio 2
    v_and_b32 v2, 63, v0
    v_bfe_u32 v3, v2, 4, 1
    v_lshrrev_b32 v4, 5, v2
    v_lshl_add_u32 v3, v3, 1, v4
    s_lshl_b32 s4, s24, 2
    v_add_u32 v3, s4, v3
    s_mov_b32 s5, 36864
    v_mul_lo_u32 v3, v3, s5
    v_and_b32 v4, 15, v2
    v_lshl_add_u32 v104, v4, 4, v3
    v_mov_b32 v106, 0xbdd2d3e8
    v_mul_f32 v110, v8, v8
    v_mul_f32 v111, v9, v9
    v_mul_f32 v112, v10, v10
    v_mul_f32 v113, v11, v11
    v_mul_f32 v114, v12, v12
    v_mul_f32 v115, v13, v13
    v_mul_f32 v116, v14, v14
    v_mul_f32 v117, v15, v15
    v_fmaak_f32 v110, v106, v110, 0xc0135761
    v_fmaak_f32 v111, v106, v111, 0xc0135761
    v_fmaak_f32 v112, v106, v112, 0xc0135761
    v_fmaak_f32 v113, v106, v113, 0xc0135761
    v_fmaak_f32 v114, v106, v114, 0xc0135761
    v_fmaak_f32 v115, v106, v115, 0xc0135761
    v_fmaak_f32 v116, v106, v116, 0xc0135761
    v_fmaak_f32 v117, v106, v117, 0xc0135761
    v_mul_f32 v110, v8, v110
    v_mul_f32 v111, v9, v111
    v_mul_f32 v112, v10, v112
    v_mul_f32 v113, v11, v113
    v_mul_f32 v114, v12, v114
    v_mul_f32 v115, v13, v115
    v_mul_f32 v116, v14, v116
    v_mul_f32 v117, v15, v117
    v_exp_f32 v110, v110
    v_exp_f32 v111, v111
    v_exp_f32 v112, v112
    v_exp_f32 v113, v113
    v_exp_f32 v114, v114
    v_exp_f32 v115, v115
    v_exp_f32 v116, v116
    v_exp_f32 v117, v117
    v_add_f32 v110, 1.0, v110
    v_add_f32 v111, 1.0, v111
    v_add_f32 v112, 1.0, v112
    v_add_f32 v113, 1.0, v113
    v_add_f32 v114, 1.0, v114
    v_add_f32 v115, 1.0, v115
    v_add_f32 v116, 1.0, v116
    v_add_f32 v117, 1.0, v117
    v_rcp_f32 v110, v110
    v_rcp_f32 v111, v111
    v_rcp_f32 v112, v112
    v_rcp_f32 v113, v113
    v_rcp_f32 v114, v114
    v_rcp_f32 v115, v115
    v_rcp_f32 v116, v116
    v_rcp_f32 v117, v117
    v_mul_f32 v8, v8, v110
    v_mul_f32 v9, v9, v111
    v_mul_f32 v10, v10, v112
    v_mul_f32 v11, v11, v113
    v_mul_f32 v12, v12, v114
    v_mul_f32 v13, v13, v115
    v_mul_f32 v14, v14, v116
    v_mul_f32 v15, v15, v117
    v_mul_f32 v110, v16, v16
    v_mul_f32 v111, v17, v17
    v_mul_f32 v112, v18, v18
    v_mul_f32 v113, v19, v19
    v_mul_f32 v114, v20, v20
    v_mul_f32 v115, v21, v21
    v_mul_f32 v116, v22, v22
    v_mul_f32 v117, v23, v23
    v_fmaak_f32 v110, v106, v110, 0xc0135761
    v_fmaak_f32 v111, v106, v111, 0xc0135761
    v_fmaak_f32 v112, v106, v112, 0xc0135761
    v_fmaak_f32 v113, v106, v113, 0xc0135761
    v_fmaak_f32 v114, v106, v114, 0xc0135761
    v_fmaak_f32 v115, v106, v115, 0xc0135761
    v_fmaak_f32 v116, v106, v116, 0xc0135761
    v_fmaak_f32 v117, v106, v117, 0xc0135761
    v_mul_f32 v110, v16, v110
    v_mul_f32 v111, v17, v111
    v_mul_f32 v112, v18, v112
    v_mul_f32 v113, v19, v113
    v_mul_f32 v114, v20, v114
    v_mul_f32 v115, v21, v115
    v_mul_f32 v116, v22, v116
    v_mul_f32 v117, v23, v117
    v_exp_f32 v110, v110
    v_exp_f32 v111, v111
    v_exp_f32 v112, v112
    v_exp_f32 v113, v113
    v_exp_f32 v114, v114
    v_exp_f32 v115, v115
    v_exp_f32 v116, v116
    v_exp_f32 v117, v117
    v_add_f32 v110, 1.0, v110
    v_add_f32 v111, 1.0, v111
    v_add_f32 v112, 1.0, v112
    v_add_f32 v113, 1.0, v113
    v_add_f32 v114, 1.0, v114
    v_add_f32 v115, 1.0, v115
    v_add_f32 v116, 1.0, v116
    v_add_f32 v117, 1.0, v117
    v_rcp_f32 v110, v110
    v_rcp_f32 v111, v111
    v_rcp_f32 v112, v112
    v_rcp_f32 v113, v113
    v_rcp_f32 v114, v114
    v_rcp_f32 v115, v115
    v_rcp_f32 v116, v116
    v_rcp_f32 v117, v117
    v_mul_f32 v16, v16, v110
    v_mul_f32 v17, v17, v111
    v_mul_f32 v18, v18, v112
    v_mul_f32 v19, v19, v113
    v_mul_f32 v20, v20, v114
    v_mul_f32 v21, v21, v115
    v_mul_f32 v22, v22, v116
    v_mul_f32 v23, v23, v117
    v_mul_f32 v110, v24, v24
    v_mul_f32 v111, v25, v25
    v_mul_f32 v112, v26, v26
    v_mul_f32 v113, v27, v27
    v_mul_f32 v114, v28, v28
    v_mul_f32 v115, v29, v29
    v_mul_f32 v116, v30, v30
    v_mul_f32 v117, v31, v31
    v_fmaak_f32 v110, v106, v110, 0xc0135761
    v_fmaak_f32 v111, v106, v111, 0xc0135761
    v_fmaak_f32 v112, v106, v112, 0xc0135761
    v_fmaak_f32 v113, v106, v113, 0xc0135761
    v_fmaak_f32 v114, v106, v114, 0xc0135761
    v_fmaak_f32 v115, v106, v115, 0xc0135761
    v_fmaak_f32 v116, v106, v116, 0xc0135761
    v_fmaak_f32 v117, v106, v117, 0xc0135761
    v_mul_f32 v110, v24, v110
    v_mul_f32 v111, v25, v111
    v_mul_f32 v112, v26, v112
    v_mul_f32 v113, v27, v113
    v_mul_f32 v114, v28, v114
    v_mul_f32 v115, v29, v115
    v_mul_f32 v116, v30, v116
    v_mul_f32 v117, v31, v117
    v_exp_f32 v110, v110
    v_exp_f32 v111, v111
    v_exp_f32 v112, v112
    v_exp_f32 v113, v113
    v_exp_f32 v114, v114
    v_exp_f32 v115, v115
    v_exp_f32 v116, v116
    v_exp_f32 v117, v117
    v_add_f32 v110, 1.0, v110
    v_add_f32 v111, 1.0, v111
    v_add_f32 v112, 1.0, v112
    v_add_f32 v113, 1.0, v113
    v_add_f32 v114, 1.0, v114
    v_add_f32 v115, 1.0, v115
    v_add_f32 v116, 1.0, v116
    v_add_f32 v117, 1.0, v117
    v_rcp_f32 v110, v110
    v_rcp_f32 v111, v111
    v_rcp_f32 v112, v112
    v_rcp_f32 v113, v113
    v_rcp_f32 v114, v114
    v_rcp_f32 v115, v115
    v_rcp_f32 v116, v116
    v_rcp_f32 v117, v117
    v_mul_f32 v24, v24, v110
    v_mul_f32 v25, v25, v111
    v_mul_f32 v26, v26, v112
    v_mul_f32 v27, v27, v113
    v_mul_f32 v28, v28, v114
    v_mul_f32 v29, v29, v115
    v_mul_f32 v30, v30, v116
    v_mul_f32 v31, v31, v117
    v_mul_f32 v110, v32, v32
    v_mul_f32 v111, v33, v33
    v_mul_f32 v112, v34, v34
    v_mul_f32 v113, v35, v35
    v_mul_f32 v114, v36, v36
    v_mul_f32 v115, v37, v37
    v_mul_f32 v116, v38, v38
    v_mul_f32 v117, v39, v39
    v_fmaak_f32 v110, v106, v110, 0xc0135761
    v_fmaak_f32 v111, v106, v111, 0xc0135761
    v_fmaak_f32 v112, v106, v112, 0xc0135761
    v_fmaak_f32 v113, v106, v113, 0xc0135761
    v_fmaak_f32 v114, v106, v114, 0xc0135761
    v_fmaak_f32 v115, v106, v115, 0xc0135761
    v_fmaak_f32 v116, v106, v116, 0xc0135761
    v_fmaak_f32 v117, v106, v117, 0xc0135761
    v_mul_f32 v110, v32, v110
    v_mul_f32 v111, v33, v111
    v_mul_f32 v112, v34, v112
    v_mul_f32 v113, v35, v113
    v_mul_f32 v114, v36, v114
    v_mul_f32 v115, v37, v115
    v_mul_f32 v116, v38, v116
    v_mul_f32 v117, v39, v117
    v_exp_f32 v110, v110
    v_exp_f32 v111, v111
    v_exp_f32 v112, v112
    v_exp_f32 v113, v113
    v_exp_f32 v114, v114
    v_exp_f32 v115, v115
    v_exp_f32 v116, v116
    v_exp_f32 v117, v117
    v_add_f32 v110, 1.0, v110
    v_add_f32 v111, 1.0, v111
    v_add_f32 v112, 1.0, v112
    v_add_f32 v113, 1.0, v113
    v_add_f32 v114, 1.0, v114
    v_add_f32 v115, 1.0, v115
    v_add_f32 v116, 1.0, v116
    v_add_f32 v117, 1.0, v117
    v_rcp_f32 v110, v110
    v_rcp_f32 v111, v111
    v_rcp_f32 v112, v112
    v_rcp_f32 v113, v113
    v_rcp_f32 v114, v114
    v_rcp_f32 v115, v115
    v_rcp_f32 v116, v116
    v_rcp_f32 v117, v117
    v_mul_f32 v32, v32, v110
    v_mul_f32 v33, v33, v111
    v_mul_f32 v34, v34, v112
    v_mul_f32 v35, v35, v113
    v_mul_f32 v36, v36, v114
    v_mul_f32 v37, v37, v115
    v_mul_f32 v38, v38, v116
    v_mul_f32 v39, v39, v117
    v_mul_f32 v110, v40, v40
    v_mul_f32 v111, v41, v41
    v_mul_f32 v112, v42, v42
    v_mul_f32 v113, v43, v43
    v_mul_f32 v114, v44, v44
    v_mul_f32 v115, v45, v45
    v_mul_f32 v116, v46, v46
    v_mul_f32 v117, v47, v47
    v_fmaak_f32 v110, v106, v110, 0xc0135761
    v_fmaak_f32 v111, v106, v111, 0xc0135761
    v_fmaak_f32 v112, v106, v112, 0xc0135761
    v_fmaak_f32 v113, v106, v113, 0xc0135761
    v_fmaak_f32 v114, v106, v114, 0xc0135761
    v_fmaak_f32 v115, v106, v115, 0xc0135761
    v_fmaak_f32 v116, v106, v116, 0xc0135761
    v_fmaak_f32 v117, v106, v117, 0xc0135761
    v_mul_f32 v110, v40, v110
    v_mul_f32 v111, v41, v111
    v_mul_f32 v112, v42, v112
    v_mul_f32 v113, v43, v113
    v_mul_f32 v114, v44, v114
    v_mul_f32 v115, v45, v115
    v_mul_f32 v116, v46, v116
    v_mul_f32 v117, v47, v117
    v_exp_f32 v110, v110
    v_exp_f32 v111, v111
    v_exp_f32 v112, v112
    v_exp_f32 v113, v113
    v_exp_f32 v114, v114
    v_exp_f32 v115, v115
    v_exp_f32 v116, v116
    v_exp_f32 v117, v117
    v_add_f32 v110, 1.0, v110
    v_add_f32 v111, 1.0, v111
    v_add_f32 v112, 1.0, v112
    v_add_f32 v113, 1.0, v113
    v_add_f32 v114, 1.0, v114
    v_add_f32 v115, 1.0, v115
    v_add_f32 v116, 1.0, v116
    v_add_f32 v117, 1.0, v117
    v_rcp_f32 v110, v110
    v_rcp_f32 v111, v111
    v_rcp_f32 v112, v112
    v_rcp_f32 v113, v113
    v_rcp_f32 v114, v114
    v_rcp_f32 v115, v115
    v_rcp_f32 v116, v116
    v_rcp_f32 v117, v117
    v_mul_f32 v40, v40, v110
    v_mul_f32 v41, v41, v111
    v_mul_f32 v42, v42, v112
    v_mul_f32 v43, v43, v113
    v_mul_f32 v44, v44, v114
    v_mul_f32 v45, v45, v115
    v_mul_f32 v46, v46, v116
    v_mul_f32 v47, v47, v117
    v_mul_f32 v110, v48, v48
    v_mul_f32 v111, v49, v49
    v_mul_f32 v112, v50, v50
    v_mul_f32 v113, v51, v51
    v_mul_f32 v114, v52, v52
    v_mul_f32 v115, v53, v53
    v_mul_f32 v116, v54, v54
    v_mul_f32 v117, v55, v55
    v_fmaak_f32 v110, v106, v110, 0xc0135761
    v_fmaak_f32 v111, v106, v111, 0xc0135761
    v_fmaak_f32 v112, v106, v112, 0xc0135761
    v_fmaak_f32 v113, v106, v113, 0xc0135761
    v_fmaak_f32 v114, v106, v114, 0xc0135761
    v_fmaak_f32 v115, v106, v115, 0xc0135761
    v_fmaak_f32 v116, v106, v116, 0xc0135761
    v_fmaak_f32 v117, v106, v117, 0xc0135761
    v_mul_f32 v110, v48, v110
    v_mul_f32 v111, v49, v111
    v_mul_f32 v112, v50, v112
    v_mul_f32 v113, v51, v113
    v_mul_f32 v114, v52, v114
    v_mul_f32 v115, v53, v115
    v_mul_f32 v116, v54, v116
    v_mul_f32 v117, v55, v117
    v_exp_f32 v110, v110
    v_exp_f32 v111, v111
    v_exp_f32 v112, v112
    v_exp_f32 v113, v113
    v_exp_f32 v114, v114
    v_exp_f32 v115, v115
    v_exp_f32 v116, v116
    v_exp_f32 v117, v117
    v_add_f32 v110, 1.0, v110
    v_add_f32 v111, 1.0, v111
    v_add_f32 v112, 1.0, v112
    v_add_f32 v113, 1.0, v113
    v_add_f32 v114, 1.0, v114
    v_add_f32 v115, 1.0, v115
    v_add_f32 v116, 1.0, v116
    v_add_f32 v117, 1.0, v117
    v_rcp_f32 v110, v110
    v_rcp_f32 v111, v111
    v_rcp_f32 v112, v112
    v_rcp_f32 v113, v113
    v_rcp_f32 v114, v114
    v_rcp_f32 v115, v115
    v_rcp_f32 v116, v116
    v_rcp_f32 v117, v117
    v_mul_f32 v48, v48, v110
    v_mul_f32 v49, v49, v111
    v_mul_f32 v50, v50, v112
    v_mul_f32 v51, v51, v113
    v_mul_f32 v52, v52, v114
    v_mul_f32 v53, v53, v115
    v_mul_f32 v54, v54, v116
    v_mul_f32 v55, v55, v117
    v_mul_f32 v110, v56, v56
    v_mul_f32 v111, v57, v57
    v_mul_f32 v112, v58, v58
    v_mul_f32 v113, v59, v59
    v_mul_f32 v114, v60, v60
    v_mul_f32 v115, v61, v61
    v_mul_f32 v116, v62, v62
    v_mul_f32 v117, v63, v63
    v_fmaak_f32 v110, v106, v110, 0xc0135761
    v_fmaak_f32 v111, v106, v111, 0xc0135761
    v_fmaak_f32 v112, v106, v112, 0xc0135761
    v_fmaak_f32 v113, v106, v113, 0xc0135761
    v_fmaak_f32 v114, v106, v114, 0xc0135761
    v_fmaak_f32 v115, v106, v115, 0xc0135761
    v_fmaak_f32 v116, v106, v116, 0xc0135761
    v_fmaak_f32 v117, v106, v117, 0xc0135761
    v_mul_f32 v110, v56, v110
    v_mul_f32 v111, v57, v111
    v_mul_f32 v112, v58, v112
    v_mul_f32 v113, v59, v113
    v_mul_f32 v114, v60, v114
    v_mul_f32 v115, v61, v115
    v_mul_f32 v116, v62, v116
    v_mul_f32 v117, v63, v117
    v_exp_f32 v110, v110
    v_exp_f32 v111, v111
    v_exp_f32 v112, v112
    v_exp_f32 v113, v113
    v_exp_f32 v114, v114
    v_exp_f32 v115, v115
    v_exp_f32 v116, v116
    v_exp_f32 v117, v117
    v_add_f32 v110, 1.0, v110
    v_add_f32 v111, 1.0, v111
    v_add_f32 v112, 1.0, v112
    v_add_f32 v113, 1.0, v113
    v_add_f32 v114, 1.0, v114
    v_add_f32 v115, 1.0, v115
    v_add_f32 v116, 1.0, v116
    v_add_f32 v117, 1.0, v117
    v_rcp_f32 v110, v110
    v_rcp_f32 v111, v111
    v_rcp_f32 v112, v112
    v_rcp_f32 v113, v113
    v_rcp_f32 v114, v114
    v_rcp_f32 v115, v115
    v_rcp_f32 v116, v116
    v_rcp_f32 v117, v117
    v_mul_f32 v56, v56, v110
    v_mul_f32 v57, v57, v111
    v_mul_f32 v58, v58, v112
    v_mul_f32 v59, v59, v113
    v_mul_f32 v60, v60, v114
    v_mul_f32 v61, v61, v115
    v_mul_f32 v62, v62, v116
    v_mul_f32 v63, v63, v117
    v_mul_f32 v110, v64, v64
    v_mul_f32 v111, v65, v65
    v_mul_f32 v112, v66, v66
    v_mul_f32 v113, v67, v67
    v_mul_f32 v114, v68, v68
    v_mul_f32 v115, v69, v69
    v_mul_f32 v116, v70, v70
    v_mul_f32 v117, v71, v71
    v_fmaak_f32 v110, v106, v110, 0xc0135761
    v_fmaak_f32 v111, v106, v111, 0xc0135761
    v_fmaak_f32 v112, v106, v112, 0xc0135761
    v_fmaak_f32 v113, v106, v113, 0xc0135761
    v_fmaak_f32 v114, v106, v114, 0xc0135761
    v_fmaak_f32 v115, v106, v115, 0xc0135761
    v_fmaak_f32 v116, v106, v116, 0xc0135761
    v_fmaak_f32 v117, v106, v117, 0xc0135761
    v_mul_f32 v110, v64, v110
    v_mul_f32 v111, v65, v111
    v_mul_f32 v112, v66, v112
    v_mul_f32 v113, v67, v113
    v_mul_f32 v114, v68, v114
    v_mul_f32 v115, v69, v115
    v_mul_f32 v116, v70, v116
    v_mul_f32 v117, v71, v117
    v_exp_f32 v110, v110
    v_exp_f32 v111, v111
    v_exp_f32 v112, v112
    v_exp_f32 v113, v113
    v_exp_f32 v114, v114
    v_exp_f32 v115, v115
    v_exp_f32 v116, v116
    v_exp_f32 v117, v117
    v_add_f32 v110, 1.0, v110
    v_add_f32 v111, 1.0, v111
    v_add_f32 v112, 1.0, v112
    v_add_f32 v113, 1.0, v113
    v_add_f32 v114, 1.0, v114
    v_add_f32 v115, 1.0, v115
    v_add_f32 v116, 1.0, v116
    v_add_f32 v117, 1.0, v117
    v_rcp_f32 v110, v110
    v_rcp_f32 v111, v111
    v_rcp_f32 v112, v112
    v_rcp_f32 v113, v113
    v_rcp_f32 v114, v114
    v_rcp_f32 v115, v115
    v_rcp_f32 v116, v116
    v_rcp_f32 v117, v117
    v_mul_f32 v64, v64, v110
    v_mul_f32 v65, v65, v111
    v_mul_f32 v66, v66, v112
    v_mul_f32 v67, v67, v113
    v_mul_f32 v68, v68, v114
    v_mul_f32 v69, v69, v115
    v_mul_f32 v70, v70, v116
    v_mul_f32 v71, v71, v117
    v_mul_f32 v110, v72, v72
    v_mul_f32 v111, v73, v73
    v_mul_f32 v112, v74, v74
    v_mul_f32 v113, v75, v75
    v_mul_f32 v114, v76, v76
    v_mul_f32 v115, v77, v77
    v_mul_f32 v116, v78, v78
    v_mul_f32 v117, v79, v79
    v_fmaak_f32 v110, v106, v110, 0xc0135761
    v_fmaak_f32 v111, v106, v111, 0xc0135761
    v_fmaak_f32 v112, v106, v112, 0xc0135761
    v_fmaak_f32 v113, v106, v113, 0xc0135761
    v_fmaak_f32 v114, v106, v114, 0xc0135761
    v_fmaak_f32 v115, v106, v115, 0xc0135761
    v_fmaak_f32 v116, v106, v116, 0xc0135761
    v_fmaak_f32 v117, v106, v117, 0xc0135761
    v_mul_f32 v110, v72, v110
    v_mul_f32 v111, v73, v111
    v_mul_f32 v112, v74, v112
    v_mul_f32 v113, v75, v113
    v_mul_f32 v114, v76, v114
    v_mul_f32 v115, v77, v115
    v_mul_f32 v116, v78, v116
    v_mul_f32 v117, v79, v117
    v_exp_f32 v110, v110
    v_exp_f32 v111, v111
    v_exp_f32 v112, v112
    v_exp_f32 v113, v113
    v_exp_f32 v114, v114
    v_exp_f32 v115, v115
    v_exp_f32 v116, v116
    v_exp_f32 v117, v117
    v_add_f32 v110, 1.0, v110
    v_add_f32 v111, 1.0, v111
    v_add_f32 v112, 1.0, v112
    v_add_f32 v113, 1.0, v113
    v_add_f32 v114, 1.0, v114
    v_add_f32 v115, 1.0, v115
    v_add_f32 v116, 1.0, v116
    v_add_f32 v117, 1.0, v117
    v_rcp_f32 v110, v110
    v_rcp_f32 v111, v111
    v_rcp_f32 v112, v112
    v_rcp_f32 v113, v113
    v_rcp_f32 v114, v114
    v_rcp_f32 v115, v115
    v_rcp_f32 v116, v116
    v_rcp_f32 v117, v117
    v_mul_f32 v72, v72, v110
    v_mul_f32 v73, v73, v111
    v_mul_f32 v74, v74, v112
    v_mul_f32 v75, v75, v113
    v_mul_f32 v76, v76, v114
    v_mul_f32 v77, v77, v115
    v_mul_f32 v78, v78, v116
    v_mul_f32 v79, v79, v117
    v_mul_f32 v110, v80, v80
    v_mul_f32 v111, v81, v81
    v_mul_f32 v112, v82, v82
    v_mul_f32 v113, v83, v83
    v_mul_f32 v114, v84, v84
    v_mul_f32 v115, v85, v85
    v_mul_f32 v116, v86, v86
    v_mul_f32 v117, v87, v87
    v_fmaak_f32 v110, v106, v110, 0xc0135761
    v_fmaak_f32 v111, v106, v111, 0xc0135761
    v_fmaak_f32 v112, v106, v112, 0xc0135761
    v_fmaak_f32 v113, v106, v113, 0xc0135761
    v_fmaak_f32 v114, v106, v114, 0xc0135761
    v_fmaak_f32 v115, v106, v115, 0xc0135761
    v_fmaak_f32 v116, v106, v116, 0xc0135761
    v_fmaak_f32 v117, v106, v117, 0xc0135761
    v_mul_f32 v110, v80, v110
    v_mul_f32 v111, v81, v111
    v_mul_f32 v112, v82, v112
    v_mul_f32 v113, v83, v113
    v_mul_f32 v114, v84, v114
    v_mul_f32 v115, v85, v115
    v_mul_f32 v116, v86, v116
    v_mul_f32 v117, v87, v117
    v_exp_f32 v110, v110
    v_exp_f32 v111, v111
    v_exp_f32 v112, v112
    v_exp_f32 v113, v113
    v_exp_f32 v114, v114
    v_exp_f32 v115, v115
    v_exp_f32 v116, v116
    v_exp_f32 v117, v117
    v_add_f32 v110, 1.0, v110
    v_add_f32 v111, 1.0, v111
    v_add_f32 v112, 1.0, v112
    v_add_f32 v113, 1.0, v113
    v_add_f32 v114, 1.0, v114
    v_add_f32 v115, 1.0, v115
    v_add_f32 v116, 1.0, v116
    v_add_f32 v117, 1.0, v117
    v_rcp_f32 v110, v110
    v_rcp_f32 v111, v111
    v_rcp_f32 v112, v112
    v_rcp_f32 v113, v113
    v_rcp_f32 v114, v114
    v_rcp_f32 v115, v115
    v_rcp_f32 v116, v116
    v_rcp_f32 v117, v117
    v_mul_f32 v80, v80, v110
    v_mul_f32 v81, v81, v111
    v_mul_f32 v82, v82, v112
    v_mul_f32 v83, v83, v113
    v_mul_f32 v84, v84, v114
    v_mul_f32 v85, v85, v115
    v_mul_f32 v86, v86, v116
    v_mul_f32 v87, v87, v117
    v_mul_f32 v110, v88, v88
    v_mul_f32 v111, v89, v89
    v_mul_f32 v112, v90, v90
    v_mul_f32 v113, v91, v91
    v_mul_f32 v114, v92, v92
    v_mul_f32 v115, v93, v93
    v_mul_f32 v116, v94, v94
    v_mul_f32 v117, v95, v95
    v_fmaak_f32 v110, v106, v110, 0xc0135761
    v_fmaak_f32 v111, v106, v111, 0xc0135761
    v_fmaak_f32 v112, v106, v112, 0xc0135761
    v_fmaak_f32 v113, v106, v113, 0xc0135761
    v_fmaak_f32 v114, v106, v114, 0xc0135761
    v_fmaak_f32 v115, v106, v115, 0xc0135761
    v_fmaak_f32 v116, v106, v116, 0xc0135761
    v_fmaak_f32 v117, v106, v117, 0xc0135761
    v_mul_f32 v110, v88, v110
    v_mul_f32 v111, v89, v111
    v_mul_f32 v112, v90, v112
    v_mul_f32 v113, v91, v113
    v_mul_f32 v114, v92, v114
    v_mul_f32 v115, v93, v115
    v_mul_f32 v116, v94, v116
    v_mul_f32 v117, v95, v117
    v_exp_f32 v110, v110
    v_exp_f32 v111, v111
    v_exp_f32 v112, v112
    v_exp_f32 v113, v113
    v_exp_f32 v114, v114
    v_exp_f32 v115, v115
    v_exp_f32 v116, v116
    v_exp_f32 v117, v117
    v_add_f32 v110, 1.0, v110
    v_add_f32 v111, 1.0, v111
    v_add_f32 v112, 1.0, v112
    v_add_f32 v113, 1.0, v113
    v_add_f32 v114, 1.0, v114
    v_add_f32 v115, 1.0, v115
    v_add_f32 v116, 1.0, v116
    v_add_f32 v117, 1.0, v117
    v_rcp_f32 v110, v110
    v_rcp_f32 v111, v111
    v_rcp_f32 v112, v112
    v_rcp_f32 v113, v113
    v_rcp_f32 v114, v114
    v_rcp_f32 v115, v115
    v_rcp_f32 v116, v116
    v_rcp_f32 v117, v117
    v_mul_f32 v88, v88, v110
    v_mul_f32 v89, v89, v111
    v_mul_f32 v90, v90, v112
    v_mul_f32 v91, v91, v113
    v_mul_f32 v92, v92, v114
    v_mul_f32 v93, v93, v115
    v_mul_f32 v94, v94, v116
    v_mul_f32 v95, v95, v117
    v_mul_f32 v110, v96, v96
    v_mul_f32 v111, v97, v97
    v_mul_f32 v112, v98, v98
    v_mul_f32 v113, v99, v99
    v_mul_f32 v114, v100, v100
    v_mul_f32 v115, v101, v101
    v_mul_f32 v116, v102, v102
    v_mul_f32 v117, v103, v103
    v_fmaak_f32 v110, v106, v110, 0xc0135761
    v_fmaak_f32 v111, v106, v111, 0xc0135761
    v_fmaak_f32 v112, v106, v112, 0xc0135761
    v_fmaak_f32 v113, v106, v113, 0xc0135761
    v_fmaak_f32 v114, v106, v114, 0xc0135761
    v_fmaak_f32 v115, v106, v115, 0xc0135761
    v_fmaak_f32 v116, v106, v116, 0xc0135761
    v_fmaak_f32 v117, v106, v117, 0xc0135761
    v_mul_f32 v110, v96, v110
    v_mul_f32 v111, v97, v111
    v_mul_f32 v112, v98, v112
    v_mul_f32 v113, v99, v113
    v_mul_f32 v114, v100, v114
    v_mul_f32 v115, v101, v115
    v_mul_f32 v116, v102, v116
    v_mul_f32 v117, v103, v117
    v_exp_f32 v110, v110
    v_exp_f32 v111, v111
    v_exp_f32 v112, v112
    v_exp_f32 v113, v113
    v_exp_f32 v114, v114
    v_exp_f32 v115, v115
    v_exp_f32 v116, v116
    v_exp_f32 v117, v117
    v_add_f32 v110, 1.0, v110
    v_add_f32 v111, 1.0, v111
    v_add_f32 v112, 1.0, v112
    v_add_f32 v113, 1.0, v113
    v_add_f32 v114, 1.0, v114
    v_add_f32 v115, 1.0, v115
    v_add_f32 v116, 1.0, v116
    v_add_f32 v117, 1.0, v117
    v_rcp_f32 v110, v110
    v_rcp_f32 v111, v111
    v_rcp_f32 v112, v112
    v_rcp_f32 v113, v113
    v_rcp_f32 v114, v114
    v_rcp_f32 v115, v115
    v_rcp_f32 v116, v116
    v_rcp_f32 v117, v117
    v_mul_f32 v96, v96, v110
    v_mul_f32 v97, v97, v111
    v_mul_f32 v98, v98, v112
    v_mul_f32 v99, v99, v113
    v_mul_f32 v100, v100, v114
    v_mul_f32 v101, v101, v115
    v_mul_f32 v102, v102, v116
    v_mul_f32 v103, v103, v117
    s_mul_i32 s42, s40, 589824
    s_sub_u32 s43, s41, 12
    s_mul_i32 s43, s43, 3072
    s_add_u32 s42, s42, s43
    s_add_u32 s16, s84, 60817408
    s_addc_u32 s17, s85, 0
    s_and_b32 s17, s17, 0xffff
    s_mov_b32 s18, 9437184
    s_mov_b32 s19, 0x20000
    v_cvt_pk_bf16_f32 v118, v8, v9
    v_cvt_pk_bf16_f32 v119, v10, v11
    v_cvt_pk_bf16_f32 v120, v56, v57
    v_cvt_pk_bf16_f32 v121, v58, v59
    s_nop 1
    v_permlane16_swap_b32 v118, v120
    v_permlane16_swap_b32 v119, v121
    buffer_store_dwordx4 v[118:121], v104, s[16:19], s42 offen offset:0 sc1
    v_cvt_pk_bf16_f32 v122, v12, v13
    v_cvt_pk_bf16_f32 v123, v14, v15
    v_cvt_pk_bf16_f32 v124, v60, v61
    v_cvt_pk_bf16_f32 v125, v62, v63
    s_nop 1
    v_permlane16_swap_b32 v122, v124
    v_permlane16_swap_b32 v123, v125
    buffer_store_dwordx4 v[122:125], v104, s[16:19], s42 offen offset:256 sc1
    v_cvt_pk_bf16_f32 v118, v16, v17
    v_cvt_pk_bf16_f32 v119, v18, v19
    v_cvt_pk_bf16_f32 v120, v64, v65
    v_cvt_pk_bf16_f32 v121, v66, v67
    s_nop 1
    v_permlane16_swap_b32 v118, v120
    v_permlane16_swap_b32 v119, v121
    buffer_store_dwordx4 v[118:121], v104, s[16:19], s42 offen offset:512 sc1
    v_cvt_pk_bf16_f32 v122, v20, v21
    v_cvt_pk_bf16_f32 v123, v22, v23
    v_cvt_pk_bf16_f32 v124, v68, v69
    v_cvt_pk_bf16_f32 v125, v70, v71
    s_nop 1
    v_permlane16_swap_b32 v122, v124
    v_permlane16_swap_b32 v123, v125
    buffer_store_dwordx4 v[122:125], v104, s[16:19], s42 offen offset:768 sc1
    v_cvt_pk_bf16_f32 v118, v24, v25
    v_cvt_pk_bf16_f32 v119, v26, v27
    v_cvt_pk_bf16_f32 v120, v72, v73
    v_cvt_pk_bf16_f32 v121, v74, v75
    s_nop 1
    v_permlane16_swap_b32 v118, v120
    v_permlane16_swap_b32 v119, v121
    buffer_store_dwordx4 v[118:121], v104, s[16:19], s42 offen offset:1024 sc1
    v_cvt_pk_bf16_f32 v122, v28, v29
    v_cvt_pk_bf16_f32 v123, v30, v31
    v_cvt_pk_bf16_f32 v124, v76, v77
    v_cvt_pk_bf16_f32 v125, v78, v79
    s_nop 1
    v_permlane16_swap_b32 v122, v124
    v_permlane16_swap_b32 v123, v125
    buffer_store_dwordx4 v[122:125], v104, s[16:19], s42 offen offset:1280 sc1
    v_cvt_pk_bf16_f32 v118, v32, v33
    v_cvt_pk_bf16_f32 v119, v34, v35
    v_cvt_pk_bf16_f32 v120, v80, v81
    v_cvt_pk_bf16_f32 v121, v82, v83
    s_nop 1
    v_permlane16_swap_b32 v118, v120
    v_permlane16_swap_b32 v119, v121
    buffer_store_dwordx4 v[118:121], v104, s[16:19], s42 offen offset:1536 sc1
    v_cvt_pk_bf16_f32 v122, v36, v37
    v_cvt_pk_bf16_f32 v123, v38, v39
    v_cvt_pk_bf16_f32 v124, v84, v85
    v_cvt_pk_bf16_f32 v125, v86, v87
    s_nop 1
    v_permlane16_swap_b32 v122, v124
    v_permlane16_swap_b32 v123, v125
    buffer_store_dwordx4 v[122:125], v104, s[16:19], s42 offen offset:1792 sc1
    v_cvt_pk_bf16_f32 v118, v40, v41
    v_cvt_pk_bf16_f32 v119, v42, v43
    v_cvt_pk_bf16_f32 v120, v88, v89
    v_cvt_pk_bf16_f32 v121, v90, v91
    s_nop 1
    v_permlane16_swap_b32 v118, v120
    v_permlane16_swap_b32 v119, v121
    buffer_store_dwordx4 v[118:121], v104, s[16:19], s42 offen offset:2048 sc1
    v_cvt_pk_bf16_f32 v122, v44, v45
    v_cvt_pk_bf16_f32 v123, v46, v47
    v_cvt_pk_bf16_f32 v124, v92, v93
    v_cvt_pk_bf16_f32 v125, v94, v95
    s_nop 1
    v_permlane16_swap_b32 v122, v124
    v_permlane16_swap_b32 v123, v125
    buffer_store_dwordx4 v[122:125], v104, s[16:19], s42 offen offset:2304 sc1
    v_cvt_pk_bf16_f32 v118, v48, v49
    v_cvt_pk_bf16_f32 v119, v50, v51
    v_cvt_pk_bf16_f32 v120, v96, v97
    v_cvt_pk_bf16_f32 v121, v98, v99
    s_nop 1
    v_permlane16_swap_b32 v118, v120
    v_permlane16_swap_b32 v119, v121
    buffer_store_dwordx4 v[118:121], v104, s[16:19], s42 offen offset:2560 sc1
    v_cvt_pk_bf16_f32 v122, v52, v53
    v_cvt_pk_bf16_f32 v123, v54, v55
    v_cvt_pk_bf16_f32 v124, v100, v101
    v_cvt_pk_bf16_f32 v125, v102, v103
    s_nop 1
    v_permlane16_swap_b32 v122, v124
    v_permlane16_swap_b32 v123, v125
    buffer_store_dwordx4 v[122:125], v104, s[16:19], s42 offen offset:2816 sc1
    v_mov_b32 v126, v8
    v_mul_f32 v127, v8, v8
    v_mov_b32 v128, v9
    v_mul_f32 v129, v9, v9
    v_mov_b32 v130, v10
    v_mul_f32 v131, v10, v10
    v_mov_b32 v132, v11
    v_mul_f32 v133, v11, v11
    v_mov_b32 v134, v56
    v_mul_f32 v135, v56, v56
    v_mov_b32 v136, v57
    v_mul_f32 v137, v57, v57
    v_mov_b32 v138, v58
    v_mul_f32 v139, v58, v58
    v_mov_b32 v140, v59
    v_mul_f32 v141, v59, v59
    v_add_f32 v126, v126, v12
    v_fmac_f32 v127, v12, v12
    v_add_f32 v128, v128, v13
    v_fmac_f32 v129, v13, v13
    v_add_f32 v130, v130, v14
    v_fmac_f32 v131, v14, v14
    v_add_f32 v132, v132, v15
    v_fmac_f32 v133, v15, v15
    v_add_f32 v134, v134, v60
    v_fmac_f32 v135, v60, v60
    v_add_f32 v136, v136, v61
    v_fmac_f32 v137, v61, v61
    v_add_f32 v138, v138, v62
    v_fmac_f32 v139, v62, v62
    v_add_f32 v140, v140, v63
    v_fmac_f32 v141, v63, v63
    v_add_f32 v126, v126, v16
    v_fmac_f32 v127, v16, v16
    v_add_f32 v128, v128, v17
    v_fmac_f32 v129, v17, v17
    v_add_f32 v130, v130, v18
    v_fmac_f32 v131, v18, v18
    v_add_f32 v132, v132, v19
    v_fmac_f32 v133, v19, v19
    v_add_f32 v134, v134, v64
    v_fmac_f32 v135, v64, v64
    v_add_f32 v136, v136, v65
    v_fmac_f32 v137, v65, v65
    v_add_f32 v138, v138, v66
    v_fmac_f32 v139, v66, v66
    v_add_f32 v140, v140, v67
    v_fmac_f32 v141, v67, v67
    v_add_f32 v126, v126, v20
    v_fmac_f32 v127, v20, v20
    v_add_f32 v128, v128, v21
    v_fmac_f32 v129, v21, v21
    v_add_f32 v130, v130, v22
    v_fmac_f32 v131, v22, v22
    v_add_f32 v132, v132, v23
    v_fmac_f32 v133, v23, v23
    v_add_f32 v134, v134, v68
    v_fmac_f32 v135, v68, v68
    v_add_f32 v136, v136, v69
    v_fmac_f32 v137, v69, v69
    v_add_f32 v138, v138, v70
    v_fmac_f32 v139, v70, v70
    v_add_f32 v140, v140, v71
    v_fmac_f32 v141, v71, v71
    v_add_f32 v126, v126, v24
    v_fmac_f32 v127, v24, v24
    v_add_f32 v128, v128, v25
    v_fmac_f32 v129, v25, v25
    v_add_f32 v130, v130, v26
    v_fmac_f32 v131, v26, v26
    v_add_f32 v132, v132, v27
    v_fmac_f32 v133, v27, v27
    v_add_f32 v134, v134, v72
    v_fmac_f32 v135, v72, v72
    v_add_f32 v136, v136, v73
    v_fmac_f32 v137, v73, v73
    v_add_f32 v138, v138, v74
    v_fmac_f32 v139, v74, v74
    v_add_f32 v140, v140, v75
    v_fmac_f32 v141, v75, v75
    v_add_f32 v126, v126, v28
    v_fmac_f32 v127, v28, v28
    v_add_f32 v128, v128, v29
    v_fmac_f32 v129, v29, v29
    v_add_f32 v130, v130, v30
    v_fmac_f32 v131, v30, v30
    v_add_f32 v132, v132, v31
    v_fmac_f32 v133, v31, v31
    v_add_f32 v134, v134, v76
    v_fmac_f32 v135, v76, v76
    v_add_f32 v136, v136, v77
    v_fmac_f32 v137, v77, v77
    v_add_f32 v138, v138, v78
    v_fmac_f32 v139, v78, v78
    v_add_f32 v140, v140, v79
    v_fmac_f32 v141, v79, v79
    v_add_f32 v126, v126, v32
    v_fmac_f32 v127, v32, v32
    v_add_f32 v128, v128, v33
    v_fmac_f32 v129, v33, v33
    v_add_f32 v130, v130, v34
    v_fmac_f32 v131, v34, v34
    v_add_f32 v132, v132, v35
    v_fmac_f32 v133, v35, v35
    v_add_f32 v134, v134, v80
    v_fmac_f32 v135, v80, v80
    v_add_f32 v136, v136, v81
    v_fmac_f32 v137, v81, v81
    v_add_f32 v138, v138, v82
    v_fmac_f32 v139, v82, v82
    v_add_f32 v140, v140, v83
    v_fmac_f32 v141, v83, v83
    v_add_f32 v126, v126, v36
    v_fmac_f32 v127, v36, v36
    v_add_f32 v128, v128, v37
    v_fmac_f32 v129, v37, v37
    v_add_f32 v130, v130, v38
    v_fmac_f32 v131, v38, v38
    v_add_f32 v132, v132, v39
    v_fmac_f32 v133, v39, v39
    v_add_f32 v134, v134, v84
    v_fmac_f32 v135, v84, v84
    v_add_f32 v136, v136, v85
    v_fmac_f32 v137, v85, v85
    v_add_f32 v138, v138, v86
    v_fmac_f32 v139, v86, v86
    v_add_f32 v140, v140, v87
    v_fmac_f32 v141, v87, v87
    v_add_f32 v126, v126, v40
    v_fmac_f32 v127, v40, v40
    v_add_f32 v128, v128, v41
    v_fmac_f32 v129, v41, v41
    v_add_f32 v130, v130, v42
    v_fmac_f32 v131, v42, v42
    v_add_f32 v132, v132, v43
    v_fmac_f32 v133, v43, v43
    v_add_f32 v134, v134, v88
    v_fmac_f32 v135, v88, v88
    v_add_f32 v136, v136, v89
    v_fmac_f32 v137, v89, v89
    v_add_f32 v138, v138, v90
    v_fmac_f32 v139, v90, v90
    v_add_f32 v140, v140, v91
    v_fmac_f32 v141, v91, v91
    v_add_f32 v126, v126, v44
    v_fmac_f32 v127, v44, v44
    v_add_f32 v128, v128, v45
    v_fmac_f32 v129, v45, v45
    v_add_f32 v130, v130, v46
    v_fmac_f32 v131, v46, v46
    v_add_f32 v132, v132, v47
    v_fmac_f32 v133, v47, v47
    v_add_f32 v134, v134, v92
    v_fmac_f32 v135, v92, v92
    v_add_f32 v136, v136, v93
    v_fmac_f32 v137, v93, v93
    v_add_f32 v138, v138, v94
    v_fmac_f32 v139, v94, v94
    v_add_f32 v140, v140, v95
    v_fmac_f32 v141, v95, v95
    v_add_f32 v126, v126, v48
    v_fmac_f32 v127, v48, v48
    v_add_f32 v128, v128, v49
    v_fmac_f32 v129, v49, v49
    v_add_f32 v130, v130, v50
    v_fmac_f32 v131, v50, v50
    v_add_f32 v132, v132, v51
    v_fmac_f32 v133, v51, v51
    v_add_f32 v134, v134, v96
    v_fmac_f32 v135, v96, v96
    v_add_f32 v136, v136, v97
    v_fmac_f32 v137, v97, v97
    v_add_f32 v138, v138, v98
    v_fmac_f32 v139, v98, v98
    v_add_f32 v140, v140, v99
    v_fmac_f32 v141, v99, v99
    v_add_f32 v126, v126, v52
    v_fmac_f32 v127, v52, v52
    v_add_f32 v128, v128, v53
    v_fmac_f32 v129, v53, v53
    v_add_f32 v130, v130, v54
    v_fmac_f32 v131, v54, v54
    v_add_f32 v132, v132, v55
    v_fmac_f32 v133, v55, v55
    v_add_f32 v134, v134, v100
    v_fmac_f32 v135, v100, v100
    v_add_f32 v136, v136, v101
    v_fmac_f32 v137, v101, v101
    v_add_f32 v138, v138, v102
    v_fmac_f32 v139, v102, v102
    v_add_f32 v140, v140, v103
    v_fmac_f32 v141, v103, v103
    v_add_f32_dpp v126, v126, v126 row_ror:8 row_mask:0xf bank_mask:0xf
    v_add_f32_dpp v127, v127, v127 row_ror:8 row_mask:0xf bank_mask:0xf
    v_add_f32_dpp v128, v128, v128 row_ror:8 row_mask:0xf bank_mask:0xf
    v_add_f32_dpp v129, v129, v129 row_ror:8 row_mask:0xf bank_mask:0xf
    v_add_f32_dpp v130, v130, v130 row_ror:8 row_mask:0xf bank_mask:0xf
    v_add_f32_dpp v131, v131, v131 row_ror:8 row_mask:0xf bank_mask:0xf
    v_add_f32_dpp v132, v132, v132 row_ror:8 row_mask:0xf bank_mask:0xf
    v_add_f32_dpp v133, v133, v133 row_ror:8 row_mask:0xf bank_mask:0xf
    v_add_f32_dpp v134, v134, v134 row_ror:8 row_mask:0xf bank_mask:0xf
    v_add_f32_dpp v135, v135, v135 row_ror:8 row_mask:0xf bank_mask:0xf
    v_add_f32_dpp v136, v136, v136 row_ror:8 row_mask:0xf bank_mask:0xf
    v_add_f32_dpp v137, v137, v137 row_ror:8 row_mask:0xf bank_mask:0xf
    v_add_f32_dpp v138, v138, v138 row_ror:8 row_mask:0xf bank_mask:0xf
    v_add_f32_dpp v139, v139, v139 row_ror:8 row_mask:0xf bank_mask:0xf
    v_add_f32_dpp v140, v140, v140 row_ror:8 row_mask:0xf bank_mask:0xf
    v_add_f32_dpp v141, v141, v141 row_ror:8 row_mask:0xf bank_mask:0xf
    v_add_f32_dpp v126, v126, v126 row_ror:4 row_mask:0xf bank_mask:0xf
    v_add_f32_dpp v127, v127, v127 row_ror:4 row_mask:0xf bank_mask:0xf
    v_add_f32_dpp v128, v128, v128 row_ror:4 row_mask:0xf bank_mask:0xf
    v_add_f32_dpp v129, v129, v129 row_ror:4 row_mask:0xf bank_mask:0xf
    v_add_f32_dpp v130, v130, v130 row_ror:4 row_mask:0xf bank_mask:0xf
    v_add_f32_dpp v131, v131, v131 row_ror:4 row_mask:0xf bank_mask:0xf
    v_add_f32_dpp v132, v132, v132 row_ror:4 row_mask:0xf bank_mask:0xf
    v_add_f32_dpp v133, v133, v133 row_ror:4 row_mask:0xf bank_mask:0xf
    v_add_f32_dpp v134, v134, v134 row_ror:4 row_mask:0xf bank_mask:0xf
    v_add_f32_dpp v135, v135, v135 row_ror:4 row_mask:0xf bank_mask:0xf
    v_add_f32_dpp v136, v136, v136 row_ror:4 row_mask:0xf bank_mask:0xf
    v_add_f32_dpp v137, v137, v137 row_ror:4 row_mask:0xf bank_mask:0xf
    v_add_f32_dpp v138, v138, v138 row_ror:4 row_mask:0xf bank_mask:0xf
    v_add_f32_dpp v139, v139, v139 row_ror:4 row_mask:0xf bank_mask:0xf
    v_add_f32_dpp v140, v140, v140 row_ror:4 row_mask:0xf bank_mask:0xf
    v_add_f32_dpp v141, v141, v141 row_ror:4 row_mask:0xf bank_mask:0xf
    v_add_f32_dpp v126, v126, v126 row_ror:2 row_mask:0xf bank_mask:0xf
    v_add_f32_dpp v127, v127, v127 row_ror:2 row_mask:0xf bank_mask:0xf
    v_add_f32_dpp v128, v128, v128 row_ror:2 row_mask:0xf bank_mask:0xf
    v_add_f32_dpp v129, v129, v129 row_ror:2 row_mask:0xf bank_mask:0xf
    v_add_f32_dpp v130, v130, v130 row_ror:2 row_mask:0xf bank_mask:0xf
    v_add_f32_dpp v131, v131, v131 row_ror:2 row_mask:0xf bank_mask:0xf
    v_add_f32_dpp v132, v132, v132 row_ror:2 row_mask:0xf bank_mask:0xf
    v_add_f32_dpp v133, v133, v133 row_ror:2 row_mask:0xf bank_mask:0xf
    v_add_f32_dpp v134, v134, v134 row_ror:2 row_mask:0xf bank_mask:0xf
    v_add_f32_dpp v135, v135, v135 row_ror:2 row_mask:0xf bank_mask:0xf
    v_add_f32_dpp v136, v136, v136 row_ror:2 row_mask:0xf bank_mask:0xf
    v_add_f32_dpp v137, v137, v137 row_ror:2 row_mask:0xf bank_mask:0xf
    v_add_f32_dpp v138, v138, v138 row_ror:2 row_mask:0xf bank_mask:0xf
    v_add_f32_dpp v139, v139, v139 row_ror:2 row_mask:0xf bank_mask:0xf
    v_add_f32_dpp v140, v140, v140 row_ror:2 row_mask:0xf bank_mask:0xf
    v_add_f32_dpp v141, v141, v141 row_ror:2 row_mask:0xf bank_mask:0xf
    v_add_f32_dpp v126, v126, v126 row_ror:1 row_mask:0xf bank_mask:0xf
    v_add_f32_dpp v127, v127, v127 row_ror:1 row_mask:0xf bank_mask:0xf
    v_add_f32_dpp v128, v128, v128 row_ror:1 row_mask:0xf bank_mask:0xf
    v_add_f32_dpp v129, v129, v129 row_ror:1 row_mask:0xf bank_mask:0xf
    v_add_f32_dpp v130, v130, v130 row_ror:1 row_mask:0xf bank_mask:0xf
    v_add_f32_dpp v131, v131, v131 row_ror:1 row_mask:0xf bank_mask:0xf
    v_add_f32_dpp v132, v132, v132 row_ror:1 row_mask:0xf bank_mask:0xf
    v_add_f32_dpp v133, v133, v133 row_ror:1 row_mask:0xf bank_mask:0xf
    v_add_f32_dpp v134, v134, v134 row_ror:1 row_mask:0xf bank_mask:0xf
    v_add_f32_dpp v135, v135, v135 row_ror:1 row_mask:0xf bank_mask:0xf
    v_add_f32_dpp v136, v136, v136 row_ror:1 row_mask:0xf bank_mask:0xf
    v_add_f32_dpp v137, v137, v137 row_ror:1 row_mask:0xf bank_mask:0xf
    v_add_f32_dpp v138, v138, v138 row_ror:1 row_mask:0xf bank_mask:0xf
    v_add_f32_dpp v139, v139, v139 row_ror:1 row_mask:0xf bank_mask:0xf
    v_add_f32_dpp v140, v140, v140 row_ror:1 row_mask:0xf bank_mask:0xf
    v_add_f32_dpp v141, v141, v141 row_ror:1 row_mask:0xf bank_mask:0xf
    s_add_u32 s20, s84, 71303168
    s_addc_u32 s21, s85, 0
    s_and_b32 s21, s21, 0xffff
    s_mov_b32 s22, 196608
    s_mov_b32 s23, 0x20000
    v_lshrrev_b32 v3, 4, v2
    v_lshlrev_b32 v3, 5, v3
    s_lshl_b32 s4, s24, 8
    v_add_u32 v3, s4, v3
    v_and_b32 v4, 15, v2
    v_cmp_eq_u32 vcc, 0, v4
    v_mov_b32 v4, 0x7ffffff0
    s_nop 0
    v_cndmask_b32 v3, v4, v3, vcc
    s_sub_u32 s43, s41, 12
    s_mul_i32 s43, s43, 16384
    s_lshl_b32 s4, s40, 10
    s_add_u32 s43, s43, s4
    buffer_store_dwordx4 v[126:129], v3, s[20:23], s43 offen offset:0 sc1
    buffer_store_dwordx4 v[130:133], v3, s[20:23], s43 offen offset:16 sc1
    buffer_store_dwordx4 v[134:137], v3, s[20:23], s43 offen offset:128 sc1
    buffer_store_dwordx4 v[138:141], v3, s[20:23], s43 offen offset:144 sc1
    s_lshl_b32 s49, s40, 4
    s_add_u32 s49, s49, s41
    s_sub_u32 s49, s49, 12
    s_add_u32 s56, s84, 39845888
    s_addc_u32 s57, s85, 0
    s_and_b32 s57, s57, 0xffff
    s_mov_b32 s58, 16384
    s_mov_b32 s59, 0x20000
    s_cmp_lg_u32 s24, 0
    s_cbranch_scc1 Lrdyok_12
    s_mov_b32 s20, s32
    s_mov_b32 s21, s33
    s_and_b32 s21, s21, 0xffff
    s_mov_b32 s22, 256
    s_mov_b32 s23, 0x20000
    s_mov_b32 s5, 0
Lrdy_11:
    buffer_load_dword v2, off, s[20:23], 0 sc1
    s_waitcnt vmcnt(0)
    v_readfirstlane_b32 s6, v2
    s_add_u32 s5, s5, 1
    s_nop 2
    s_cmp_lg_u32 s6, 0
    s_cbranch_scc1 Lrdyok_12
    s_sleep 8
    s_cmp_lt_u32 s5, 0x20000
    s_cbranch_scc1 Lrdy_11
Lrdyok_12:
    s_waitcnt vmcnt(0)
    s_barrier
    s_cmp_lg_u32 s24, 0
    s_cbranch_scc1 Lpub_13
    s_lshl_b32 s4, s49, 2
    s_add_u32 s4, s4, 12288
    v_mov_b32 v2, 1
    buffer_store_dword v2, off, s[56:59], s4 sc1
Lpub_13:
    s_branch LG_5
Lv_3:
    s_cmp_ge_u32 s2, 240
    s_cbranch_scc1 Laux_4
    s_sub_u32 s31, s2, 192
    s_load_dwordx2 s[80:81], s[0:1], 0
    s_load_dwordx2 s[82:83], s[0:1], 8
    s_load_dwordx2 s[84:85], s[0:1], 88
    s_and_b32 s4, s31, 3
    s_lshr_b32 s5, s31, 3
    s_and_b32 s38, s5, 1
    s_bfe_u32 s6, s31, 0x10002
    s_lshl_b32 s6, s6, 1
    s_add_u32 s6, s6, s38
    s_lshl_b32 s6, s6, 2
    s_add_u32 s40, s4, s6
    s_lshr_b32 s41, s5, 1
    s_mov_b32 s39, s41
    s_waitcnt lgkmcnt(0)
    s_mov_b32 s8, s80
    s_mov_b32 s9, s81
    s_and_b32 s9, s9, 0xffff
    s_mov_b32 s10, 2359296
    s_mov_b32 s11, 0x20000
    s_mov_b32 s12, s82
    s_mov_b32 s13, s83
    s_and_b32 s13, s13, 0xffff
    s_mov_b32 s14, 1990656
    s_mov_b32 s15, 0x20000
    s_add_u32 s16, s84, 23592960
    s_addc_u32 s17, s85, 0
    s_and_b32 s17, s17, 0xffff
    s_mov_b32 s18, 2359296
    s_mov_b32 s19, 0x20000
    v_and_b32 v2, 63, v0
    v_lshrrev_b32 v3, 3, v2
    s_lshl_b32 s4, s24, 5
    v_add_u32 v3, s4, v3
    s_mov_b32 s5, 1152
    v_mul_lo_u32 v3, v3, s5
    v_lshrrev_b32 v4, 4, v2
    v_and_b32 v5, 7, v2
    v_xor_b32 v6, v5, v4
    v_lshlrev_b32 v6, 4, v6
    v_add_u32 v232, v3, v6
    v_xor_b32 v6, 64, v6
    v_add_u32 v233, v3, v6
    v_add_u32 v234, 16384, v232
    v_add_u32 v233, 8192, v233
    v_add_u32 v235, 16384, v233
    v_and_b32 v3, 15, v2
    v_lshrrev_b32 v5, 1, v3
    v_xor_b32 v5, v5, v4
    v_lshlrev_b32 v5, 4, v5
    v_lshlrev_b32 v3, 7, v3
    v_add_u32 v3, v3, v5
    s_lshl_b32 s4, s24, 13
    s_add_u32 s27, s4, 49152
    v_add_u32 v239, s27, v3
    v_xor_b32 v240, 64, v239
    v_and_b32 v2, 63, v0
    s_mul_i32 s28, s24, 3072
    s_lshl_b32 s4, s24, 3
    s_mov_b32 s5, 3456
    v_add_u32 v3, 0, v2
    v_mul_u32_u24 v4, 2731, v3
    v_lshrrev_b32 v4, 16, v4
    v_mul_u32_u24 v5, 24, v4
    v_sub_u32 v5, v3, v5
    v_add_u32 v4, s4, v4
    v_bfe_u32 v3, v4, 1, 1
    v_bfe_u32 v6, v4, 3, 1
    v_lshl_or_b32 v3, v6, 1, v3
    v_lshlrev_b32 v3, 1, v3
    v_xor_b32 v5, v5, v3
    v_mul_lo_u32 v4, v4, s5
    v_lshl_add_u32 v4, v5, 4, v4
    v_mov_b32 v236, v4
    v_add_u32 v3, 64, v2
    v_mul_u32_u24 v4, 2731, v3
    v_lshrrev_b32 v4, 16, v4
    v_mul_u32_u24 v5, 24, v4
    v_sub_u32 v5, v3, v5
    v_add_u32 v4, s4, v4
    v_bfe_u32 v3, v4, 1, 1
    v_bfe_u32 v6, v4, 3, 1
    v_lshl_or_b32 v3, v6, 1, v3
    v_lshlrev_b32 v3, 1, v3
    v_xor_b32 v5, v5, v3
    v_mul_lo_u32 v4, v4, s5
    v_lshl_add_u32 v4, v5, 4, v4
    v_subrev_u32 v237, 1024, v4
    v_add_u32 v3, 128, v2
    v_mul_u32_u24 v4, 2731, v3
    v_lshrrev_b32 v4, 16, v4
    v_mul_u32_u24 v5, 24, v4
    v_sub_u32 v5, v3, v5
    v_add_u32 v4, s4, v4
    v_bfe_u32 v3, v4, 1, 1
    v_bfe_u32 v6, v4, 3, 1
    v_lshl_or_b32 v3, v6, 1, v3
    v_lshlrev_b32 v3, 1, v3
    v_xor_b32 v5, v5, v3
    v_mul_lo_u32 v4, v4, s5
    v_lshl_add_u32 v4, v5, 4, v4
    v_subrev_u32 v238, 2048, v4
    v_lshrrev_b32 v3, 4, v2
    v_bfe_u32 v4, v2, 2, 2
    v_lshl_add_u32 v5, v3, 3, v4
    v_mul_u32_u24 v5, 384, v5
    v_and_b32 v6, 3, v2
    v_lshl_add_u32 v5, v6, 3, v5
    v_lshrrev_b32 v4, 1, v4
    v_and_b32 v3, 1, v3
    v_lshl_or_b32 v4, v3, 1, v4
    v_xor_b32 v3, 0, v4
    v_lshl_add_u32 v241, v3, 5, v5
    v_xor_b32 v3, 1, v4
    v_lshl_add_u32 v242, v3, 5, v5
    v_xor_b32 v3, 2, v4
    v_lshl_add_u32 v243, v3, 5, v5
    v_xor_b32 v3, 3, v4
    v_lshl_add_u32 v244, v3, 5, v5
    s_mul_i32 s25, s40, 147456
    s_mul_i32 s26, s41, 384
    s_add_u32 s26, s26, 2304
    s_add_u32 m0, s28, 0
    s_nop 0
    buffer_load_dwordx4 v236, s[12:15], s26 offen lds
    buffer_load_dwordx4 v237, s[12:15], s26 offen offset:1024 lds
    buffer_load_dwordx4 v238, s[12:15], s26 offen offset:2048 lds
    s_add_u32 s26, s26, 110592
    s_add_u32 m0, s27, 0
    s_nop 0
    buffer_load_dwordx4 v232, s[8:11], s25 offen lds
    buffer_load_dwordx4 v233, s[8:11], s25 offen offset:1024 lds
    buffer_load_dwordx4 v234, s[8:11], s25 offen offset:2048 lds
    buffer_load_dwordx4 v235, s[8:11], s25 offen offset:3072 lds
    s_add_u32 s25, s25, 128
    s_add_u32 m0, s28, 12288
    s_nop 0
    buffer_load_dwordx4 v236, s[12:15], s26 offen lds
    buffer_load_dwordx4 v237, s[12:15], s26 offen offset:1024 lds
    buffer_load_dwordx4 v238, s[12:15], s26 offen offset:2048 lds
    s_add_u32 s26, s26, 110592
    s_add_u32 m0, s28, 24576
    s_nop 0
    buffer_load_dwordx4 v236, s[12:15], s26 offen lds
    buffer_load_dwordx4 v237, s[12:15], s26 offen offset:1024 lds
    buffer_load_dwordx4 v238, s[12:15], s26 offen offset:2048 lds
    s_add_u32 s26, s26, 110592
    s_add_u32 m0, s27, 4096
    s_nop 0
    buffer_load_dwordx4 v232, s[8:11], s25 offen lds
    buffer_load_dwordx4 v233, s[8:11], s25 offen offset:1024 lds
    buffer_load_dwordx4 v234, s[8:11], s25 offen offset:2048 lds
    buffer_load_dwordx4 v235, s[8:11], s25 offen offset:3072 lds
    s_add_u32 s25, s25, 128
    s_add_u32 m0, s28, 36864
    s_nop 0
    buffer_load_dwordx4 v236, s[12:15], s26 offen lds
    buffer_load_dwordx4 v237, s[12:15], s26 offen offset:1024 lds
    buffer_load_dwordx4 v238, s[12:15], s26 offen offset:2048 lds
    s_add_u32 s26, s26, 110592
    v_mov_b32 v8, 0
    v_mov_b32 v9, 0
    v_mov_b32 v10, 0
    v_mov_b32 v11, 0
    v_mov_b32 v12, 0
    v_mov_b32 v13, 0
    v_mov_b32 v14, 0
    v_mov_b32 v15, 0
    v_mov_b32 v16, 0
    v_mov_b32 v17, 0
    v_mov_b32 v18, 0
    v_mov_b32 v19, 0
    v_mov_b32 v20, 0
    v_mov_b32 v21, 0
    v_mov_b32 v22, 0
    v_mov_b32 v23, 0
    v_mov_b32 v24, 0
    v_mov_b32 v25, 0
    v_mov_b32 v26, 0
    v_mov_b32 v27, 0
    v_mov_b32 v28, 0
    v_mov_b32 v29, 0
    v_mov_b32 v30, 0
    v_mov_b32 v31, 0
    v_mov_b32 v32, 0
    v_mov_b32 v33, 0
    v_mov_b32 v34, 0
    v_mov_b32 v35, 0
    v_mov_b32 v36, 0
    v_mov_b32 v37, 0
    v_mov_b32 v38, 0
    v_mov_b32 v39, 0
    v_mov_b32 v40, 0
    v_mov_b32 v41, 0
    v_mov_b32 v42, 0
    v_mov_b32 v43, 0
    v_mov_b32 v44, 0
    v_mov_b32 v45, 0
    v_mov_b32 v46, 0
    v_mov_b32 v47, 0
    v_mov_b32 v48, 0
    v_mov_b32 v49, 0
    v_mov_b32 v50, 0
    v_mov_b32 v51, 0
    v_mov_b32 v52, 0
    v_mov_b32 v53, 0
    v_mov_b32 v54, 0
    v_mov_b32 v55, 0
    v_mov_b32 v56, 0
    v_mov_b32 v57, 0
    v_mov_b32 v58, 0
    v_mov_b32 v59, 0
    v_mov_b32 v60, 0
    v_mov_b32 v61, 0
    v_mov_b32 v62, 0
    v_mov_b32 v63, 0
    v_mov_b32 v64, 0
    v_mov_b32 v65, 0
    v_mov_b32 v66, 0
    v_mov_b32 v67, 0
    v_mov_b32 v68, 0
    v_mov_b32 v69, 0
    v_mov_b32 v70, 0
    v_mov_b32 v71, 0
    v_mov_b32 v72, 0
    v_mov_b32 v73, 0
    v_mov_b32 v74, 0
    v_mov_b32 v75, 0
    v_mov_b32 v76, 0
    v_mov_b32 v77, 0
    v_mov_b32 v78, 0
    v_mov_b32 v79, 0
    v_mov_b32 v80, 0
    v_mov_b32 v81, 0
    v_mov_b32 v82, 0
    v_mov_b32 v83, 0
    v_mov_b32 v84, 0
    v_mov_b32 v85, 0
    v_mov_b32 v86, 0
    v_mov_b32 v87, 0
    v_mov_b32 v88, 0
    v_mov_b32 v89, 0
    v_mov_b32 v90, 0
    v_mov_b32 v91, 0
    v_mov_b32 v92, 0
    v_mov_b32 v93, 0
    v_mov_b32 v94, 0
    v_mov_b32 v95, 0
    v_mov_b32 v96, 0
    v_mov_b32 v97, 0
    v_mov_b32 v98, 0
    v_mov_b32 v99, 0
    v_mov_b32 v100, 0
    v_mov_b32 v101, 0
    v_mov_b32 v102, 0
    v_mov_b32 v103, 0
    s_waitcnt vmcnt(13)
    s_barrier
    ds_read_b128 v[200:203], v239 offset:0
    ds_read_b128 v[204:207], v239 offset:2048
    ds_read_b128 v[208:211], v240 offset:0
    ds_read_b128 v[212:215], v240 offset:2048
    ds_read_b64_tr_b16 v[104:105], v241 offset:0
    ds_read_b64_tr_b16 v[106:107], v241 offset:1536
    ds_read_b64_tr_b16 v[108:109], v242 offset:0
    ds_read_b64_tr_b16 v[110:111], v242 offset:1536
    ds_read_b64_tr_b16 v[112:113], v243 offset:0
    ds_read_b64_tr_b16 v[114:115], v243 offset:1536
    ds_read_b64_tr_b16 v[116:117], v244 offset:0
    ds_read_b64_tr_b16 v[118:119], v244 offset:1536
    ds_read_b64_tr_b16 v[120:121], v241 offset:128
    ds_read_b64_tr_b16 v[122:123], v241 offset:1664
    ds_read_b64_tr_b16 v[124:125], v242 offset:128
    ds_read_b64_tr_b16 v[126:127], v242 offset:1664
    ds_read_b64_tr_b16 v[128:129], v243 offset:128
    ds_read_b64_tr_b16 v[130:131], v243 offset:1664
    ds_read_b64_tr_b16 v[132:133], v244 offset:128
    ds_read_b64_tr_b16 v[134:135], v244 offset:1664
    ds_read_b64_tr_b16 v[136:137], v241 offset:256
    ds_read_b64_tr_b16 v[138:139], v241 offset:1792
    ds_read_b64_tr_b16 v[140:141], v242 offset:256
    ds_read_b64_tr_b16 v[142:143], v242 offset:1792
    ds_read_b64_tr_b16 v[144:145], v243 offset:256
    ds_read_b64_tr_b16 v[146:147], v243 offset:1792
    ds_read_b64_tr_b16 v[148:149], v244 offset:256
    ds_read_b64_tr_b16 v[150:151], v244 offset:1792
    s_mov_b32 s30, 3
Lk_14:
    s_waitcnt vmcnt(10) lgkmcnt(0)
    s_barrier
    v_mfma_f32_16x16x32_bf16 v[8:11], v[200:203], v[104:107], v[8:11]
    ds_read_b64_tr_b16 v[152:153], v241 offset:12288
    s_add_u32 m0, s28, 0
    v_mfma_f32_16x16x32_bf16 v[56:59], v[204:207], v[104:107], v[56:59]
    buffer_load_dwordx4 v236, s[12:15], s26 offen lds
    ds_read_b64_tr_b16 v[154:155], v241 offset:13824
    v_mfma_f32_16x16x32_bf16 v[12:15], v[200:203], v[108:111], v[12:15]
    ds_read_b64_tr_b16 v[156:157], v242 offset:12288
    ds_read_b64_tr_b16 v[158:159], v242 offset:13824
    v_mfma_f32_16x16x32_bf16 v[60:63], v[204:207], v[108:111], v[60:63]
    ds_read_b64_tr_b16 v[160:161], v243 offset:12288
    ds_read_b64_tr_b16 v[162:163], v243 offset:13824
    v_mfma_f32_16x16x32_bf16 v[16:19], v[200:203], v[112:115], v[16:19]
    buffer_load_dwordx4 v237, s[12:15], s26 offen offset:1024 lds
    ds_read_b64_tr_b16 v[164:165], v244 offset:12288
    v_mfma_f32_16x16x32_bf16 v[64:67], v[204:207], v[112:115], v[64:67]
    ds_read_b64_tr_b16 v[166:167], v244 offset:13824
    ds_read_b64_tr_b16 v[168:169], v241 offset:12416
    v_mfma_f32_16x16x32_bf16 v[20:23], v[200:203], v[116:119], v[20:23]
    ds_read_b64_tr_b16 v[170:171], v241 offset:13952
    ds_read_b64_tr_b16 v[172:173], v242 offset:12416
    v_mfma_f32_16x16x32_bf16 v[68:71], v[204:207], v[116:119], v[68:71]
    buffer_load_dwordx4 v238, s[12:15], s26 offen offset:2048 lds
    s_add_u32 s26, s26, 110592
    v_mfma_f32_16x16x32_bf16 v[24:27], v[200:203], v[120:123], v[24:27]
    ds_read_b64_tr_b16 v[174:175], v242 offset:13952
    ds_read_b64_tr_b16 v[176:177], v243 offset:12416
    v_mfma_f32_16x16x32_bf16 v[72:75], v[204:207], v[120:123], v[72:75]
    ds_read_b64_tr_b16 v[178:179], v243 offset:13952
    s_add_u32 m0, s27, 0
    v_mfma_f32_16x16x32_bf16 v[28:31], v[200:203], v[124:127], v[28:31]
    buffer_load_dwordx4 v232, s[8:11], s25 offen lds
    ds_read_b64_tr_b16 v[180:181], v244 offset:12416
    v_mfma_f32_16x16x32_bf16 v[76:79], v[204:207], v[124:127], v[76:79]
    ds_read_b64_tr_b16 v[182:183], v244 offset:13952
    ds_read_b64_tr_b16 v[184:185], v241 offset:12544
    v_mfma_f32_16x16x32_bf16 v[32:35], v[200:203], v[128:131], v[32:35]
    ds_read_b64_tr_b16 v[186:187], v241 offset:14080
    ds_read_b64_tr_b16 v[188:189], v242 offset:12544
    v_mfma_f32_16x16x32_bf16 v[80:83], v[204:207], v[128:131], v[80:83]
    ds_read_b64_tr_b16 v[190:191], v242 offset:14080
    ds_read_b64_tr_b16 v[192:193], v243 offset:12544
    v_mfma_f32_16x16x32_bf16 v[36:39], v[200:203], v[132:135], v[36:39]
    buffer_load_dwordx4 v233, s[8:11], s25 offen offset:1024 lds
    ds_read_b64_tr_b16 v[194:195], v243 offset:14080
    v_mfma_f32_16x16x32_bf16 v[84:87], v[204:207], v[132:135], v[84:87]
    ds_read_b64_tr_b16 v[196:197], v244 offset:12544
    ds_read_b64_tr_b16 v[198:199], v244 offset:14080
    v_mfma_f32_16x16x32_bf16 v[40:43], v[200:203], v[136:139], v[40:43]
    v_mfma_f32_16x16x32_bf16 v[88:91], v[204:207], v[136:139], v[88:91]
    buffer_load_dwordx4 v234, s[8:11], s25 offen offset:2048 lds
    v_mfma_f32_16x16x32_bf16 v[44:47], v[200:203], v[140:143], v[44:47]
    v_mfma_f32_16x16x32_bf16 v[92:95], v[204:207], v[140:143], v[92:95]
    v_mfma_f32_16x16x32_bf16 v[48:51], v[200:203], v[144:147], v[48:51]
    buffer_load_dwordx4 v235, s[8:11], s25 offen offset:3072 lds
    s_add_u32 s25, s25, 128
    v_mfma_f32_16x16x32_bf16 v[96:99], v[204:207], v[144:147], v[96:99]
    v_mfma_f32_16x16x32_bf16 v[52:55], v[200:203], v[148:151], v[52:55]
    v_mfma_f32_16x16x32_bf16 v[100:103], v[204:207], v[148:151], v[100:103]
    s_waitcnt vmcnt(10) lgkmcnt(0)
    s_barrier
    v_mfma_f32_16x16x32_bf16 v[8:11], v[208:211], v[152:155], v[8:11]
    ds_read_b128 v[216:219], v239 offset:4096
    s_add_u32 m0, s28, 12288
    v_mfma_f32_16x16x32_bf16 v[56:59], v[212:215], v[152:155], v[56:59]
    buffer_load_dwordx4 v236, s[12:15], s26 offen lds
    ds_read_b128 v[220:223], v239 offset:6144
    v_mfma_f32_16x16x32_bf16 v[12:15], v[208:211], v[156:159], v[12:15]
    ds_read_b128 v[224:227], v240 offset:4096
    ds_read_b128 v[228:231], v240 offset:6144
    v_mfma_f32_16x16x32_bf16 v[60:63], v[212:215], v[156:159], v[60:63]
    ds_read_b64_tr_b16 v[104:105], v241 offset:24576
    ds_read_b64_tr_b16 v[106:107], v241 offset:26112
    v_mfma_f32_16x16x32_bf16 v[16:19], v[208:211], v[160:163], v[16:19]
    ds_read_b64_tr_b16 v[108:109], v242 offset:24576
    ds_read_b64_tr_b16 v[110:111], v242 offset:26112
    v_mfma_f32_16x16x32_bf16 v[64:67], v[212:215], v[160:163], v[64:67]
    ds_read_b64_tr_b16 v[112:113], v243 offset:24576
    ds_read_b64_tr_b16 v[114:115], v243 offset:26112
    v_mfma_f32_16x16x32_bf16 v[20:23], v[208:211], v[164:167], v[20:23]
    ds_read_b64_tr_b16 v[116:117], v244 offset:24576
    ds_read_b64_tr_b16 v[118:119], v244 offset:26112
    v_mfma_f32_16x16x32_bf16 v[68:71], v[212:215], v[164:167], v[68:71]
    ds_read_b64_tr_b16 v[120:121], v241 offset:24704
    ds_read_b64_tr_b16 v[122:123], v241 offset:26240
    v_mfma_f32_16x16x32_bf16 v[24:27], v[208:211], v[168:171], v[24:27]
    buffer_load_dwordx4 v237, s[12:15], s26 offen offset:1024 lds
    ds_read_b64_tr_b16 v[124:125], v242 offset:24704
    v_mfma_f32_16x16x32_bf16 v[72:75], v[212:215], v[168:171], v[72:75]
    ds_read_b64_tr_b16 v[126:127], v242 offset:26240
    ds_read_b64_tr_b16 v[128:129], v243 offset:24704
    v_mfma_f32_16x16x32_bf16 v[28:31], v[208:211], v[172:175], v[28:31]
    ds_read_b64_tr_b16 v[130:131], v243 offset:26240
    ds_read_b64_tr_b16 v[132:133], v244 offset:24704
    v_mfma_f32_16x16x32_bf16 v[76:79], v[212:215], v[172:175], v[76:79]
    ds_read_b64_tr_b16 v[134:135], v244 offset:26240
    ds_read_b64_tr_b16 v[136:137], v241 offset:24832
    v_mfma_f32_16x16x32_bf16 v[32:35], v[208:211], v[176:179], v[32:35]
    ds_read_b64_tr_b16 v[138:139], v241 offset:26368
    ds_read_b64_tr_b16 v[140:141], v242 offset:24832
    v_mfma_f32_16x16x32_bf16 v[80:83], v[212:215], v[176:179], v[80:83]
    ds_read_b64_tr_b16 v[142:143], v242 offset:26368
    ds_read_b64_tr_b16 v[144:145], v243 offset:24832
    v_mfma_f32_16x16x32_bf16 v[36:39], v[208:211], v[180:183], v[36:39]
    ds_read_b64_tr_b16 v[146:147], v243 offset:26368
    ds_read_b64_tr_b16 v[148:149], v244 offset:24832
    v_mfma_f32_16x16x32_bf16 v[84:87], v[212:215], v[180:183], v[84:87]
    ds_read_b64_tr_b16 v[150:151], v244 offset:26368
    v_mfma_f32_16x16x32_bf16 v[40:43], v[208:211], v[184:187], v[40:43]
    buffer_load_dwordx4 v238, s[12:15], s26 offen offset:2048 lds
    s_add_u32 s26, s26, 110592
    v_mfma_f32_16x16x32_bf16 v[88:91], v[212:215], v[184:187], v[88:91]
    v_mfma_f32_16x16x32_bf16 v[44:47], v[208:211], v[188:191], v[44:47]
    v_mfma_f32_16x16x32_bf16 v[92:95], v[212:215], v[188:191], v[92:95]
    v_mfma_f32_16x16x32_bf16 v[48:51], v[208:211], v[192:195], v[48:51]
    v_mfma_f32_16x16x32_bf16 v[96:99], v[212:215], v[192:195], v[96:99]
    v_mfma_f32_16x16x32_bf16 v[52:55], v[208:211], v[196:199], v[52:55]
    v_mfma_f32_16x16x32_bf16 v[100:103], v[212:215], v[196:199], v[100:103]
    s_waitcnt vmcnt(10) lgkmcnt(0)
    s_barrier
    v_mfma_f32_16x16x32_bf16 v[8:11], v[216:219], v[104:107], v[8:11]
    ds_read_b64_tr_b16 v[152:153], v241 offset:36864
    s_add_u32 m0, s28, 24576
    v_mfma_f32_16x16x32_bf16 v[56:59], v[220:223], v[104:107], v[56:59]
    buffer_load_dwordx4 v236, s[12:15], s26 offen lds
    ds_read_b64_tr_b16 v[154:155], v241 offset:38400
    v_mfma_f32_16x16x32_bf16 v[12:15], v[216:219], v[108:111], v[12:15]
    ds_read_b64_tr_b16 v[156:157], v242 offset:36864
    ds_read_b64_tr_b16 v[158:159], v242 offset:38400
    v_mfma_f32_16x16x32_bf16 v[60:63], v[220:223], v[108:111], v[60:63]
    ds_read_b64_tr_b16 v[160:161], v243 offset:36864
    ds_read_b64_tr_b16 v[162:163], v243 offset:38400
    v_mfma_f32_16x16x32_bf16 v[16:19], v[216:219], v[112:115], v[16:19]
    buffer_load_dwordx4 v237, s[12:15], s26 offen offset:1024 lds
    ds_read_b64_tr_b16 v[164:165], v244 offset:36864
    v_mfma_f32_16x16x32_bf16 v[64:67], v[220:223], v[112:115], v[64:67]
    ds_read_b64_tr_b16 v[166:167], v244 offset:38400
    ds_read_b64_tr_b16 v[168:169], v241 offset:36992
    v_mfma_f32_16x16x32_bf16 v[20:23], v[216:219], v[116:119], v[20:23]
    ds_read_b64_tr_b16 v[170:171], v241 offset:38528
    ds_read_b64_tr_b16 v[172:173], v242 offset:36992
    v_mfma_f32_16x16x32_bf16 v[68:71], v[220:223], v[116:119], v[68:71]
    buffer_load_dwordx4 v238, s[12:15], s26 offen offset:2048 lds
    s_add_u32 s26, s26, 110592
    v_mfma_f32_16x16x32_bf16 v[24:27], v[216:219], v[120:123], v[24:27]
    ds_read_b64_tr_b16 v[174:175], v242 offset:38528
    ds_read_b64_tr_b16 v[176:177], v243 offset:36992
    v_mfma_f32_16x16x32_bf16 v[72:75], v[220:223], v[120:123], v[72:75]
    ds_read_b64_tr_b16 v[178:179], v243 offset:38528
    s_add_u32 m0, s27, 4096
    v_mfma_f32_16x16x32_bf16 v[28:31], v[216:219], v[124:127], v[28:31]
    buffer_load_dwordx4 v232, s[8:11], s25 offen lds
    ds_read_b64_tr_b16 v[180:181], v244 offset:36992
    v_mfma_f32_16x16x32_bf16 v[76:79], v[220:223], v[124:127], v[76:79]
    ds_read_b64_tr_b16 v[182:183], v244 offset:38528
    ds_read_b64_tr_b16 v[184:185], v241 offset:37120
    v_mfma_f32_16x16x32_bf16 v[32:35], v[216:219], v[128:131], v[32:35]
    ds_read_b64_tr_b16 v[186:187], v241 offset:38656
    ds_read_b64_tr_b16 v[188:189], v242 offset:37120
    v_mfma_f32_16x16x32_bf16 v[80:83], v[220:223], v[128:131], v[80:83]
    ds_read_b64_tr_b16 v[190:191], v242 offset:38656
    ds_read_b64_tr_b16 v[192:193], v243 offset:37120
    v_mfma_f32_16x16x32_bf16 v[36:39], v[216:219], v[132:135], v[36:39]
    buffer_load_dwordx4 v233, s[8:11], s25 offen offset:1024 lds
    ds_read_b64_tr_b16 v[194:195], v243 offset:38656
    v_mfma_f32_16x16x32_bf16 v[84:87], v[220:223], v[132:135], v[84:87]
    ds_read_b64_tr_b16 v[196:197], v244 offset:37120
    ds_read_b64_tr_b16 v[198:199], v244 offset:38656
    v_mfma_f32_16x16x32_bf16 v[40:43], v[216:219], v[136:139], v[40:43]
    v_mfma_f32_16x16x32_bf16 v[88:91], v[220:223], v[136:139], v[88:91]
    buffer_load_dwordx4 v234, s[8:11], s25 offen offset:2048 lds
    v_mfma_f32_16x16x32_bf16 v[44:47], v[216:219], v[140:143], v[44:47]
    v_mfma_f32_16x16x32_bf16 v[92:95], v[220:223], v[140:143], v[92:95]
    v_mfma_f32_16x16x32_bf16 v[48:51], v[216:219], v[144:147], v[48:51]
    buffer_load_dwordx4 v235, s[8:11], s25 offen offset:3072 lds
    s_add_u32 s25, s25, 128
    v_mfma_f32_16x16x32_bf16 v[96:99], v[220:223], v[144:147], v[96:99]
    v_mfma_f32_16x16x32_bf16 v[52:55], v[216:219], v[148:151], v[52:55]
    v_mfma_f32_16x16x32_bf16 v[100:103], v[220:223], v[148:151], v[100:103]
    s_waitcnt vmcnt(10) lgkmcnt(0)
    s_barrier
    v_mfma_f32_16x16x32_bf16 v[8:11], v[224:227], v[152:155], v[8:11]
    ds_read_b128 v[200:203], v239 offset:0
    s_add_u32 m0, s28, 36864
    v_mfma_f32_16x16x32_bf16 v[56:59], v[228:231], v[152:155], v[56:59]
    buffer_load_dwordx4 v236, s[12:15], s26 offen lds
    ds_read_b128 v[204:207], v239 offset:2048
    v_mfma_f32_16x16x32_bf16 v[12:15], v[224:227], v[156:159], v[12:15]
    ds_read_b128 v[208:211], v240 offset:0
    ds_read_b128 v[212:215], v240 offset:2048
    v_mfma_f32_16x16x32_bf16 v[60:63], v[228:231], v[156:159], v[60:63]
    ds_read_b64_tr_b16 v[104:105], v241 offset:0
    ds_read_b64_tr_b16 v[106:107], v241 offset:1536
    v_mfma_f32_16x16x32_bf16 v[16:19], v[224:227], v[160:163], v[16:19]
    ds_read_b64_tr_b16 v[108:109], v242 offset:0
    ds_read_b64_tr_b16 v[110:111], v242 offset:1536
    v_mfma_f32_16x16x32_bf16 v[64:67], v[228:231], v[160:163], v[64:67]
    ds_read_b64_tr_b16 v[112:113], v243 offset:0
    ds_read_b64_tr_b16 v[114:115], v243 offset:1536
    v_mfma_f32_16x16x32_bf16 v[20:23], v[224:227], v[164:167], v[20:23]
    ds_read_b64_tr_b16 v[116:117], v244 offset:0
    ds_read_b64_tr_b16 v[118:119], v244 offset:1536
    v_mfma_f32_16x16x32_bf16 v[68:71], v[228:231], v[164:167], v[68:71]
    ds_read_b64_tr_b16 v[120:121], v241 offset:128
    ds_read_b64_tr_b16 v[122:123], v241 offset:1664
    v_mfma_f32_16x16x32_bf16 v[24:27], v[224:227], v[168:171], v[24:27]
    buffer_load_dwordx4 v237, s[12:15], s26 offen offset:1024 lds
    ds_read_b64_tr_b16 v[124:125], v242 offset:128
    v_mfma_f32_16x16x32_bf16 v[72:75], v[228:231], v[168:171], v[72:75]
    ds_read_b64_tr_b16 v[126:127], v242 offset:1664
    ds_read_b64_tr_b16 v[128:129], v243 offset:128
    v_mfma_f32_16x16x32_bf16 v[28:31], v[224:227], v[172:175], v[28:31]
    ds_read_b64_tr_b16 v[130:131], v243 offset:1664
    ds_read_b64_tr_b16 v[132:133], v244 offset:128
    v_mfma_f32_16x16x32_bf16 v[76:79], v[228:231], v[172:175], v[76:79]
    ds_read_b64_tr_b16 v[134:135], v244 offset:1664
    ds_read_b64_tr_b16 v[136:137], v241 offset:256
    v_mfma_f32_16x16x32_bf16 v[32:35], v[224:227], v[176:179], v[32:35]
    ds_read_b64_tr_b16 v[138:139], v241 offset:1792
    ds_read_b64_tr_b16 v[140:141], v242 offset:256
    v_mfma_f32_16x16x32_bf16 v[80:83], v[228:231], v[176:179], v[80:83]
    ds_read_b64_tr_b16 v[142:143], v242 offset:1792
    ds_read_b64_tr_b16 v[144:145], v243 offset:256
    v_mfma_f32_16x16x32_bf16 v[36:39], v[224:227], v[180:183], v[36:39]
    ds_read_b64_tr_b16 v[146:147], v243 offset:1792
    ds_read_b64_tr_b16 v[148:149], v244 offset:256
    v_mfma_f32_16x16x32_bf16 v[84:87], v[228:231], v[180:183], v[84:87]
    ds_read_b64_tr_b16 v[150:151], v244 offset:1792
    v_mfma_f32_16x16x32_bf16 v[40:43], v[224:227], v[184:187], v[40:43]
    buffer_load_dwordx4 v238, s[12:15], s26 offen offset:2048 lds
    s_add_u32 s26, s26, 110592
    v_mfma_f32_16x16x32_bf16 v[88:91], v[228:231], v[184:187], v[88:91]
    v_mfma_f32_16x16x32_bf16 v[44:47], v[224:227], v[188:191], v[44:47]
    v_mfma_f32_16x16x32_bf16 v[92:95], v[228:231], v[188:191], v[92:95]
    v_mfma_f32_16x16x32_bf16 v[48:51], v[224:227], v[192:195], v[48:51]
    v_mfma_f32_16x16x32_bf16 v[96:99], v[228:231], v[192:195], v[96:99]
    v_mfma_f32_16x16x32_bf16 v[52:55], v[224:227], v[196:199], v[52:55]
    v_mfma_f32_16x16x32_bf16 v[100:103], v[228:231], v[196:199], v[100:103]
    s_sub_u32 s30, s30, 1
    s_cmp_lg_u32 s30, 0
    s_cbranch_scc1 Lk_14
    s_waitcnt vmcnt(10) lgkmcnt(0)
    s_barrier
    v_mfma_f32_16x16x32_bf16 v[8:11], v[200:203], v[104:107], v[8:11]
    ds_read_b64_tr_b16 v[152:153], v241 offset:12288
    s_add_u32 m0, s28, 0
    v_mfma_f32_16x16x32_bf16 v[56:59], v[204:207], v[104:107], v[56:59]
    buffer_load_dwordx4 v236, s[12:15], s26 offen lds
    ds_read_b64_tr_b16 v[154:155], v241 offset:13824
    v_mfma_f32_16x16x32_bf16 v[12:15], v[200:203], v[108:111], v[12:15]
    ds_read_b64_tr_b16 v[156:157], v242 offset:12288
    ds_read_b64_tr_b16 v[158:159], v242 offset:13824
    v_mfma_f32_16x16x32_bf16 v[60:63], v[204:207], v[108:111], v[60:63]
    ds_read_b64_tr_b16 v[160:161], v243 offset:12288
    ds_read_b64_tr_b16 v[162:163], v243 offset:13824
    v_mfma_f32_16x16x32_bf16 v[16:19], v[200:203], v[112:115], v[16:19]
    buffer_load_dwordx4 v237, s[12:15], s26 offen offset:1024 lds
    ds_read_b64_tr_b16 v[164:165], v244 offset:12288
    v_mfma_f32_16x16x32_bf16 v[64:67], v[204:207], v[112:115], v[64:67]
    ds_read_b64_tr_b16 v[166:167], v244 offset:13824
    ds_read_b64_tr_b16 v[168:169], v241 offset:12416
    v_mfma_f32_16x16x32_bf16 v[20:23], v[200:203], v[116:119], v[20:23]
    ds_read_b64_tr_b16 v[170:171], v241 offset:13952
    ds_read_b64_tr_b16 v[172:173], v242 offset:12416
    v_mfma_f32_16x16x32_bf16 v[68:71], v[204:207], v[116:119], v[68:71]
    buffer_load_dwordx4 v238, s[12:15], s26 offen offset:2048 lds
    s_add_u32 s26, s26, 110592
    v_mfma_f32_16x16x32_bf16 v[24:27], v[200:203], v[120:123], v[24:27]
    ds_read_b64_tr_b16 v[174:175], v242 offset:13952
    ds_read_b64_tr_b16 v[176:177], v243 offset:12416
    v_mfma_f32_16x16x32_bf16 v[72:75], v[204:207], v[120:123], v[72:75]
    ds_read_b64_tr_b16 v[178:179], v243 offset:13952
    s_add_u32 m0, s27, 0
    v_mfma_f32_16x16x32_bf16 v[28:31], v[200:203], v[124:127], v[28:31]
    buffer_load_dwordx4 v232, s[8:11], s25 offen lds
    ds_read_b64_tr_b16 v[180:181], v244 offset:12416
    v_mfma_f32_16x16x32_bf16 v[76:79], v[204:207], v[124:127], v[76:79]
    ds_read_b64_tr_b16 v[182:183], v244 offset:13952
    ds_read_b64_tr_b16 v[184:185], v241 offset:12544
    v_mfma_f32_16x16x32_bf16 v[32:35], v[200:203], v[128:131], v[32:35]
    ds_read_b64_tr_b16 v[186:187], v241 offset:14080
    ds_read_b64_tr_b16 v[188:189], v242 offset:12544
    v_mfma_f32_16x16x32_bf16 v[80:83], v[204:207], v[128:131], v[80:83]
    ds_read_b64_tr_b16 v[190:191], v242 offset:14080
    ds_read_b64_tr_b16 v[192:193], v243 offset:12544
    v_mfma_f32_16x16x32_bf16 v[36:39], v[200:203], v[132:135], v[36:39]
    buffer_load_dwordx4 v233, s[8:11], s25 offen offset:1024 lds
    ds_read_b64_tr_b16 v[194:195], v243 offset:14080
    v_mfma_f32_16x16x32_bf16 v[84:87], v[204:207], v[132:135], v[84:87]
    ds_read_b64_tr_b16 v[196:197], v244 offset:12544
    ds_read_b64_tr_b16 v[198:199], v244 offset:14080
    v_mfma_f32_16x16x32_bf16 v[40:43], v[200:203], v[136:139], v[40:43]
    v_mfma_f32_16x16x32_bf16 v[88:91], v[204:207], v[136:139], v[88:91]
    buffer_load_dwordx4 v234, s[8:11], s25 offen offset:2048 lds
    v_mfma_f32_16x16x32_bf16 v[44:47], v[200:203], v[140:143], v[44:47]
    v_mfma_f32_16x16x32_bf16 v[92:95], v[204:207], v[140:143], v[92:95]
    v_mfma_f32_16x16x32_bf16 v[48:51], v[200:203], v[144:147], v[48:51]
    buffer_load_dwordx4 v235, s[8:11], s25 offen offset:3072 lds
    s_add_u32 s25, s25, 128
    v_mfma_f32_16x16x32_bf16 v[96:99], v[204:207], v[144:147], v[96:99]
    v_mfma_f32_16x16x32_bf16 v[52:55], v[200:203], v[148:151], v[52:55]
    v_mfma_f32_16x16x32_bf16 v[100:103], v[204:207], v[148:151], v[100:103]
    s_waitcnt vmcnt(10) lgkmcnt(0)
    s_barrier
    v_mfma_f32_16x16x32_bf16 v[8:11], v[208:211], v[152:155], v[8:11]
    ds_read_b128 v[216:219], v239 offset:4096
    s_add_u32 m0, s28, 12288
    v_mfma_f32_16x16x32_bf16 v[56:59], v[212:215], v[152:155], v[56:59]
    buffer_load_dwordx4 v236, s[12:15], s26 offen lds
    ds_read_b128 v[220:223], v239 offset:6144
    v_mfma_f32_16x16x32_bf16 v[12:15], v[208:211], v[156:159], v[12:15]
    ds_read_b128 v[224:227], v240 offset:4096
    ds_read_b128 v[228:231], v240 offset:6144
    v_mfma_f32_16x16x32_bf16 v[60:63], v[212:215], v[156:159], v[60:63]
    ds_read_b64_tr_b16 v[104:105], v241 offset:24576
    ds_read_b64_tr_b16 v[106:107], v241 offset:26112
    v_mfma_f32_16x16x32_bf16 v[16:19], v[208:211], v[160:163], v[16:19]
    ds_read_b64_tr_b16 v[108:109], v242 offset:24576
    ds_read_b64_tr_b16 v[110:111], v242 offset:26112
    v_mfma_f32_16x16x32_bf16 v[64:67], v[212:215], v[160:163], v[64:67]
    ds_read_b64_tr_b16 v[112:113], v243 offset:24576
    ds_read_b64_tr_b16 v[114:115], v243 offset:26112
    v_mfma_f32_16x16x32_bf16 v[20:23], v[208:211], v[164:167], v[20:23]
    ds_read_b64_tr_b16 v[116:117], v244 offset:24576
    ds_read_b64_tr_b16 v[118:119], v244 offset:26112
    v_mfma_f32_16x16x32_bf16 v[68:71], v[212:215], v[164:167], v[68:71]
    ds_read_b64_tr_b16 v[120:121], v241 offset:24704
    ds_read_b64_tr_b16 v[122:123], v241 offset:26240
    v_mfma_f32_16x16x32_bf16 v[24:27], v[208:211], v[168:171], v[24:27]
    buffer_load_dwordx4 v237, s[12:15], s26 offen offset:1024 lds
    ds_read_b64_tr_b16 v[124:125], v242 offset:24704
    v_mfma_f32_16x16x32_bf16 v[72:75], v[212:215], v[168:171], v[72:75]
    ds_read_b64_tr_b16 v[126:127], v242 offset:26240
    ds_read_b64_tr_b16 v[128:129], v243 offset:24704
    v_mfma_f32_16x16x32_bf16 v[28:31], v[208:211], v[172:175], v[28:31]
    ds_read_b64_tr_b16 v[130:131], v243 offset:26240
    ds_read_b64_tr_b16 v[132:133], v244 offset:24704
    v_mfma_f32_16x16x32_bf16 v[76:79], v[212:215], v[172:175], v[76:79]
    ds_read_b64_tr_b16 v[134:135], v244 offset:26240
    ds_read_b64_tr_b16 v[136:137], v241 offset:24832
    v_mfma_f32_16x16x32_bf16 v[32:35], v[208:211], v[176:179], v[32:35]
    ds_read_b64_tr_b16 v[138:139], v241 offset:26368
    ds_read_b64_tr_b16 v[140:141], v242 offset:24832
    v_mfma_f32_16x16x32_bf16 v[80:83], v[212:215], v[176:179], v[80:83]
    ds_read_b64_tr_b16 v[142:143], v242 offset:26368
    ds_read_b64_tr_b16 v[144:145], v243 offset:24832
    v_mfma_f32_16x16x32_bf16 v[36:39], v[208:211], v[180:183], v[36:39]
    ds_read_b64_tr_b16 v[146:147], v243 offset:26368
    ds_read_b64_tr_b16 v[148:149], v244 offset:24832
    v_mfma_f32_16x16x32_bf16 v[84:87], v[212:215], v[180:183], v[84:87]
    ds_read_b64_tr_b16 v[150:151], v244 offset:26368
    v_mfma_f32_16x16x32_bf16 v[40:43], v[208:211], v[184:187], v[40:43]
    buffer_load_dwordx4 v238, s[12:15], s26 offen offset:2048 lds
    s_add_u32 s26, s26, 110592
    v_mfma_f32_16x16x32_bf16 v[88:91], v[212:215], v[184:187], v[88:91]
    v_mfma_f32_16x16x32_bf16 v[44:47], v[208:211], v[188:191], v[44:47]
    v_mfma_f32_16x16x32_bf16 v[92:95], v[212:215], v[188:191], v[92:95]
    v_mfma_f32_16x16x32_bf16 v[48:51], v[208:211], v[192:195], v[48:51]
    v_mfma_f32_16x16x32_bf16 v[96:99], v[212:215], v[192:195], v[96:99]
    v_mfma_f32_16x16x32_bf16 v[52:55], v[208:211], v[196:199], v[52:55]
    v_mfma_f32_16x16x32_bf16 v[100:103], v[212:215], v[196:199], v[100:103]
    s_waitcnt vmcnt(10) lgkmcnt(0)
    s_barrier
    v_mfma_f32_16x16x32_bf16 v[8:11], v[216:219], v[104:107], v[8:11]
    ds_read_b64_tr_b16 v[152:153], v241 offset:36864
    ds_read_b64_tr_b16 v[154:155], v241 offset:38400
    v_mfma_f32_16x16x32_bf16 v[56:59], v[220:223], v[104:107], v[56:59]
    ds_read_b64_tr_b16 v[156:157], v242 offset:36864
    ds_read_b64_tr_b16 v[158:159], v242 offset:38400
    v_mfma_f32_16x16x32_bf16 v[12:15], v[216:219], v[108:111], v[12:15]
    ds_read_b64_tr_b16 v[160:161], v243 offset:36864
    ds_read_b64_tr_b16 v[162:163], v243 offset:38400
    v_mfma_f32_16x16x32_bf16 v[60:63], v[220:223], v[108:111], v[60:63]
    ds_read_b64_tr_b16 v[164:165], v244 offset:36864
    ds_read_b64_tr_b16 v[166:167], v244 offset:38400
    v_mfma_f32_16x16x32_bf16 v[16:19], v[216:219], v[112:115], v[16:19]
    ds_read_b64_tr_b16 v[168:169], v241 offset:36992
    ds_read_b64_tr_b16 v[170:171], v241 offset:38528
    v_mfma_f32_16x16x32_bf16 v[64:67], v[220:223], v[112:115], v[64:67]
    ds_read_b64_tr_b16 v[172:173], v242 offset:36992
    ds_read_b64_tr_b16 v[174:175], v242 offset:38528
    v_mfma_f32_16x16x32_bf16 v[20:23], v[216:219], v[116:119], v[20:23]
    ds_read_b64_tr_b16 v[176:177], v243 offset:36992
    ds_read_b64_tr_b16 v[178:179], v243 offset:38528
    v_mfma_f32_16x16x32_bf16 v[68:71], v[220:223], v[116:119], v[68:71]
    ds_read_b64_tr_b16 v[180:181], v244 offset:36992
    ds_read_b64_tr_b16 v[182:183], v244 offset:38528
    v_mfma_f32_16x16x32_bf16 v[24:27], v[216:219], v[120:123], v[24:27]
    ds_read_b64_tr_b16 v[184:185], v241 offset:37120
    ds_read_b64_tr_b16 v[186:187], v241 offset:38656
    v_mfma_f32_16x16x32_bf16 v[72:75], v[220:223], v[120:123], v[72:75]
    ds_read_b64_tr_b16 v[188:189], v242 offset:37120
    ds_read_b64_tr_b16 v[190:191], v242 offset:38656
    v_mfma_f32_16x16x32_bf16 v[28:31], v[216:219], v[124:127], v[28:31]
    ds_read_b64_tr_b16 v[192:193], v243 offset:37120
    ds_read_b64_tr_b16 v[194:195], v243 offset:38656
    v_mfma_f32_16x16x32_bf16 v[76:79], v[220:223], v[124:127], v[76:79]
    ds_read_b64_tr_b16 v[196:197], v244 offset:37120
    ds_read_b64_tr_b16 v[198:199], v244 offset:38656
    v_mfma_f32_16x16x32_bf16 v[32:35], v[216:219], v[128:131], v[32:35]
    v_mfma_f32_16x16x32_bf16 v[80:83], v[220:223], v[128:131], v[80:83]
    v_mfma_f32_16x16x32_bf16 v[36:39], v[216:219], v[132:135], v[36:39]
    v_mfma_f32_16x16x32_bf16 v[84:87], v[220:223], v[132:135], v[84:87]
    v_mfma_f32_16x16x32_bf16 v[40:43], v[216:219], v[136:139], v[40:43]
    v_mfma_f32_16x16x32_bf16 v[88:91], v[220:223], v[136:139], v[88:91]
    v_mfma_f32_16x16x32_bf16 v[44:47], v[216:219], v[140:143], v[44:47]
    v_mfma_f32_16x16x32_bf16 v[92:95], v[220:223], v[140:143], v[92:95]
    v_mfma_f32_16x16x32_bf16 v[48:51], v[216:219], v[144:147], v[48:51]
    v_mfma_f32_16x16x32_bf16 v[96:99], v[220:223], v[144:147], v[96:99]
    v_mfma_f32_16x16x32_bf16 v[52:55], v[216:219], v[148:151], v[52:55]
    v_mfma_f32_16x16x32_bf16 v[100:103], v[220:223], v[148:151], v[100:103]
    s_waitcnt vmcnt(3) lgkmcnt(0)
    s_barrier
    v_mfma_f32_16x16x32_bf16 v[8:11], v[224:227], v[152:155], v[8:11]
    ds_read_b128 v[200:203], v239 offset:0
    ds_read_b128 v[204:207], v239 offset:2048
    v_mfma_f32_16x16x32_bf16 v[56:59], v[228:231], v[152:155], v[56:59]
    ds_read_b128 v[208:211], v240 offset:0
    ds_read_b128 v[212:215], v240 offset:2048
    v_mfma_f32_16x16x32_bf16 v[12:15], v[224:227], v[156:159], v[12:15]
    ds_read_b64_tr_b16 v[104:105], v241 offset:0
    ds_read_b64_tr_b16 v[106:107], v241 offset:1536
    v_mfma_f32_16x16x32_bf16 v[60:63], v[228:231], v[156:159], v[60:63]
    ds_read_b64_tr_b16 v[108:109], v242 offset:0
    ds_read_b64_tr_b16 v[110:111], v242 offset:1536
    v_mfma_f32_16x16x32_bf16 v[16:19], v[224:227], v[160:163], v[16:19]
    ds_read_b64_tr_b16 v[112:113], v243 offset:0
    ds_read_b64_tr_b16 v[114:115], v243 offset:1536
    v_mfma_f32_16x16x32_bf16 v[64:67], v[228:231], v[160:163], v[64:67]
    ds_read_b64_tr_b16 v[116:117], v244 offset:0
    ds_read_b64_tr_b16 v[118:119], v244 offset:1536
    v_mfma_f32_16x16x32_bf16 v[20:23], v[224:227], v[164:167], v[20:23]
    ds_read_b64_tr_b16 v[120:121], v241 offset:128
    ds_read_b64_tr_b16 v[122:123], v241 offset:1664
    v_mfma_f32_16x16x32_bf16 v[68:71], v[228:231], v[164:167], v[68:71]
    ds_read_b64_tr_b16 v[124:125], v242 offset:128
    ds_read_b64_tr_b16 v[126:127], v242 offset:1664
    v_mfma_f32_16x16x32_bf16 v[24:27], v[224:227], v[168:171], v[24:27]
    ds_read_b64_tr_b16 v[128:129], v243 offset:128
    ds_read_b64_tr_b16 v[130:131], v243 offset:1664
    v_mfma_f32_16x16x32_bf16 v[72:75], v[228:231], v[168:171], v[72:75]
    ds_read_b64_tr_b16 v[132:133], v244 offset:128
    ds_read_b64_tr_b16 v[134:135], v244 offset:1664
    v_mfma_f32_16x16x32_bf16 v[28:31], v[224:227], v[172:175], v[28:31]
    ds_read_b64_tr_b16 v[136:137], v241 offset:256
    ds_read_b64_tr_b16 v[138:139], v241 offset:1792
    v_mfma_f32_16x16x32_bf16 v[76:79], v[228:231], v[172:175], v[76:79]
    ds_read_b64_tr_b16 v[140:141], v242 offset:256
    ds_read_b64_tr_b16 v[142:143], v242 offset:1792
    v_mfma_f32_16x16x32_bf16 v[32:35], v[224:227], v[176:179], v[32:35]
    ds_read_b64_tr_b16 v[144:145], v243 offset:256
    ds_read_b64_tr_b16 v[146:147], v243 offset:1792
    v_mfma_f32_16x16x32_bf16 v[80:83], v[228:231], v[176:179], v[80:83]
    ds_read_b64_tr_b16 v[148:149], v244 offset:256
    ds_read_b64_tr_b16 v[150:151], v244 offset:1792
    v_mfma_f32_16x16x32_bf16 v[36:39], v[224:227], v[180:183], v[36:39]
    v_mfma_f32_16x16x32_bf16 v[84:87], v[228:231], v[180:183], v[84:87]
    v_mfma_f32_16x16x32_bf16 v[40:43], v[224:227], v[184:187], v[40:43]
    v_mfma_f32_16x16x32_bf16 v[88:91], v[228:231], v[184:187], v[88:91]
    v_mfma_f32_16x16x32_bf16 v[44:47], v[224:227], v[188:191], v[44:47]
    v_mfma_f32_16x16x32_bf16 v[92:95], v[228:231], v[188:191], v[92:95]
    v_mfma_f32_16x16x32_bf16 v[48:51], v[224:227], v[192:195], v[48:51]
    v_mfma_f32_16x16x32_bf16 v[96:99], v[228:231], v[192:195], v[96:99]
    v_mfma_f32_16x16x32_bf16 v[52:55], v[224:227], v[196:199], v[52:55]
    v_mfma_f32_16x16x32_bf16 v[100:103], v[228:231], v[196:199], v[100:103]
    s_waitcnt vmcnt(0) lgkmcnt(0)
    s_barrier
    v_mfma_f32_16x16x32_bf16 v[8:11], v[200:203], v[104:107], v[8:11]
    ds_read_b64_tr_b16 v[152:153], v241 offset:12288
    ds_read_b64_tr_b16 v[154:155], v241 offset:13824
    v_mfma_f32_16x16x32_bf16 v[56:59], v[204:207], v[104:107], v[56:59]
    ds_read_b64_tr_b16 v[156:157], v242 offset:12288
    ds_read_b64_tr_b16 v[158:159], v242 offset:13824
    v_mfma_f32_16x16x32_bf16 v[12:15], v[200:203], v[108:111], v[12:15]
    ds_read_b64_tr_b16 v[160:161], v243 offset:12288
    ds_read_b64_tr_b16 v[162:163], v243 offset:13824
    v_mfma_f32_16x16x32_bf16 v[60:63], v[204:207], v[108:111], v[60:63]
    ds_read_b64_tr_b16 v[164:165], v244 offset:12288
    ds_read_b64_tr_b16 v[166:167], v244 offset:13824
    v_mfma_f32_16x16x32_bf16 v[16:19], v[200:203], v[112:115], v[16:19]
    ds_read_b64_tr_b16 v[168:169], v241 offset:12416
    ds_read_b64_tr_b16 v[170:171], v241 offset:13952
    v_mfma_f32_16x16x32_bf16 v[64:67], v[204:207], v[112:115], v[64:67]
    ds_read_b64_tr_b16 v[172:173], v242 offset:12416
    ds_read_b64_tr_b16 v[174:175], v242 offset:13952
    v_mfma_f32_16x16x32_bf16 v[20:23], v[200:203], v[116:119], v[20:23]
    ds_read_b64_tr_b16 v[176:177], v243 offset:12416
    ds_read_b64_tr_b16 v[178:179], v243 offset:13952
    v_mfma_f32_16x16x32_bf16 v[68:71], v[204:207], v[116:119], v[68:71]
    ds_read_b64_tr_b16 v[180:181], v244 offset:12416
    ds_read_b64_tr_b16 v[182:183], v244 offset:13952
    v_mfma_f32_16x16x32_bf16 v[24:27], v[200:203], v[120:123], v[24:27]
    ds_read_b64_tr_b16 v[184:185], v241 offset:12544
    ds_read_b64_tr_b16 v[186:187], v241 offset:14080
    v_mfma_f32_16x16x32_bf16 v[72:75], v[204:207], v[120:123], v[72:75]
    ds_read_b64_tr_b16 v[188:189], v242 offset:12544
    ds_read_b64_tr_b16 v[190:191], v242 offset:14080
    v_mfma_f32_16x16x32_bf16 v[28:31], v[200:203], v[124:127], v[28:31]
    ds_read_b64_tr_b16 v[192:193], v243 offset:12544
    ds_read_b64_tr_b16 v[194:195], v243 offset:14080
    v_mfma_f32_16x16x32_bf16 v[76:79], v[204:207], v[124:127], v[76:79]
    ds_read_b64_tr_b16 v[196:197], v244 offset:12544
    ds_read_b64_tr_b16 v[198:199], v244 offset:14080
    v_mfma_f32_16x16x32_bf16 v[32:35], v[200:203], v[128:131], v[32:35]
    v_mfma_f32_16x16x32_bf16 v[80:83], v[204:207], v[128:131], v[80:83]
    v_mfma_f32_16x16x32_bf16 v[36:39], v[200:203], v[132:135], v[36:39]
    v_mfma_f32_16x16x32_bf16 v[84:87], v[204:207], v[132:135], v[84:87]
    v_mfma_f32_16x16x32_bf16 v[40:43], v[200:203], v[136:139], v[40:43]
    v_mfma_f32_16x16x32_bf16 v[88:91], v[204:207], v[136:139], v[88:91]
    v_mfma_f32_16x16x32_bf16 v[44:47], v[200:203], v[140:143], v[44:47]
    v_mfma_f32_16x16x32_bf16 v[92:95], v[204:207], v[140:143], v[92:95]
    v_mfma_f32_16x16x32_bf16 v[48:51], v[200:203], v[144:147], v[48:51]
    v_mfma_f32_16x16x32_bf16 v[96:99], v[204:207], v[144:147], v[96:99]
    v_mfma_f32_16x16x32_bf16 v[52:55], v[200:203], v[148:151], v[52:55]
    v_mfma_f32_16x16x32_bf16 v[100:103], v[204:207], v[148:151], v[100:103]
    s_waitcnt vmcnt(0) lgkmcnt(0)
    s_barrier
    v_mfma_f32_16x16x32_bf16 v[8:11], v[208:211], v[152:155], v[8:11]
    v_mfma_f32_16x16x32_bf16 v[56:59], v[212:215], v[152:155], v[56:59]
    v_mfma_f32_16x16x32_bf16 v[12:15], v[208:211], v[156:159], v[12:15]
    v_mfma_f32_16x16x32_bf16 v[60:63], v[212:215], v[156:159], v[60:63]
    v_mfma_f32_16x16x32_bf16 v[16:19], v[208:211], v[160:163], v[16:19]
    v_mfma_f32_16x16x32_bf16 v[64:67], v[212:215], v[160:163], v[64:67]
    v_mfma_f32_16x16x32_bf16 v[20:23], v[208:211], v[164:167], v[20:23]
    v_mfma_f32_16x16x32_bf16 v[68:71], v[212:215], v[164:167], v[68:71]
    v_mfma_f32_16x16x32_bf16 v[24:27], v[208:211], v[168:171], v[24:27]
    v_mfma_f32_16x16x32_bf16 v[72:75], v[212:215], v[168:171], v[72:75]
    v_mfma_f32_16x16x32_bf16 v[28:31], v[208:211], v[172:175], v[28:31]
    v_mfma_f32_16x16x32_bf16 v[76:79], v[212:215], v[172:175], v[76:79]
    v_mfma_f32_16x16x32_bf16 v[32:35], v[208:211], v[176:179], v[32:35]
    v_mfma_f32_16x16x32_bf16 v[80:83], v[212:215], v[176:179], v[80:83]
    v_mfma_f32_16x16x32_bf16 v[36:39], v[208:211], v[180:183], v[36:39]
    v_mfma_f32_16x16x32_bf16 v[84:87], v[212:215], v[180:183], v[84:87]
    v_mfma_f32_16x16x32_bf16 v[40:43], v[208:211], v[184:187], v[40:43]
    v_mfma_f32_16x16x32_bf16 v[88:91], v[212:215], v[184:187], v[88:91]
    v_mfma_f32_16x16x32_bf16 v[44:47], v[208:211], v[188:191], v[44:47]
    v_mfma_f32_16x16x32_bf16 v[92:95], v[212:215], v[188:191], v[92:95]
    v_mfma_f32_16x16x32_bf16 v[48:51], v[208:211], v[192:195], v[48:51]
    v_mfma_f32_16x16x32_bf16 v[96:99], v[212:215], v[192:195], v[96:99]
    v_mfma_f32_16x16x32_bf16 v[52:55], v[208:211], v[196:199], v[52:55]
    v_mfma_f32_16x16x32_bf16 v[100:103], v[212:215], v[196:199], v[100:103]
    v_and_b32 v2, 63, v0
    v_bfe_u32 v3, v2, 4, 1
    v_lshrrev_b32 v4, 5, v2
    v_lshl_add_u32 v3, v3, 1, v4
    s_lshl_b32 s4, s24, 2
    v_add_u32 v3, s4, v3
    v_mul_u32_u24 v3, 576, v3
    v_and_b32 v4, 15, v2
    v_add_u32 v3, v3, v4
    v_lshlrev_b32 v104, 4, v3
    s_mul_i32 s42, s40, 147456
    s_mul_i32 s43, s41, 3072
    s_add_u32 s42, s42, s43
    v_cvt_pk_bf16_f32 v108, v8, v9
    v_cvt_pk_bf16_f32 v109, v10, v11
    v_cvt_pk_bf16_f32 v110, v56, v57
    v_cvt_pk_bf16_f32 v111, v58, v59
    s_nop 1
    v_permlane16_swap_b32 v108, v110
    v_permlane16_swap_b32 v109, v111
    buffer_store_dwordx4 v[108:111], v104, s[16:19], s42 offen offset:0 sc1
    v_cvt_pk_bf16_f32 v112, v12, v13
    v_cvt_pk_bf16_f32 v113, v14, v15
    v_cvt_pk_bf16_f32 v114, v60, v61
    v_cvt_pk_bf16_f32 v115, v62, v63
    s_nop 1
    v_permlane16_swap_b32 v112, v114
    v_permlane16_swap_b32 v113, v115
    buffer_store_dwordx4 v[112:115], v104, s[16:19], s42 offen offset:256 sc1
    v_cvt_pk_bf16_f32 v108, v16, v17
    v_cvt_pk_bf16_f32 v109, v18, v19
    v_cvt_pk_bf16_f32 v110, v64, v65
    v_cvt_pk_bf16_f32 v111, v66, v67
    s_nop 1
    v_permlane16_swap_b32 v108, v110
    v_permlane16_swap_b32 v109, v111
    buffer_store_dwordx4 v[108:111], v104, s[16:19], s42 offen offset:512 sc1
    v_cvt_pk_bf16_f32 v112, v20, v21
    v_cvt_pk_bf16_f32 v113, v22, v23
    v_cvt_pk_bf16_f32 v114, v68, v69
    v_cvt_pk_bf16_f32 v115, v70, v71
    s_nop 1
    v_permlane16_swap_b32 v112, v114
    v_permlane16_swap_b32 v113, v115
    buffer_store_dwordx4 v[112:115], v104, s[16:19], s42 offen offset:768 sc1
    v_cvt_pk_bf16_f32 v108, v24, v25
    v_cvt_pk_bf16_f32 v109, v26, v27
    v_cvt_pk_bf16_f32 v110, v72, v73
    v_cvt_pk_bf16_f32 v111, v74, v75
    s_nop 1
    v_permlane16_swap_b32 v108, v110
    v_permlane16_swap_b32 v109, v111
    buffer_store_dwordx4 v[108:111], v104, s[16:19], s42 offen offset:1024 sc1
    v_cvt_pk_bf16_f32 v112, v28, v29
    v_cvt_pk_bf16_f32 v113, v30, v31
    v_cvt_pk_bf16_f32 v114, v76, v77
    v_cvt_pk_bf16_f32 v115, v78, v79
    s_nop 1
    v_permlane16_swap_b32 v112, v114
    v_permlane16_swap_b32 v113, v115
    buffer_store_dwordx4 v[112:115], v104, s[16:19], s42 offen offset:1280 sc1
    v_cvt_pk_bf16_f32 v108, v32, v33
    v_cvt_pk_bf16_f32 v109, v34, v35
    v_cvt_pk_bf16_f32 v110, v80, v81
    v_cvt_pk_bf16_f32 v111, v82, v83
    s_nop 1
    v_permlane16_swap_b32 v108, v110
    v_permlane16_swap_b32 v109, v111
    buffer_store_dwordx4 v[108:111], v104, s[16:19], s42 offen offset:1536 sc1
    v_cvt_pk_bf16_f32 v112, v36, v37
    v_cvt_pk_bf16_f32 v113, v38, v39
    v_cvt_pk_bf16_f32 v114, v84, v85
    v_cvt_pk_bf16_f32 v115, v86, v87
    s_nop 1
    v_permlane16_swap_b32 v112, v114
    v_permlane16_swap_b32 v113, v115
    buffer_store_dwordx4 v[112:115], v104, s[16:19], s42 offen offset:1792 sc1
    v_cvt_pk_bf16_f32 v108, v40, v41
    v_cvt_pk_bf16_f32 v109, v42, v43
    v_cvt_pk_bf16_f32 v110, v88, v89
    v_cvt_pk_bf16_f32 v111, v90, v91
    s_nop 1
    v_permlane16_swap_b32 v108, v110
    v_permlane16_swap_b32 v109, v111
    buffer_store_dwordx4 v[108:111], v104, s[16:19], s42 offen offset:2048 sc1
    v_cvt_pk_bf16_f32 v112, v44, v45
    v_cvt_pk_bf16_f32 v113, v46, v47
    v_cvt_pk_bf16_f32 v114, v92, v93
    v_cvt_pk_bf16_f32 v115, v94, v95
    s_nop 1
    v_permlane16_swap_b32 v112, v114
    v_permlane16_swap_b32 v113, v115
    buffer_store_dwordx4 v[112:115], v104, s[16:19], s42 offen offset:2304 sc1
    v_cvt_pk_bf16_f32 v108, v48, v49
    v_cvt_pk_bf16_f32 v109, v50, v51
    v_cvt_pk_bf16_f32 v110, v96, v97
    v_cvt_pk_bf16_f32 v111, v98, v99
    s_nop 1
    v_permlane16_swap_b32 v108, v110
    v_permlane16_swap_b32 v109, v111
    buffer_store_dwordx4 v[108:111], v104, s[16:19], s42 offen offset:2560 sc1
    v_cvt_pk_bf16_f32 v112, v52, v53
    v_cvt_pk_bf16_f32 v113, v54, v55
    v_cvt_pk_bf16_f32 v114, v100, v101
    v_cvt_pk_bf16_f32 v115, v102, v103
    s_nop 1
    v_permlane16_swap_b32 v112, v114
    v_permlane16_swap_b32 v113, v115
    buffer_store_dwordx4 v[112:115], v104, s[16:19], s42 offen offset:2816 sc1
    s_lshl_b32 s49, s41, 4
    s_add_u32 s49, s49, s40
    s_add_u32 s56, s84, 39845888
    s_addc_u32 s57, s85, 0
    s_and_b32 s57, s57, 0xffff
    s_mov_b32 s58, 16384
    s_mov_b32 s59, 0x20000
    s_cmp_lg_u32 s24, 0
    s_cbranch_scc1 Lrdyok_16
    s_mov_b32 s20, s32
    s_mov_b32 s21, s33
    s_and_b32 s21, s21, 0xffff
    s_mov_b32 s22, 256
    s_mov_b32 s23, 0x20000
    s_mov_b32 s5, 0
Lrdy_15:
    buffer_load_dword v2, off, s[20:23], 0 sc1
    s_waitcnt vmcnt(0)
    v_readfirstlane_b32 s6, v2
    s_add_u32 s5, s5, 1
    s_nop 2
    s_cmp_lg_u32 s6, 0
    s_cbranch_scc1 Lrdyok_16
    s_sleep 8
    s_cmp_lt_u32 s5, 0x20000
    s_cbranch_scc1 Lrdy_15
Lrdyok_16:
    s_waitcnt vmcnt(0)
    s_barrier
    s_cmp_lg_u32 s24, 0
    s_cbranch_scc1 Lpub_17
    s_lshl_b32 s4, s49, 2
    s_add_u32 s4, s4, 13824
    v_mov_b32 v2, 1
    buffer_store_dword v2, off, s[56:59], s4 sc1
Lpub_17:
    s_branch LG_5
Laux_4:
    s_sub_u32 s31, s2, 240
    s_load_dwordx2 s[80:81], s[0:1], 0
    s_load_dwordx2 s[82:83], s[0:1], 64
    s_load_dwordx2 s[84:85], s[0:1], 88
    s_lshl_b32 s45, s31, 2
    s_add_u32 s45, s45, s24
    s_waitcnt lgkmcnt(0)
    s_cmp_lg_u32 s31, 0
    s_cbranch_scc1 Lnozero_18
    s_add_u32 s12, s84, 39845888
    s_addc_u32 s13, s85, 0
    s_and_b32 s13, s13, 0xffff
    s_mov_b32 s14, 16384
    s_mov_b32 s15, 0x20000
    v_lshlrev_b32 v2, 4, v0
    v_mov_b32 v4, 0
    v_mov_b32 v5, 0
    v_mov_b32 v6, 0
    v_mov_b32 v7, 0
    s_mov_b32 s4, 0
    buffer_store_dwordx4 v[4:7], v2, s[12:15], s4 offen sc1
    s_mov_b32 s4, 4096
    buffer_store_dwordx4 v[4:7], v2, s[12:15], s4 offen sc1
    s_mov_b32 s4, 8192
    buffer_store_dwordx4 v[4:7], v2, s[12:15], s4 offen sc1
    s_mov_b32 s4, 12288
    buffer_store_dwordx4 v[4:7], v2, s[12:15], s4 offen sc1
    s_add_u32 s12, s84, 26148864
    s_addc_u32 s13, s85, 0
    s_and_b32 s13, s13, 0xffff
    s_mov_b32 s14, 64
    s_mov_b32 s15, 0x20000
    v_mov_b32 v8, 0x3f803f80
    v_lshlrev_b32 v9, 2, v0
    buffer_store_dword v8, v9, s[12:15], 0 offen sc1
    s_waitcnt vmcnt(0)
    s_barrier
    s_cmp_lg_u32 s24, 0
    s_cbranch_scc1 Lrdyset_19
    s_mov_b32 s12, s32
    s_mov_b32 s13, s33
    s_and_b32 s13, s13, 0xffff
    s_mov_b32 s14, 256
    s_mov_b32 s15, 0x20000
    v_mov_b32 v2, 1
    buffer_store_dword v2, off, s[12:15], 0 sc1
Lrdyset_19:
Lnozero_18:
    s_mov_b32 s44, s45
Lgate_20:
    v_and_b32 v2, 63, v0
    v_lshrrev_b32 v3, 3, v2
    s_mov_b32 s12, s80
    s_mov_b32 s13, s81
    s_and_b32 s13, s13, 0xffff
    s_mov_b32 s14, 2359296
    s_mov_b32 s15, 0x20000
    s_mov_b32 s20, s82
    s_mov_b32 s21, s83
    s_and_b32 s21, s21, 0xffff
    s_mov_b32 s22, 1152
    s_mov_b32 s23, 0x20000
    v_and_b32 v4, 7, v2
    v_lshlrev_b32 v4, 4, v4
    v_mul_u32_u24 v5, 1152, v3
    v_add_u32 v5, v5, v4
    s_mul_i32 s42, s44, 9216
    buffer_load_dwordx4 v[16:19], v5, s[12:15], s42 offen offset:0
    buffer_load_dwordx4 v[52:55], v4, s[20:23], 0 offen offset:0
    buffer_load_dwordx4 v[20:23], v5, s[12:15], s42 offen offset:128
    buffer_load_dwordx4 v[56:59], v4, s[20:23], 0 offen offset:128
    buffer_load_dwordx4 v[24:27], v5, s[12:15], s42 offen offset:256
    buffer_load_dwordx4 v[60:63], v4, s[20:23], 0 offen offset:256
    buffer_load_dwordx4 v[28:31], v5, s[12:15], s42 offen offset:384
    buffer_load_dwordx4 v[64:67], v4, s[20:23], 0 offen offset:384
    buffer_load_dwordx4 v[32:35], v5, s[12:15], s42 offen offset:512
    buffer_load_dwordx4 v[68:71], v4, s[20:23], 0 offen offset:512
    buffer_load_dwordx4 v[36:39], v5, s[12:15], s42 offen offset:640
    buffer_load_dwordx4 v[72:75], v4, s[20:23], 0 offen offset:640
    buffer_load_dwordx4 v[40:43], v5, s[12:15], s42 offen offset:768
    buffer_load_dwordx4 v[76:79], v4, s[20:23], 0 offen offset:768
    buffer_load_dwordx4 v[44:47], v5, s[12:15], s42 offen offset:896
    buffer_load_dwordx4 v[80:83], v4, s[20:23], 0 offen offset:896
    buffer_load_dwordx4 v[48:51], v5, s[12:15], s42 offen offset:1024
    buffer_load_dwordx4 v[84:87], v4, s[20:23], 0 offen offset:1024
    s_waitcnt vmcnt(0)
    v_mov_b32 v6, 0
    v_mov_b32 v11, 0
    s_nop 1
    v_dot2_f32_bf16 v11, v16, v52, v11
    v_dot2_f32_bf16 v6, v17, v53, v6
    v_dot2_f32_bf16 v11, v18, v54, v11
    v_dot2_f32_bf16 v6, v19, v55, v6
    v_dot2_f32_bf16 v11, v20, v56, v11
    v_dot2_f32_bf16 v6, v21, v57, v6
    v_dot2_f32_bf16 v11, v22, v58, v11
    v_dot2_f32_bf16 v6, v23, v59, v6
    v_dot2_f32_bf16 v11, v24, v60, v11
    v_dot2_f32_bf16 v6, v25, v61, v6
    v_dot2_f32_bf16 v11, v26, v62, v11
    v_dot2_f32_bf16 v6, v27, v63, v6
    v_dot2_f32_bf16 v11, v28, v64, v11
    v_dot2_f32_bf16 v6, v29, v65, v6
    v_dot2_f32_bf16 v11, v30, v66, v11
    v_dot2_f32_bf16 v6, v31, v67, v6
    v_dot2_f32_bf16 v11, v32, v68, v11
    v_dot2_f32_bf16 v6, v33, v69, v6
    v_dot2_f32_bf16 v11, v34, v70, v11
    v_dot2_f32_bf16 v6, v35, v71, v6
    v_dot2_f32_bf16 v11, v36, v72, v11
    v_dot2_f32_bf16 v6, v37, v73, v6
    v_dot2_f32_bf16 v11, v38, v74, v11
    v_dot2_f32_bf16 v6, v39, v75, v6
    v_dot2_f32_bf16 v11, v40, v76, v11
    v_dot2_f32_bf16 v6, v41, v77, v6
    v_dot2_f32_bf16 v11, v42, v78, v11
    v_dot2_f32_bf16 v6, v43, v79, v6
    v_dot2_f32_bf16 v11, v44, v80, v11
    v_dot2_f32_bf16 v6, v45, v81, v6
    v_dot2_f32_bf16 v11, v46, v82, v11
    v_dot2_f32_bf16 v6, v47, v83, v6
    v_dot2_f32_bf16 v11, v48, v84, v11
    v_dot2_f32_bf16 v6, v49, v85, v6
    v_dot2_f32_bf16 v11, v50, v86, v11
    v_dot2_f32_bf16 v6, v51, v87, v6
    s_nop 3
    v_add_f32 v6, v6, v11
    s_nop 1
    v_add_f32_dpp v6, v6, v6 quad_perm:[1,0,3,2] row_mask:0xf bank_mask:0xf
    s_nop 1
    v_add_f32_dpp v6, v6, v6 quad_perm:[2,3,0,1] row_mask:0xf bank_mask:0xf
    s_nop 1
    v_add_f32_dpp v6, v6, v6 row_half_mirror row_mask:0xf bank_mask:0xf
    s_nop 0
    v_mul_f32 v6, 0xbfb8aa3b, v6
    v_exp_f32 v6, v6
    s_nop 0
    v_add_f32 v6, 1.0, v6
    v_rcp_f32 v6, v6
    s_add_u32 s12, s84, 38797312
    s_addc_u32 s13, s85, 0
    s_and_b32 s13, s13, 0xffff
    s_mov_b32 s14, 8192
    s_mov_b32 s15, 0x20000
    v_lshlrev_b32 v5, 2, v3
    s_lshl_b32 s42, s44, 5
    buffer_store_dword v6, v5, s[12:15], s42 offen sc1
    s_add_u32 s44, s44, 64
    s_cmp_lt_u32 s44, 256
    s_cbranch_scc1 Lgate_20
    s_add_u32 s56, s84, 39845888
    s_addc_u32 s57, s85, 0
    s_and_b32 s57, s57, 0xffff
    s_mov_b32 s58, 16384
    s_mov_b32 s59, 0x20000
    s_cmp_lg_u32 s24, 0
    s_cbranch_scc1 Lrdyok_22
    s_mov_b32 s20, s32
    s_mov_b32 s21, s33
    s_and_b32 s21, s21, 0xffff
    s_mov_b32 s22, 256
    s_mov_b32 s23, 0x20000
    s_mov_b32 s5, 0
Lrdy_21:
    buffer_load_dword v2, off, s[20:23], 0 sc1
    s_waitcnt vmcnt(0)
    v_readfirstlane_b32 s6, v2
    s_add_u32 s5, s5, 1
    s_nop 2
    s_cmp_lg_u32 s6, 0
    s_cbranch_scc1 Lrdyok_22
    s_sleep 8
    s_cmp_lt_u32 s5, 0x20000
    s_cbranch_scc1 Lrdy_21
Lrdyok_22:
    s_waitcnt vmcnt(0)
    s_barrier
    s_cmp_lg_u32 s24, 0
    s_cbranch_scc1 Lpub_23
    s_lshl_b32 s4, s31, 2
    s_add_u32 s4, s4, 14336
    v_mov_b32 v2, 1
    buffer_store_dword v2, off, s[56:59], s4 sc1
Lpub_23:
LG_5:
    s_load_dwordx2 s[80:81], s[0:1], 0
    s_load_dwordx2 s[82:83], s[0:1], 32
    s_load_dwordx2 s[84:85], s[0:1], 88
    s_load_dwordx2 s[86:87], s[0:1], 40
    s_load_dwordx2 s[88:89], s[0:1], 48
    s_load_dwordx2 s[90:91], s[0:1], 16
    s_load_dwordx2 s[92:93], s[0:1], 56
    s_load_dwordx2 s[94:95], s[0:1], 72
    s_mov_b32 s31, s2
    s_waitcnt lgkmcnt(0)
    s_setprio 2
    s_and_b32 s4, s31, 7
    s_lshr_b32 s5, s31, 3
    s_lshr_b32 s6, s4, 2
    s_lshl_b32 s6, s6, 3
    s_and_b32 s7, s5, 7
    s_add_u32 s46, s6, s7
    s_and_b32 s6, s4, 3
    s_lshl_b32 s6, s6, 2
    s_lshr_b32 s7, s5, 3
    s_add_u32 s47, s6, s7
    s_mov_b32 s8, s80
    s_mov_b32 s9, s81
    s_and_b32 s9, s9, 0xffff
    s_mov_b32 s10, 2359296
    s_mov_b32 s11, 0x20000
    s_mov_b32 s12, s82
    s_mov_b32 s13, s83
    s_and_b32 s13, s13, 0xffff
    s_mov_b32 s14, 5308416
    s_mov_b32 s15, 0x20000
    v_and_b32 v2, 63, v0
    v_lshrrev_b32 v3, 3, v2
    s_lshl_b32 s4, s24, 5
    v_add_u32 v3, s4, v3
    s_mov_b32 s5, 1152
    v_mul_lo_u32 v3, v3, s5
    v_lshrrev_b32 v4, 4, v2
    v_and_b32 v5, 7, v2
    v_xor_b32 v6, v5, v4
    v_lshlrev_b32 v6, 4, v6
    v_add_u32 v184, v3, v6
    v_xor_b32 v6, 64, v6
    v_add_u32 v185, v3, v6
    v_add_u32 v186, 16384, v184
    v_add_u32 v185, 8192, v185
    v_add_u32 v187, 16384, v185
    v_and_b32 v3, 15, v2
    v_lshrrev_b32 v5, 1, v3
    v_xor_b32 v5, v5, v4
    v_lshlrev_b32 v5, 4, v5
    v_lshlrev_b32 v3, 7, v3
    v_add_u32 v3, v3, v5
    s_lshl_b32 s4, s24, 13
    s_add_u32 s27, s4, 36864
    v_add_u32 v191, s27, v3
    v_xor_b32 v192, 64, v191
    v_and_b32 v2, 63, v0
    s_mul_i32 s28, s24, 2304
    s_lshl_b32 s4, s24, 3
    s_mov_b32 s5, 9216
    v_add_u32 v3, 0, v2
    v_mul_u32_u24 v4, 3641, v3
    v_lshrrev_b32 v4, 16, v4
    v_mul_u32_u24 v5, 18, v4
    v_sub_u32 v5, v3, v5
    v_add_u32 v4, s4, v4
    v_and_b32 v3, 4, v4
    v_lshlrev_b32 v3, 1, v3
    v_and_b32 v6, 8, v4
    v_lshrrev_b32 v6, 1, v6
    v_and_b32 v4, 0x33, v4
    v_or3_b32 v4, v4, v3, v6
    v_mul_lo_u32 v4, v4, s5
    v_lshl_add_u32 v4, v5, 4, v4
    v_mov_b32 v188, v4
    v_add_u32 v3, 64, v2
    v_mul_u32_u24 v4, 3641, v3
    v_lshrrev_b32 v4, 16, v4
    v_mul_u32_u24 v5, 18, v4
    v_sub_u32 v5, v3, v5
    v_add_u32 v4, s4, v4
    v_and_b32 v3, 4, v4
    v_lshlrev_b32 v3, 1, v3
    v_and_b32 v6, 8, v4
    v_lshrrev_b32 v6, 1, v6
    v_and_b32 v4, 0x33, v4
    v_or3_b32 v4, v4, v3, v6
    v_mul_lo_u32 v4, v4, s5
    v_lshl_add_u32 v4, v5, 4, v4
    v_subrev_u32 v189, 1024, v4
    v_lshrrev_b32 v3, 2, v2
    v_add_u32 v3, 128, v3
    v_mul_u32_u24 v4, 3641, v3
    v_lshrrev_b32 v4, 16, v4
    v_mul_u32_u24 v5, 18, v4
    v_sub_u32 v5, v3, v5
    v_add_u32 v4, s4, v4
    v_and_b32 v3, 4, v4
    v_lshlrev_b32 v3, 1, v3
    v_and_b32 v6, 8, v4
    v_lshrrev_b32 v6, 1, v6
    v_and_b32 v4, 0x33, v4
    v_or3_b32 v4, v4, v3, v6
    v_mul_lo_u32 v4, v4, s5
    v_lshl_add_u32 v4, v5, 4, v4
    v_and_b32 v5, 3, v2
    v_lshl_add_u32 v4, v5, 2, v4
    v_subrev_u32 v190, 2048, v4
    v_lshrrev_b32 v3, 5, v2
    v_lshlrev_b32 v3, 4, v3
    v_bfe_u32 v4, v2, 4, 1
    v_lshl_add_u32 v3, v4, 2, v3
    v_bfe_u32 v4, v2, 2, 2
    v_add_u32 v3, v3, v4
    v_mul_u32_u24 v3, 288, v3
    v_and_b32 v4, 3, v2
    v_lshl_add_u32 v193, v4, 3, v3
    s_mul_i32 s25, s46, 147456
    s_mul_i32 s26, s47, 288
    s_add_u32 m0, s28, 0
    s_nop 0
    buffer_load_dwordx4 v188, s[12:15], s26 offen lds
    buffer_load_dwordx4 v189, s[12:15], s26 offen offset:1024 lds
    buffer_load_dword v190, s[12:15], s26 offen offset:2048 lds
    s_add_u32 s26, s26, 294912
    s_add_u32 m0, s27, 0
    s_nop 0
    buffer_load_dwordx4 v184, s[8:11], s25 offen lds
    buffer_load_dwordx4 v185, s[8:11], s25 offen offset:1024 lds
    buffer_load_dwordx4 v186, s[8:11], s25 offen offset:2048 lds
    buffer_load_dwordx4 v187, s[8:11], s25 offen offset:3072 lds
    s_add_u32 s25, s25, 128
    s_add_u32 m0, s28, 9216
    s_nop 0
    buffer_load_dwordx4 v188, s[12:15], s26 offen lds
    buffer_load_dwordx4 v189, s[12:15], s26 offen offset:1024 lds
    buffer_load_dword v190, s[12:15], s26 offen offset:2048 lds
    s_add_u32 s26, s26, 294912
    s_add_u32 m0, s28, 18432
    s_nop 0
    buffer_load_dwordx4 v188, s[12:15], s26 offen lds
    buffer_load_dwordx4 v189, s[12:15], s26 offen offset:1024 lds
    buffer_load_dword v190, s[12:15], s26 offen offset:2048 lds
    s_add_u32 s26, s26, 294912
    s_add_u32 m0, s27, 4096
    s_nop 0
    buffer_load_dwordx4 v184, s[8:11], s25 offen lds
    buffer_load_dwordx4 v185, s[8:11], s25 offen offset:1024 lds
    buffer_load_dwordx4 v186, s[8:11], s25 offen offset:2048 lds
    buffer_load_dwordx4 v187, s[8:11], s25 offen offset:3072 lds
    s_add_u32 s25, s25, 128
    s_add_u32 m0, s28, 27648
    s_nop 0
    buffer_load_dwordx4 v188, s[12:15], s26 offen lds
    buffer_load_dwordx4 v189, s[12:15], s26 offen offset:1024 lds
    buffer_load_dword v190, s[12:15], s26 offen offset:2048 lds
    s_add_u32 s26, s26, 294912
    v_mov_b32 v8, 0
    v_mov_b32 v9, 0
    v_mov_b32 v10, 0
    v_mov_b32 v11, 0
    v_mov_b32 v12, 0
    v_mov_b32 v13, 0
    v_mov_b32 v14, 0
    v_mov_b32 v15, 0
    v_mov_b32 v16, 0
    v_mov_b32 v17, 0
    v_mov_b32 v18, 0
    v_mov_b32 v19, 0
    v_mov_b32 v20, 0
    v_mov_b32 v21, 0
    v_mov_b32 v22, 0
    v_mov_b32 v23, 0
    v_mov_b32 v24, 0
    v_mov_b32 v25, 0
    v_mov_b32 v26, 0
    v_mov_b32 v27, 0
    v_mov_b32 v28, 0
    v_mov_b32 v29, 0
    v_mov_b32 v30, 0
    v_mov_b32 v31, 0
    v_mov_b32 v32, 0
    v_mov_b32 v33, 0
    v_mov_b32 v34, 0
    v_mov_b32 v35, 0
    v_mov_b32 v36, 0
    v_mov_b32 v37, 0
    v_mov_b32 v38, 0
    v_mov_b32 v39, 0
    v_mov_b32 v40, 0
    v_mov_b32 v41, 0
    v_mov_b32 v42, 0
    v_mov_b32 v43, 0
    v_mov_b32 v44, 0
    v_mov_b32 v45, 0
    v_mov_b32 v46, 0
    v_mov_b32 v47, 0
    v_mov_b32 v48, 0
    v_mov_b32 v49, 0
    v_mov_b32 v50, 0
    v_mov_b32 v51, 0
    v_mov_b32 v52, 0
    v_mov_b32 v53, 0
    v_mov_b32 v54, 0
    v_mov_b32 v55, 0
    v_mov_b32 v56, 0
    v_mov_b32 v57, 0
    v_mov_b32 v58, 0
    v_mov_b32 v59, 0
    v_mov_b32 v60, 0
    v_mov_b32 v61, 0
    v_mov_b32 v62, 0
    v_mov_b32 v63, 0
    v_mov_b32 v64, 0
    v_mov_b32 v65, 0
    v_mov_b32 v66, 0
    v_mov_b32 v67, 0
    v_mov_b32 v68, 0
    v_mov_b32 v69, 0
    v_mov_b32 v70, 0
    v_mov_b32 v71, 0
    v_mov_b32 v72, 0
    v_mov_b32 v73, 0
    v_mov_b32 v74, 0
    v_mov_b32 v75, 0
    v_mov_b32 v76, 0
    v_mov_b32 v77, 0
    v_mov_b32 v78, 0
    v_mov_b32 v79, 0
    s_waitcnt vmcnt(13)
    s_barrier
    ds_read_b128 v[152:155], v191 offset:0
    ds_read_b128 v[156:159], v191 offset:2048
    ds_read_b128 v[160:163], v192 offset:0
    ds_read_b128 v[164:167], v192 offset:2048
    ds_read_b64_tr_b16 v[80:81], v193 offset:0
    ds_read_b64_tr_b16 v[82:83], v193 offset:2304
    ds_read_b64_tr_b16 v[84:85], v193 offset:32
    ds_read_b64_tr_b16 v[86:87], v193 offset:2336
    ds_read_b64_tr_b16 v[88:89], v193 offset:64
    ds_read_b64_tr_b16 v[90:91], v193 offset:2368
    ds_read_b64_tr_b16 v[92:93], v193 offset:96
    ds_read_b64_tr_b16 v[94:95], v193 offset:2400
    ds_read_b64_tr_b16 v[96:97], v193 offset:128
    ds_read_b64_tr_b16 v[98:99], v193 offset:2432
    ds_read_b64_tr_b16 v[100:101], v193 offset:160
    ds_read_b64_tr_b16 v[102:103], v193 offset:2464
    ds_read_b64_tr_b16 v[104:105], v193 offset:192
    ds_read_b64_tr_b16 v[106:107], v193 offset:2496
    ds_read_b64_tr_b16 v[108:109], v193 offset:224
    ds_read_b64_tr_b16 v[110:111], v193 offset:2528
    ds_read_b64_tr_b16 v[112:113], v193 offset:256
    ds_read_b64_tr_b16 v[114:115], v193 offset:2560
    s_mov_b32 s30, 3
Lk_24:
    s_waitcnt vmcnt(10) lgkmcnt(0)
    s_barrier
    v_mfma_f32_16x16x32_bf16 v[8:11], v[80:83], v[152:155], v[8:11]
    ds_read_b64_tr_b16 v[116:117], v193 offset:9216
    s_add_u32 m0, s28, 0
    v_mfma_f32_16x16x32_bf16 v[44:47], v[80:83], v[156:159], v[44:47]
    buffer_load_dwordx4 v188, s[12:15], s26 offen lds
    ds_read_b64_tr_b16 v[118:119], v193 offset:11520
    v_mfma_f32_16x16x32_bf16 v[12:15], v[84:87], v[152:155], v[12:15]
    ds_read_b64_tr_b16 v[120:121], v193 offset:9248
    ds_read_b64_tr_b16 v[122:123], v193 offset:11552
    v_mfma_f32_16x16x32_bf16 v[48:51], v[84:87], v[156:159], v[48:51]
    buffer_load_dwordx4 v189, s[12:15], s26 offen offset:1024 lds
    ds_read_b64_tr_b16 v[124:125], v193 offset:9280
    v_mfma_f32_16x16x32_bf16 v[16:19], v[88:91], v[152:155], v[16:19]
    ds_read_b64_tr_b16 v[126:127], v193 offset:11584
    ds_read_b64_tr_b16 v[128:129], v193 offset:9312
    v_mfma_f32_16x16x32_bf16 v[52:55], v[88:91], v[156:159], v[52:55]
    buffer_load_dword v190, s[12:15], s26 offen offset:2048 lds
    s_add_u32 s26, s26, 294912
    v_mfma_f32_16x16x32_bf16 v[20:23], v[92:95], v[152:155], v[20:23]
    ds_read_b64_tr_b16 v[130:131], v193 offset:11616
    ds_read_b64_tr_b16 v[132:133], v193 offset:9344
    v_mfma_f32_16x16x32_bf16 v[56:59], v[92:95], v[156:159], v[56:59]
    ds_read_b64_tr_b16 v[134:135], v193 offset:11648
    s_add_u32 m0, s27, 0
    v_mfma_f32_16x16x32_bf16 v[24:27], v[96:99], v[152:155], v[24:27]
    buffer_load_dwordx4 v184, s[8:11], s25 offen lds
    ds_read_b64_tr_b16 v[136:137], v193 offset:9376
    v_mfma_f32_16x16x32_bf16 v[60:63], v[96:99], v[156:159], v[60:63]
    ds_read_b64_tr_b16 v[138:139], v193 offset:11680
    ds_read_b64_tr_b16 v[140:141], v193 offset:9408
    v_mfma_f32_16x16x32_bf16 v[28:31], v[100:103], v[152:155], v[28:31]
    buffer_load_dwordx4 v185, s[8:11], s25 offen offset:1024 lds
    ds_read_b64_tr_b16 v[142:143], v193 offset:11712
    v_mfma_f32_16x16x32_bf16 v[64:67], v[100:103], v[156:159], v[64:67]
    ds_read_b64_tr_b16 v[144:145], v193 offset:9440
    ds_read_b64_tr_b16 v[146:147], v193 offset:11744
    v_mfma_f32_16x16x32_bf16 v[32:35], v[104:107], v[152:155], v[32:35]
    ds_read_b64_tr_b16 v[148:149], v193 offset:9472
    ds_read_b64_tr_b16 v[150:151], v193 offset:11776
    v_mfma_f32_16x16x32_bf16 v[68:71], v[104:107], v[156:159], v[68:71]
    buffer_load_dwordx4 v186, s[8:11], s25 offen offset:2048 lds
    v_mfma_f32_16x16x32_bf16 v[36:39], v[108:111], v[152:155], v[36:39]
    v_mfma_f32_16x16x32_bf16 v[72:75], v[108:111], v[156:159], v[72:75]
    buffer_load_dwordx4 v187, s[8:11], s25 offen offset:3072 lds
    s_add_u32 s25, s25, 128
    v_mfma_f32_16x16x32_bf16 v[40:43], v[112:115], v[152:155], v[40:43]
    v_mfma_f32_16x16x32_bf16 v[76:79], v[112:115], v[156:159], v[76:79]
    s_waitcnt vmcnt(10) lgkmcnt(0)
    s_barrier
    v_mfma_f32_16x16x32_bf16 v[8:11], v[116:119], v[160:163], v[8:11]
    ds_read_b128 v[168:171], v191 offset:4096
    s_add_u32 m0, s28, 9216
    v_mfma_f32_16x16x32_bf16 v[44:47], v[116:119], v[164:167], v[44:47]
    buffer_load_dwordx4 v188, s[12:15], s26 offen lds
    ds_read_b128 v[172:175], v191 offset:6144
    v_mfma_f32_16x16x32_bf16 v[12:15], v[120:123], v[160:163], v[12:15]
    ds_read_b128 v[176:179], v192 offset:4096
    ds_read_b128 v[180:183], v192 offset:6144
    v_mfma_f32_16x16x32_bf16 v[48:51], v[120:123], v[164:167], v[48:51]
    ds_read_b64_tr_b16 v[80:81], v193 offset:18432
    ds_read_b64_tr_b16 v[82:83], v193 offset:20736
    v_mfma_f32_16x16x32_bf16 v[16:19], v[124:127], v[160:163], v[16:19]
    ds_read_b64_tr_b16 v[84:85], v193 offset:18464
    ds_read_b64_tr_b16 v[86:87], v193 offset:20768
    v_mfma_f32_16x16x32_bf16 v[52:55], v[124:127], v[164:167], v[52:55]
    ds_read_b64_tr_b16 v[88:89], v193 offset:18496
    ds_read_b64_tr_b16 v[90:91], v193 offset:20800
    v_mfma_f32_16x16x32_bf16 v[20:23], v[128:131], v[160:163], v[20:23]
    buffer_load_dwordx4 v189, s[12:15], s26 offen offset:1024 lds
    ds_read_b64_tr_b16 v[92:93], v193 offset:18528
    v_mfma_f32_16x16x32_bf16 v[56:59], v[128:131], v[164:167], v[56:59]
    ds_read_b64_tr_b16 v[94:95], v193 offset:20832
    ds_read_b64_tr_b16 v[96:97], v193 offset:18560
    v_mfma_f32_16x16x32_bf16 v[24:27], v[132:135], v[160:163], v[24:27]
    ds_read_b64_tr_b16 v[98:99], v193 offset:20864
    ds_read_b64_tr_b16 v[100:101], v193 offset:18592
    v_mfma_f32_16x16x32_bf16 v[60:63], v[132:135], v[164:167], v[60:63]
    ds_read_b64_tr_b16 v[102:103], v193 offset:20896
    ds_read_b64_tr_b16 v[104:105], v193 offset:18624
    v_mfma_f32_16x16x32_bf16 v[28:31], v[136:139], v[160:163], v[28:31]
    ds_read_b64_tr_b16 v[106:107], v193 offset:20928
    ds_read_b64_tr_b16 v[108:109], v193 offset:18656
    v_mfma_f32_16x16x32_bf16 v[64:67], v[136:139], v[164:167], v[64:67]
    ds_read_b64_tr_b16 v[110:111], v193 offset:20960
    ds_read_b64_tr_b16 v[112:113], v193 offset:18688
    v_mfma_f32_16x16x32_bf16 v[32:35], v[140:143], v[160:163], v[32:35]
    buffer_load_dword v190, s[12:15], s26 offen offset:2048 lds
    s_add_u32 s26, s26, 294912
    v_mfma_f32_16x16x32_bf16 v[68:71], v[140:143], v[164:167], v[68:71]
    ds_read_b64_tr_b16 v[114:115], v193 offset:20992
    v_mfma_f32_16x16x32_bf16 v[36:39], v[144:147], v[160:163], v[36:39]
    v_mfma_f32_16x16x32_bf16 v[72:75], v[144:147], v[164:167], v[72:75]
    v_mfma_f32_16x16x32_bf16 v[40:43], v[148:151], v[160:163], v[40:43]
    v_mfma_f32_16x16x32_bf16 v[76:79], v[148:151], v[164:167], v[76:79]
    s_waitcnt vmcnt(10) lgkmcnt(0)
    s_barrier
    v_mfma_f32_16x16x32_bf16 v[8:11], v[80:83], v[168:171], v[8:11]
    ds_read_b64_tr_b16 v[116:117], v193 offset:27648
    s_add_u32 m0, s28, 18432
    v_mfma_f32_16x16x32_bf16 v[44:47], v[80:83], v[172:175], v[44:47]
    buffer_load_dwordx4 v188, s[12:15], s26 offen lds
    ds_read_b64_tr_b16 v[118:119], v193 offset:29952
    v_mfma_f32_16x16x32_bf16 v[12:15], v[84:87], v[168:171], v[12:15]
    ds_read_b64_tr_b16 v[120:121], v193 offset:27680
    ds_read_b64_tr_b16 v[122:123], v193 offset:29984
    v_mfma_f32_16x16x32_bf16 v[48:51], v[84:87], v[172:175], v[48:51]
    buffer_load_dwordx4 v189, s[12:15], s26 offen offset:1024 lds
    ds_read_b64_tr_b16 v[124:125], v193 offset:27712
    v_mfma_f32_16x16x32_bf16 v[16:19], v[88:91], v[168:171], v[16:19]
    ds_read_b64_tr_b16 v[126:127], v193 offset:30016
    ds_read_b64_tr_b16 v[128:129], v193 offset:27744
    v_mfma_f32_16x16x32_bf16 v[52:55], v[88:91], v[172:175], v[52:55]
    buffer_load_dword v190, s[12:15], s26 offen offset:2048 lds
    s_add_u32 s26, s26, 294912
    v_mfma_f32_16x16x32_bf16 v[20:23], v[92:95], v[168:171], v[20:23]
    ds_read_b64_tr_b16 v[130:131], v193 offset:30048
    ds_read_b64_tr_b16 v[132:133], v193 offset:27776
    v_mfma_f32_16x16x32_bf16 v[56:59], v[92:95], v[172:175], v[56:59]
    ds_read_b64_tr_b16 v[134:135], v193 offset:30080
    s_add_u32 m0, s27, 4096
    v_mfma_f32_16x16x32_bf16 v[24:27], v[96:99], v[168:171], v[24:27]
    buffer_load_dwordx4 v184, s[8:11], s25 offen lds
    ds_read_b64_tr_b16 v[136:137], v193 offset:27808
    v_mfma_f32_16x16x32_bf16 v[60:63], v[96:99], v[172:175], v[60:63]
    ds_read_b64_tr_b16 v[138:139], v193 offset:30112
    ds_read_b64_tr_b16 v[140:141], v193 offset:27840
    v_mfma_f32_16x16x32_bf16 v[28:31], v[100:103], v[168:171], v[28:31]
    buffer_load_dwordx4 v185, s[8:11], s25 offen offset:1024 lds
    ds_read_b64_tr_b16 v[142:143], v193 offset:30144
    v_mfma_f32_16x16x32_bf16 v[64:67], v[100:103], v[172:175], v[64:67]
    ds_read_b64_tr_b16 v[144:145], v193 offset:27872
    ds_read_b64_tr_b16 v[146:147], v193 offset:30176
    v_mfma_f32_16x16x32_bf16 v[32:35], v[104:107], v[168:171], v[32:35]
    ds_read_b64_tr_b16 v[148:149], v193 offset:27904
    ds_read_b64_tr_b16 v[150:151], v193 offset:30208
    v_mfma_f32_16x16x32_bf16 v[68:71], v[104:107], v[172:175], v[68:71]
    buffer_load_dwordx4 v186, s[8:11], s25 offen offset:2048 lds
    v_mfma_f32_16x16x32_bf16 v[36:39], v[108:111], v[168:171], v[36:39]
    v_mfma_f32_16x16x32_bf16 v[72:75], v[108:111], v[172:175], v[72:75]
    buffer_load_dwordx4 v187, s[8:11], s25 offen offset:3072 lds
    s_add_u32 s25, s25, 128
    v_mfma_f32_16x16x32_bf16 v[40:43], v[112:115], v[168:171], v[40:43]
    v_mfma_f32_16x16x32_bf16 v[76:79], v[112:115], v[172:175], v[76:79]
    s_waitcnt vmcnt(10) lgkmcnt(0)
    s_barrier
    v_mfma_f32_16x16x32_bf16 v[8:11], v[116:119], v[176:179], v[8:11]
    ds_read_b128 v[152:155], v191 offset:0
    s_add_u32 m0, s28, 27648
    v_mfma_f32_16x16x32_bf16 v[44:47], v[116:119], v[180:183], v[44:47]
    buffer_load_dwordx4 v188, s[12:15], s26 offen lds
    ds_read_b128 v[156:159], v191 offset:2048
    v_mfma_f32_16x16x32_bf16 v[12:15], v[120:123], v[176:179], v[12:15]
    ds_read_b128 v[160:163], v192 offset:0
    ds_read_b128 v[164:167], v192 offset:2048
    v_mfma_f32_16x16x32_bf16 v[48:51], v[120:123], v[180:183], v[48:51]
    ds_read_b64_tr_b16 v[80:81], v193 offset:0
    ds_read_b64_tr_b16 v[82:83], v193 offset:2304
    v_mfma_f32_16x16x32_bf16 v[16:19], v[124:127], v[176:179], v[16:19]
    ds_read_b64_tr_b16 v[84:85], v193 offset:32
    ds_read_b64_tr_b16 v[86:87], v193 offset:2336
    v_mfma_f32_16x16x32_bf16 v[52:55], v[124:127], v[180:183], v[52:55]
    ds_read_b64_tr_b16 v[88:89], v193 offset:64
    ds_read_b64_tr_b16 v[90:91], v193 offset:2368
    v_mfma_f32_16x16x32_bf16 v[20:23], v[128:131], v[176:179], v[20:23]
    buffer_load_dwordx4 v189, s[12:15], s26 offen offset:1024 lds
    ds_read_b64_tr_b16 v[92:93], v193 offset:96
    v_mfma_f32_16x16x32_bf16 v[56:59], v[128:131], v[180:183], v[56:59]
    ds_read_b64_tr_b16 v[94:95], v193 offset:2400
    ds_read_b64_tr_b16 v[96:97], v193 offset:128
    v_mfma_f32_16x16x32_bf16 v[24:27], v[132:135], v[176:179], v[24:27]
    ds_read_b64_tr_b16 v[98:99], v193 offset:2432
    ds_read_b64_tr_b16 v[100:101], v193 offset:160
    v_mfma_f32_16x16x32_bf16 v[60:63], v[132:135], v[180:183], v[60:63]
    ds_read_b64_tr_b16 v[102:103], v193 offset:2464
    ds_read_b64_tr_b16 v[104:105], v193 offset:192
    v_mfma_f32_16x16x32_bf16 v[28:31], v[136:139], v[176:179], v[28:31]
    ds_read_b64_tr_b16 v[106:107], v193 offset:2496
    ds_read_b64_tr_b16 v[108:109], v193 offset:224
    v_mfma_f32_16x16x32_bf16 v[64:67], v[136:139], v[180:183], v[64:67]
    ds_read_b64_tr_b16 v[110:111], v193 offset:2528
    ds_read_b64_tr_b16 v[112:113], v193 offset:256
    v_mfma_f32_16x16x32_bf16 v[32:35], v[140:143], v[176:179], v[32:35]
    buffer_load_dword v190, s[12:15], s26 offen offset:2048 lds
    s_add_u32 s26, s26, 294912
    v_mfma_f32_16x16x32_bf16 v[68:71], v[140:143], v[180:183], v[68:71]
    ds_read_b64_tr_b16 v[114:115], v193 offset:2560
    v_mfma_f32_16x16x32_bf16 v[36:39], v[144:147], v[176:179], v[36:39]
    v_mfma_f32_16x16x32_bf16 v[72:75], v[144:147], v[180:183], v[72:75]
    v_mfma_f32_16x16x32_bf16 v[40:43], v[148:151], v[176:179], v[40:43]
    v_mfma_f32_16x16x32_bf16 v[76:79], v[148:151], v[180:183], v[76:79]
    s_sub_u32 s30, s30, 1
    s_cmp_lg_u32 s30, 0
    s_cbranch_scc1 Lk_24
    s_waitcnt vmcnt(10) lgkmcnt(0)
    s_barrier
    v_mfma_f32_16x16x32_bf16 v[8:11], v[80:83], v[152:155], v[8:11]
    ds_read_b64_tr_b16 v[116:117], v193 offset:9216
    s_add_u32 m0, s28, 0
    v_mfma_f32_16x16x32_bf16 v[44:47], v[80:83], v[156:159], v[44:47]
    buffer_load_dwordx4 v188, s[12:15], s26 offen lds
    ds_read_b64_tr_b16 v[118:119], v193 offset:11520
    v_mfma_f32_16x16x32_bf16 v[12:15], v[84:87], v[152:155], v[12:15]
    ds_read_b64_tr_b16 v[120:121], v193 offset:9248
    ds_read_b64_tr_b16 v[122:123], v193 offset:11552
    v_mfma_f32_16x16x32_bf16 v[48:51], v[84:87], v[156:159], v[48:51]
    buffer_load_dwordx4 v189, s[12:15], s26 offen offset:1024 lds
    ds_read_b64_tr_b16 v[124:125], v193 offset:9280
    v_mfma_f32_16x16x32_bf16 v[16:19], v[88:91], v[152:155], v[16:19]
    ds_read_b64_tr_b16 v[126:127], v193 offset:11584
    ds_read_b64_tr_b16 v[128:129], v193 offset:9312
    v_mfma_f32_16x16x32_bf16 v[52:55], v[88:91], v[156:159], v[52:55]
    buffer_load_dword v190, s[12:15], s26 offen offset:2048 lds
    s_add_u32 s26, s26, 294912
    v_mfma_f32_16x16x32_bf16 v[20:23], v[92:95], v[152:155], v[20:23]
    ds_read_b64_tr_b16 v[130:131], v193 offset:11616
    ds_read_b64_tr_b16 v[132:133], v193 offset:9344
    v_mfma_f32_16x16x32_bf16 v[56:59], v[92:95], v[156:159], v[56:59]
    ds_read_b64_tr_b16 v[134:135], v193 offset:11648
    s_add_u32 m0, s27, 0
    v_mfma_f32_16x16x32_bf16 v[24:27], v[96:99], v[152:155], v[24:27]
    buffer_load_dwordx4 v184, s[8:11], s25 offen lds
    ds_read_b64_tr_b16 v[136:137], v193 offset:9376
    v_mfma_f32_16x16x32_bf16 v[60:63], v[96:99], v[156:159], v[60:63]
    ds_read_b64_tr_b16 v[138:139], v193 offset:11680
    ds_read_b64_tr_b16 v[140:141], v193 offset:9408
    v_mfma_f32_16x16x32_bf16 v[28:31], v[100:103], v[152:155], v[28:31]
    buffer_load_dwordx4 v185, s[8:11], s25 offen offset:1024 lds
    ds_read_b64_tr_b16 v[142:143], v193 offset:11712
    v_mfma_f32_16x16x32_bf16 v[64:67], v[100:103], v[156:159], v[64:67]
    ds_read_b64_tr_b16 v[144:145], v193 offset:9440
    ds_read_b64_tr_b16 v[146:147], v193 offset:11744
    v_mfma_f32_16x16x32_bf16 v[32:35], v[104:107], v[152:155], v[32:35]
    ds_read_b64_tr_b16 v[148:149], v193 offset:9472
    ds_read_b64_tr_b16 v[150:151], v193 offset:11776
    v_mfma_f32_16x16x32_bf16 v[68:71], v[104:107], v[156:159], v[68:71]
    buffer_load_dwordx4 v186, s[8:11], s25 offen offset:2048 lds
    v_mfma_f32_16x16x32_bf16 v[36:39], v[108:111], v[152:155], v[36:39]
    v_mfma_f32_16x16x32_bf16 v[72:75], v[108:111], v[156:159], v[72:75]
    buffer_load_dwordx4 v187, s[8:11], s25 offen offset:3072 lds
    s_add_u32 s25, s25, 128
    v_mfma_f32_16x16x32_bf16 v[40:43], v[112:115], v[152:155], v[40:43]
    v_mfma_f32_16x16x32_bf16 v[76:79], v[112:115], v[156:159], v[76:79]
    s_waitcnt vmcnt(10) lgkmcnt(0)
    s_barrier
    v_mfma_f32_16x16x32_bf16 v[8:11], v[116:119], v[160:163], v[8:11]
    ds_read_b128 v[168:171], v191 offset:4096
    s_add_u32 m0, s28, 9216
    v_mfma_f32_16x16x32_bf16 v[44:47], v[116:119], v[164:167], v[44:47]
    buffer_load_dwordx4 v188, s[12:15], s26 offen lds
    ds_read_b128 v[172:175], v191 offset:6144
    v_mfma_f32_16x16x32_bf16 v[12:15], v[120:123], v[160:163], v[12:15]
    ds_read_b128 v[176:179], v192 offset:4096
    ds_read_b128 v[180:183], v192 offset:6144
    v_mfma_f32_16x16x32_bf16 v[48:51], v[120:123], v[164:167], v[48:51]
    ds_read_b64_tr_b16 v[80:81], v193 offset:18432
    ds_read_b64_tr_b16 v[82:83], v193 offset:20736
    v_mfma_f32_16x16x32_bf16 v[16:19], v[124:127], v[160:163], v[16:19]
    ds_read_b64_tr_b16 v[84:85], v193 offset:18464
    ds_read_b64_tr_b16 v[86:87], v193 offset:20768
    v_mfma_f32_16x16x32_bf16 v[52:55], v[124:127], v[164:167], v[52:55]
    ds_read_b64_tr_b16 v[88:89], v193 offset:18496
    ds_read_b64_tr_b16 v[90:91], v193 offset:20800
    v_mfma_f32_16x16x32_bf16 v[20:23], v[128:131], v[160:163], v[20:23]
    buffer_load_dwordx4 v189, s[12:15], s26 offen offset:1024 lds
    ds_read_b64_tr_b16 v[92:93], v193 offset:18528
    v_mfma_f32_16x16x32_bf16 v[56:59], v[128:131], v[164:167], v[56:59]
    ds_read_b64_tr_b16 v[94:95], v193 offset:20832
    ds_read_b64_tr_b16 v[96:97], v193 offset:18560
    v_mfma_f32_16x16x32_bf16 v[24:27], v[132:135], v[160:163], v[24:27]
    ds_read_b64_tr_b16 v[98:99], v193 offset:20864
    ds_read_b64_tr_b16 v[100:101], v193 offset:18592
    v_mfma_f32_16x16x32_bf16 v[60:63], v[132:135], v[164:167], v[60:63]
    ds_read_b64_tr_b16 v[102:103], v193 offset:20896
    ds_read_b64_tr_b16 v[104:105], v193 offset:18624
    v_mfma_f32_16x16x32_bf16 v[28:31], v[136:139], v[160:163], v[28:31]
    ds_read_b64_tr_b16 v[106:107], v193 offset:20928
    ds_read_b64_tr_b16 v[108:109], v193 offset:18656
    v_mfma_f32_16x16x32_bf16 v[64:67], v[136:139], v[164:167], v[64:67]
    ds_read_b64_tr_b16 v[110:111], v193 offset:20960
    ds_read_b64_tr_b16 v[112:113], v193 offset:18688
    v_mfma_f32_16x16x32_bf16 v[32:35], v[140:143], v[160:163], v[32:35]
    buffer_load_dword v190, s[12:15], s26 offen offset:2048 lds
    s_add_u32 s26, s26, 294912
    v_mfma_f32_16x16x32_bf16 v[68:71], v[140:143], v[164:167], v[68:71]
    ds_read_b64_tr_b16 v[114:115], v193 offset:20992
    v_mfma_f32_16x16x32_bf16 v[36:39], v[144:147], v[160:163], v[36:39]
    v_mfma_f32_16x16x32_bf16 v[72:75], v[144:147], v[164:167], v[72:75]
    v_mfma_f32_16x16x32_bf16 v[40:43], v[148:151], v[160:163], v[40:43]
    v_mfma_f32_16x16x32_bf16 v[76:79], v[148:151], v[164:167], v[76:79]
    s_waitcnt vmcnt(10) lgkmcnt(0)
    s_barrier
    v_mfma_f32_16x16x32_bf16 v[8:11], v[80:83], v[168:171], v[8:11]
    ds_read_b64_tr_b16 v[116:117], v193 offset:27648
    ds_read_b64_tr_b16 v[118:119], v193 offset:29952
    v_mfma_f32_16x16x32_bf16 v[44:47], v[80:83], v[172:175], v[44:47]
    ds_read_b64_tr_b16 v[120:121], v193 offset:27680
    ds_read_b64_tr_b16 v[122:123], v193 offset:29984
    v_mfma_f32_16x16x32_bf16 v[12:15], v[84:87], v[168:171], v[12:15]
    ds_read_b64_tr_b16 v[124:125], v193 offset:27712
    ds_read_b64_tr_b16 v[126:127], v193 offset:30016
    v_mfma_f32_16x16x32_bf16 v[48:51], v[84:87], v[172:175], v[48:51]
    ds_read_b64_tr_b16 v[128:129], v193 offset:27744
    ds_read_b64_tr_b16 v[130:131], v193 offset:30048
    v_mfma_f32_16x16x32_bf16 v[16:19], v[88:91], v[168:171], v[16:19]
    ds_read_b64_tr_b16 v[132:133], v193 offset:27776
    ds_read_b64_tr_b16 v[134:135], v193 offset:30080
    v_mfma_f32_16x16x32_bf16 v[52:55], v[88:91], v[172:175], v[52:55]
    ds_read_b64_tr_b16 v[136:137], v193 offset:27808
    ds_read_b64_tr_b16 v[138:139], v193 offset:30112
    v_mfma_f32_16x16x32_bf16 v[20:23], v[92:95], v[168:171], v[20:23]
    ds_read_b64_tr_b16 v[140:141], v193 offset:27840
    ds_read_b64_tr_b16 v[142:143], v193 offset:30144
    v_mfma_f32_16x16x32_bf16 v[56:59], v[92:95], v[172:175], v[56:59]
    ds_read_b64_tr_b16 v[144:145], v193 offset:27872
    ds_read_b64_tr_b16 v[146:147], v193 offset:30176
    v_mfma_f32_16x16x32_bf16 v[24:27], v[96:99], v[168:171], v[24:27]
    ds_read_b64_tr_b16 v[148:149], v193 offset:27904
    ds_read_b64_tr_b16 v[150:151], v193 offset:30208
    v_mfma_f32_16x16x32_bf16 v[60:63], v[96:99], v[172:175], v[60:63]
    v_mfma_f32_16x16x32_bf16 v[28:31], v[100:103], v[168:171], v[28:31]
    v_mfma_f32_16x16x32_bf16 v[64:67], v[100:103], v[172:175], v[64:67]
    v_mfma_f32_16x16x32_bf16 v[32:35], v[104:107], v[168:171], v[32:35]
    v_mfma_f32_16x16x32_bf16 v[68:71], v[104:107], v[172:175], v[68:71]
    v_mfma_f32_16x16x32_bf16 v[36:39], v[108:111], v[168:171], v[36:39]
    v_mfma_f32_16x16x32_bf16 v[72:75], v[108:111], v[172:175], v[72:75]
    v_mfma_f32_16x16x32_bf16 v[40:43], v[112:115], v[168:171], v[40:43]
    v_mfma_f32_16x16x32_bf16 v[76:79], v[112:115], v[172:175], v[76:79]
    s_waitcnt vmcnt(3) lgkmcnt(0)
    s_barrier
    v_mfma_f32_16x16x32_bf16 v[8:11], v[116:119], v[176:179], v[8:11]
    ds_read_b128 v[152:155], v191 offset:0
    ds_read_b128 v[156:159], v191 offset:2048
    v_mfma_f32_16x16x32_bf16 v[44:47], v[116:119], v[180:183], v[44:47]
    ds_read_b128 v[160:163], v192 offset:0
    ds_read_b128 v[164:167], v192 offset:2048
    v_mfma_f32_16x16x32_bf16 v[12:15], v[120:123], v[176:179], v[12:15]
    ds_read_b64_tr_b16 v[80:81], v193 offset:0
    ds_read_b64_tr_b16 v[82:83], v193 offset:2304
    v_mfma_f32_16x16x32_bf16 v[48:51], v[120:123], v[180:183], v[48:51]
    ds_read_b64_tr_b16 v[84:85], v193 offset:32
    ds_read_b64_tr_b16 v[86:87], v193 offset:2336
    v_mfma_f32_16x16x32_bf16 v[16:19], v[124:127], v[176:179], v[16:19]
    ds_read_b64_tr_b16 v[88:89], v193 offset:64
    ds_read_b64_tr_b16 v[90:91], v193 offset:2368
    v_mfma_f32_16x16x32_bf16 v[52:55], v[124:127], v[180:183], v[52:55]
    ds_read_b64_tr_b16 v[92:93], v193 offset:96
    ds_read_b64_tr_b16 v[94:95], v193 offset:2400
    v_mfma_f32_16x16x32_bf16 v[20:23], v[128:131], v[176:179], v[20:23]
    ds_read_b64_tr_b16 v[96:97], v193 offset:128
    ds_read_b64_tr_b16 v[98:99], v193 offset:2432
    v_mfma_f32_16x16x32_bf16 v[56:59], v[128:131], v[180:183], v[56:59]
    ds_read_b64_tr_b16 v[100:101], v193 offset:160
    ds_read_b64_tr_b16 v[102:103], v193 offset:2464
    v_mfma_f32_16x16x32_bf16 v[24:27], v[132:135], v[176:179], v[24:27]
    ds_read_b64_tr_b16 v[104:105], v193 offset:192
    ds_read_b64_tr_b16 v[106:107], v193 offset:2496
    v_mfma_f32_16x16x32_bf16 v[60:63], v[132:135], v[180:183], v[60:63]
    ds_read_b64_tr_b16 v[108:109], v193 offset:224
    ds_read_b64_tr_b16 v[110:111], v193 offset:2528
    v_mfma_f32_16x16x32_bf16 v[28:31], v[136:139], v[176:179], v[28:31]
    ds_read_b64_tr_b16 v[112:113], v193 offset:256
    ds_read_b64_tr_b16 v[114:115], v193 offset:2560
    v_mfma_f32_16x16x32_bf16 v[64:67], v[136:139], v[180:183], v[64:67]
    v_mfma_f32_16x16x32_bf16 v[32:35], v[140:143], v[176:179], v[32:35]
    v_mfma_f32_16x16x32_bf16 v[68:71], v[140:143], v[180:183], v[68:71]
    v_mfma_f32_16x16x32_bf16 v[36:39], v[144:147], v[176:179], v[36:39]
    v_mfma_f32_16x16x32_bf16 v[72:75], v[144:147], v[180:183], v[72:75]
    v_mfma_f32_16x16x32_bf16 v[40:43], v[148:151], v[176:179], v[40:43]
    v_mfma_f32_16x16x32_bf16 v[76:79], v[148:151], v[180:183], v[76:79]
    s_waitcnt vmcnt(0) lgkmcnt(0)
    s_barrier
    v_mfma_f32_16x16x32_bf16 v[8:11], v[80:83], v[152:155], v[8:11]
    ds_read_b64_tr_b16 v[116:117], v193 offset:9216
    ds_read_b64_tr_b16 v[118:119], v193 offset:11520
    v_mfma_f32_16x16x32_bf16 v[44:47], v[80:83], v[156:159], v[44:47]
    ds_read_b64_tr_b16 v[120:121], v193 offset:9248
    ds_read_b64_tr_b16 v[122:123], v193 offset:11552
    v_mfma_f32_16x16x32_bf16 v[12:15], v[84:87], v[152:155], v[12:15]
    ds_read_b64_tr_b16 v[124:125], v193 offset:9280
    ds_read_b64_tr_b16 v[126:127], v193 offset:11584
    v_mfma_f32_16x16x32_bf16 v[48:51], v[84:87], v[156:159], v[48:51]
    ds_read_b64_tr_b16 v[128:129], v193 offset:9312
    ds_read_b64_tr_b16 v[130:131], v193 offset:11616
    v_mfma_f32_16x16x32_bf16 v[16:19], v[88:91], v[152:155], v[16:19]
    ds_read_b64_tr_b16 v[132:133], v193 offset:9344
    ds_read_b64_tr_b16 v[134:135], v193 offset:11648
    v_mfma_f32_16x16x32_bf16 v[52:55], v[88:91], v[156:159], v[52:55]
    ds_read_b64_tr_b16 v[136:137], v193 offset:9376
    ds_read_b64_tr_b16 v[138:139], v193 offset:11680
    v_mfma_f32_16x16x32_bf16 v[20:23], v[92:95], v[152:155], v[20:23]
    ds_read_b64_tr_b16 v[140:141], v193 offset:9408
    ds_read_b64_tr_b16 v[142:143], v193 offset:11712
    v_mfma_f32_16x16x32_bf16 v[56:59], v[92:95], v[156:159], v[56:59]
    ds_read_b64_tr_b16 v[144:145], v193 offset:9440
    ds_read_b64_tr_b16 v[146:147], v193 offset:11744
    v_mfma_f32_16x16x32_bf16 v[24:27], v[96:99], v[152:155], v[24:27]
    ds_read_b64_tr_b16 v[148:149], v193 offset:9472
    ds_read_b64_tr_b16 v[150:151], v193 offset:11776
    v_mfma_f32_16x16x32_bf16 v[60:63], v[96:99], v[156:159], v[60:63]
    v_mfma_f32_16x16x32_bf16 v[28:31], v[100:103], v[152:155], v[28:31]
    v_mfma_f32_16x16x32_bf16 v[64:67], v[100:103], v[156:159], v[64:67]
    v_mfma_f32_16x16x32_bf16 v[32:35], v[104:107], v[152:155], v[32:35]
    v_mfma_f32_16x16x32_bf16 v[68:71], v[104:107], v[156:159], v[68:71]
    v_mfma_f32_16x16x32_bf16 v[36:39], v[108:111], v[152:155], v[36:39]
    v_mfma_f32_16x16x32_bf16 v[72:75], v[108:111], v[156:159], v[72:75]
    v_mfma_f32_16x16x32_bf16 v[40:43], v[112:115], v[152:155], v[40:43]
    v_mfma_f32_16x16x32_bf16 v[76:79], v[112:115], v[156:159], v[76:79]
    s_waitcnt vmcnt(0) lgkmcnt(0)
    s_barrier
    v_mfma_f32_16x16x32_bf16 v[8:11], v[116:119], v[160:163], v[8:11]
    v_mfma_f32_16x16x32_bf16 v[44:47], v[116:119], v[164:167], v[44:47]
    v_mfma_f32_16x16x32_bf16 v[12:15], v[120:123], v[160:163], v[12:15]
    v_mfma_f32_16x16x32_bf16 v[48:51], v[120:123], v[164:167], v[48:51]
    v_mfma_f32_16x16x32_bf16 v[16:19], v[124:127], v[160:163], v[16:19]
    v_mfma_f32_16x16x32_bf16 v[52:55], v[124:127], v[164:167], v[52:55]
    v_mfma_f32_16x16x32_bf16 v[20:23], v[128:131], v[160:163], v[20:23]
    v_mfma_f32_16x16x32_bf16 v[56:59], v[128:131], v[164:167], v[56:59]
    v_mfma_f32_16x16x32_bf16 v[24:27], v[132:135], v[160:163], v[24:27]
    v_mfma_f32_16x16x32_bf16 v[60:63], v[132:135], v[164:167], v[60:63]
    v_mfma_f32_16x16x32_bf16 v[28:31], v[136:139], v[160:163], v[28:31]
    v_mfma_f32_16x16x32_bf16 v[64:67], v[136:139], v[164:167], v[64:67]
    v_mfma_f32_16x16x32_bf16 v[32:35], v[140:143], v[160:163], v[32:35]
    v_mfma_f32_16x16x32_bf16 v[68:71], v[140:143], v[164:167], v[68:71]
    v_mfma_f32_16x16x32_bf16 v[36:39], v[144:147], v[160:163], v[36:39]
    v_mfma_f32_16x16x32_bf16 v[72:75], v[144:147], v[164:167], v[72:75]
    v_mfma_f32_16x16x32_bf16 v[40:43], v[148:151], v[160:163], v[40:43]
    v_mfma_f32_16x16x32_bf16 v[76:79], v[148:151], v[164:167], v[76:79]
    s_mov_b32 s8, s86
    s_mov_b32 s9, s87
    s_and_b32 s9, s9, 0xffff
    s_mov_b32 s10, 8388608
    s_mov_b32 s11, 0x20000
    s_add_u32 s12, s84, 9437184
    s_addc_u32 s13, s85, 0
    s_and_b32 s13, s13, 0xffff
    s_mov_b32 s14, 9437184
    s_mov_b32 s15, 0x20000
    v_and_b32 v2, 63, v0
    v_lshrrev_b32 v3, 3, v2
    s_lshl_b32 s4, s24, 5
    v_add_u32 v3, s4, v3
    s_mov_b32 s5, 4096
    v_mul_lo_u32 v3, v3, s5
    v_lshrrev_b32 v4, 4, v2
    v_and_b32 v5, 7, v2
    v_xor_b32 v6, v5, v4
    v_lshlrev_b32 v6, 4, v6
    v_add_u32 v184, v3, v6
    v_xor_b32 v6, 64, v6
    v_add_u32 v185, v3, v6
    v_add_u32 v186, 63488, v184
    v_add_u32 v185, 31744, v185
    v_add_u32 v187, 63488, v185
    v_and_b32 v3, 15, v2
    v_lshrrev_b32 v5, 1, v3
    v_xor_b32 v5, v5, v4
    v_lshlrev_b32 v5, 4, v5
    v_lshlrev_b32 v3, 7, v3
    v_add_u32 v3, v3, v5
    s_lshl_b32 s4, s24, 13
    s_add_u32 s27, s4, 36864
    v_add_u32 v191, s27, v3
    v_xor_b32 v192, 64, v191
    s_mul_i32 s25, s46, 524288
    s_mul_i32 s26, s47, 2304
    s_mul_i32 s4, s24, 36864
    s_add_u32 s26, s26, s4
    s_add_u32 m0, s27, 0
    s_nop 0
    buffer_load_dwordx4 v184, s[8:11], s25 offen lds
    buffer_load_dwordx4 v185, s[8:11], s25 offen offset:1024 lds
    buffer_load_dwordx4 v186, s[8:11], s25 offen offset:2048 lds
    buffer_load_dwordx4 v187, s[8:11], s25 offen offset:3072 lds
    s_add_u32 s25, s25, 128
    s_add_u32 m0, s27, 4096
    s_nop 0
    buffer_load_dwordx4 v184, s[8:11], s25 offen lds
    buffer_load_dwordx4 v185, s[8:11], s25 offen offset:1024 lds
    buffer_load_dwordx4 v186, s[8:11], s25 offen offset:2048 lds
    buffer_load_dwordx4 v187, s[8:11], s25 offen offset:3072 lds
    s_add_u32 s25, s25, 128
    v_and_b32 v2, 15, v0
    v_lshlrev_b32 v2, 2, v2
    v_add_u32 v2, 14336, v2
    s_cmp_lg_u32 s24, 0
    s_cbranch_scc1 Lpolled_26
    s_mov_b32 s5, 0
Lpoll_25:
    buffer_load_dword v4, v2, s[56:59], 0 offen sc1
    s_waitcnt vmcnt(0)
    v_cmp_eq_u32 s[6:7], 0, v4
    s_add_u32 s5, s5, 1
    s_nop 1
    s_cmp_eq_u64 s[6:7], 0
    s_cbranch_scc1 Lpolled_26
    s_sleep 16
    s_cmp_lt_u32 s5, 0x100000
    s_cbranch_scc1 Lpoll_25
Lpolled_26:
    s_barrier
    s_mov_b32 s16, s88
    s_mov_b32 s17, s89
    s_and_b32 s17, s17, 0xffff
    s_mov_b32 s18, 4096
    s_mov_b32 s19, 0x20000
    s_add_u32 s20, s84, 38797312
    s_addc_u32 s21, s85, 0
    s_and_b32 s21, s21, 0xffff
    s_mov_b32 s22, 8192
    s_mov_b32 s23, 0x20000
    v_and_b32 v2, 15, v0
    s_lshl_b32 s4, s24, 5
    s_lshl_b32 s5, s46, 7
    s_add_u32 s4, s4, s5
    v_add_u32 v2, s4, v2
    v_lshlrev_b32 v3, 1, v2
    v_lshlrev_b32 v4, 2, v2
    buffer_load_ushort v234, v3, s[16:19], 0 offen offset:0
    buffer_load_dword v232, v4, s[20:23], 0 offen offset:0 sc1
    buffer_load_ushort v238, v3, s[16:19], 0 offen offset:32
    buffer_load_dword v236, v4, s[20:23], 0 offen offset:64 sc1
    v_and_b32 v2, 63, v0
    s_mul_i32 s28, s24, 2304
    v_lshlrev_b32 v188, 4, v2
    v_mov_b32 v189, v188
    v_lshlrev_b32 v190, 2, v2
    v_lshrrev_b32 v3, 4, v2
    v_mul_u32_u24 v3, 2304, v3
    v_and_b32 v4, 15, v2
    v_lshl_add_u32 v193, v4, 4, v3
    v_mov_b32 v80, 0xbdd2d3e8
    v_mul_f32 v140, v8, v8
    v_mul_f32 v141, v9, v9
    v_mul_f32 v142, v10, v10
    v_mul_f32 v143, v11, v11
    v_mul_f32 v144, v12, v12
    v_mul_f32 v145, v13, v13
    v_mul_f32 v146, v14, v14
    v_mul_f32 v147, v15, v15
    v_fmaak_f32 v140, v80, v140, 0xc0135761
    v_fmaak_f32 v141, v80, v141, 0xc0135761
    v_fmaak_f32 v142, v80, v142, 0xc0135761
    v_fmaak_f32 v143, v80, v143, 0xc0135761
    v_fmaak_f32 v144, v80, v144, 0xc0135761
    v_fmaak_f32 v145, v80, v145, 0xc0135761
    v_fmaak_f32 v146, v80, v146, 0xc0135761
    v_fmaak_f32 v147, v80, v147, 0xc0135761
    v_mul_f32 v140, v8, v140
    v_mul_f32 v141, v9, v141
    v_mul_f32 v142, v10, v142
    v_mul_f32 v143, v11, v143
    v_mul_f32 v144, v12, v144
    v_mul_f32 v145, v13, v145
    v_mul_f32 v146, v14, v146
    v_mul_f32 v147, v15, v147
    v_exp_f32 v140, v140
    v_exp_f32 v141, v141
    v_exp_f32 v142, v142
    v_exp_f32 v143, v143
    v_exp_f32 v144, v144
    v_exp_f32 v145, v145
    v_exp_f32 v146, v146
    v_exp_f32 v147, v147
    v_add_f32 v140, 1.0, v140
    v_add_f32 v141, 1.0, v141
    v_add_f32 v142, 1.0, v142
    v_add_f32 v143, 1.0, v143
    v_add_f32 v144, 1.0, v144
    v_add_f32 v145, 1.0, v145
    v_add_f32 v146, 1.0, v146
    v_add_f32 v147, 1.0, v147
    v_rcp_f32 v140, v140
    v_rcp_f32 v141, v141
    v_rcp_f32 v142, v142
    v_rcp_f32 v143, v143
    v_rcp_f32 v144, v144
    v_rcp_f32 v145, v145
    v_rcp_f32 v146, v146
    v_rcp_f32 v147, v147
    v_mul_f32 v8, v8, v140
    v_mul_f32 v9, v9, v141
    v_mul_f32 v10, v10, v142
    v_mul_f32 v11, v11, v143
    v_mul_f32 v12, v12, v144
    v_mul_f32 v13, v13, v145
    v_mul_f32 v14, v14, v146
    v_mul_f32 v15, v15, v147
    v_mul_f32 v140, v16, v16
    v_mul_f32 v141, v17, v17
    v_mul_f32 v142, v18, v18
    v_mul_f32 v143, v19, v19
    v_mul_f32 v144, v20, v20
    v_mul_f32 v145, v21, v21
    v_mul_f32 v146, v22, v22
    v_mul_f32 v147, v23, v23
    v_fmaak_f32 v140, v80, v140, 0xc0135761
    v_fmaak_f32 v141, v80, v141, 0xc0135761
    v_fmaak_f32 v142, v80, v142, 0xc0135761
    v_fmaak_f32 v143, v80, v143, 0xc0135761
    v_fmaak_f32 v144, v80, v144, 0xc0135761
    v_fmaak_f32 v145, v80, v145, 0xc0135761
    v_fmaak_f32 v146, v80, v146, 0xc0135761
    v_fmaak_f32 v147, v80, v147, 0xc0135761
    v_mul_f32 v140, v16, v140
    v_mul_f32 v141, v17, v141
    v_mul_f32 v142, v18, v142
    v_mul_f32 v143, v19, v143
    v_mul_f32 v144, v20, v144
    v_mul_f32 v145, v21, v145
    v_mul_f32 v146, v22, v146
    v_mul_f32 v147, v23, v147
    v_exp_f32 v140, v140
    v_exp_f32 v141, v141
    v_exp_f32 v142, v142
    v_exp_f32 v143, v143
    v_exp_f32 v144, v144
    v_exp_f32 v145, v145
    v_exp_f32 v146, v146
    v_exp_f32 v147, v147
    v_add_f32 v140, 1.0, v140
    v_add_f32 v141, 1.0, v141
    v_add_f32 v142, 1.0, v142
    v_add_f32 v143, 1.0, v143
    v_add_f32 v144, 1.0, v144
    v_add_f32 v145, 1.0, v145
    v_add_f32 v146, 1.0, v146
    v_add_f32 v147, 1.0, v147
    v_rcp_f32 v140, v140
    v_rcp_f32 v141, v141
    v_rcp_f32 v142, v142
    v_rcp_f32 v143, v143
    v_rcp_f32 v144, v144
    v_rcp_f32 v145, v145
    v_rcp_f32 v146, v146
    v_rcp_f32 v147, v147
    v_mul_f32 v16, v16, v140
    v_mul_f32 v17, v17, v141
    v_mul_f32 v18, v18, v142
    v_mul_f32 v19, v19, v143
    v_mul_f32 v20, v20, v144
    v_mul_f32 v21, v21, v145
    v_mul_f32 v22, v22, v146
    v_mul_f32 v23, v23, v147
    v_mul_f32 v140, v24, v24
    v_mul_f32 v141, v25, v25
    v_mul_f32 v142, v26, v26
    v_mul_f32 v143, v27, v27
    v_mul_f32 v144, v28, v28
    v_mul_f32 v145, v29, v29
    v_mul_f32 v146, v30, v30
    v_mul_f32 v147, v31, v31
    v_fmaak_f32 v140, v80, v140, 0xc0135761
    v_fmaak_f32 v141, v80, v141, 0xc0135761
    v_fmaak_f32 v142, v80, v142, 0xc0135761
    v_fmaak_f32 v143, v80, v143, 0xc0135761
    v_fmaak_f32 v144, v80, v144, 0xc0135761
    v_fmaak_f32 v145, v80, v145, 0xc0135761
    v_fmaak_f32 v146, v80, v146, 0xc0135761
    v_fmaak_f32 v147, v80, v147, 0xc0135761
    v_mul_f32 v140, v24, v140
    v_mul_f32 v141, v25, v141
    v_mul_f32 v142, v26, v142
    v_mul_f32 v143, v27, v143
    v_mul_f32 v144, v28, v144
    v_mul_f32 v145, v29, v145
    v_mul_f32 v146, v30, v146
    v_mul_f32 v147, v31, v147
    v_exp_f32 v140, v140
    v_exp_f32 v141, v141
    v_exp_f32 v142, v142
    v_exp_f32 v143, v143
    v_exp_f32 v144, v144
    v_exp_f32 v145, v145
    v_exp_f32 v146, v146
    v_exp_f32 v147, v147
    v_add_f32 v140, 1.0, v140
    v_add_f32 v141, 1.0, v141
    v_add_f32 v142, 1.0, v142
    v_add_f32 v143, 1.0, v143
    v_add_f32 v144, 1.0, v144
    v_add_f32 v145, 1.0, v145
    v_add_f32 v146, 1.0, v146
    v_add_f32 v147, 1.0, v147
    v_rcp_f32 v140, v140
    v_rcp_f32 v141, v141
    v_rcp_f32 v142, v142
    v_rcp_f32 v143, v143
    v_rcp_f32 v144, v144
    v_rcp_f32 v145, v145
    v_rcp_f32 v146, v146
    v_rcp_f32 v147, v147
    v_mul_f32 v24, v24, v140
    v_mul_f32 v25, v25, v141
    v_mul_f32 v26, v26, v142
    v_mul_f32 v27, v27, v143
    v_mul_f32 v28, v28, v144
    v_mul_f32 v29, v29, v145
    v_mul_f32 v30, v30, v146
    v_mul_f32 v31, v31, v147
    v_mul_f32 v140, v32, v32
    v_mul_f32 v141, v33, v33
    v_mul_f32 v142, v34, v34
    v_mul_f32 v143, v35, v35
    v_mul_f32 v144, v36, v36
    v_mul_f32 v145, v37, v37
    v_mul_f32 v146, v38, v38
    v_mul_f32 v147, v39, v39
    v_fmaak_f32 v140, v80, v140, 0xc0135761
    v_fmaak_f32 v141, v80, v141, 0xc0135761
    v_fmaak_f32 v142, v80, v142, 0xc0135761
    v_fmaak_f32 v143, v80, v143, 0xc0135761
    v_fmaak_f32 v144, v80, v144, 0xc0135761
    v_fmaak_f32 v145, v80, v145, 0xc0135761
    v_fmaak_f32 v146, v80, v146, 0xc0135761
    v_fmaak_f32 v147, v80, v147, 0xc0135761
    v_mul_f32 v140, v32, v140
    v_mul_f32 v141, v33, v141
    v_mul_f32 v142, v34, v142
    v_mul_f32 v143, v35, v143
    v_mul_f32 v144, v36, v144
    v_mul_f32 v145, v37, v145
    v_mul_f32 v146, v38, v146
    v_mul_f32 v147, v39, v147
    v_exp_f32 v140, v140
    v_exp_f32 v141, v141
    v_exp_f32 v142, v142
    v_exp_f32 v143, v143
    v_exp_f32 v144, v144
    v_exp_f32 v145, v145
    v_exp_f32 v146, v146
    v_exp_f32 v147, v147
    v_add_f32 v140, 1.0, v140
    v_add_f32 v141, 1.0, v141
    v_add_f32 v142, 1.0, v142
    v_add_f32 v143, 1.0, v143
    v_add_f32 v144, 1.0, v144
    v_add_f32 v145, 1.0, v145
    v_add_f32 v146, 1.0, v146
    v_add_f32 v147, 1.0, v147
    v_rcp_f32 v140, v140
    v_rcp_f32 v141, v141
    v_rcp_f32 v142, v142
    v_rcp_f32 v143, v143
    v_rcp_f32 v144, v144
    v_rcp_f32 v145, v145
    v_rcp_f32 v146, v146
    v_rcp_f32 v147, v147
    v_mul_f32 v32, v32, v140
    v_mul_f32 v33, v33, v141
    v_mul_f32 v34, v34, v142
    v_mul_f32 v35, v35, v143
    v_mul_f32 v36, v36, v144
    v_mul_f32 v37, v37, v145
    v_mul_f32 v38, v38, v146
    v_mul_f32 v39, v39, v147
    v_and_b32 v2, 63, v0
    v_lshlrev_b32 v2, 4, v2
    s_and_b32 s4, s31, 7
    s_lshl_b32 s4, s4, 10
    s_add_u32 s4, s4, 4096
    v_add_u32 v2, s4, v2
    s_cmp_lg_u32 s24, 0
    s_cbranch_scc1 Lpolled_28
    s_mov_b32 s5, 0
Lpoll_27:
    buffer_load_dwordx4 v[4:7], v2, s[56:59], 0 offen sc1
    s_waitcnt vmcnt(0)
    v_min_u32 v4, v4, v5
    v_min_u32 v6, v6, v7
    v_min_u32 v4, v4, v6
    v_cmp_eq_u32 s[6:7], 0, v4
    s_add_u32 s5, s5, 1
    s_nop 1
    s_cmp_eq_u64 s[6:7], 0
    s_cbranch_scc1 Lpolled_28
    s_sleep 16
    s_cmp_lt_u32 s5, 0x100000
    s_cbranch_scc1 Lpoll_27
Lpolled_28:
    s_barrier
    s_add_u32 m0, s28, 0
    s_nop 0
    buffer_load_dwordx4 v188, s[12:15], s26 offen sc1 lds
    buffer_load_dwordx4 v189, s[12:15], s26 offen offset:1024 sc1 lds
    buffer_load_dword v190, s[12:15], s26 offen offset:2048 sc1 lds
    s_add_u32 s26, s26, 147456
    s_add_u32 m0, s28, 9216
    s_nop 0
    buffer_load_dwordx4 v188, s[12:15], s26 offen sc1 lds
    buffer_load_dwordx4 v189, s[12:15], s26 offen offset:1024 sc1 lds
    buffer_load_dword v190, s[12:15], s26 offen offset:2048 sc1 lds
    s_add_u32 s26, s26, 147456
    s_add_u32 m0, s28, 18432
    s_nop 0
    buffer_load_dwordx4 v188, s[12:15], s26 offen sc1 lds
    buffer_load_dwordx4 v189, s[12:15], s26 offen offset:1024 sc1 lds
    buffer_load_dword v190, s[12:15], s26 offen offset:2048 sc1 lds
    s_add_u32 s26, s26, 147456
    s_add_u32 m0, s28, 27648
    s_nop 0
    buffer_load_dwordx4 v188, s[12:15], s26 offen sc1 lds
    buffer_load_dwordx4 v189, s[12:15], s26 offen offset:1024 sc1 lds
    buffer_load_dword v190, s[12:15], s26 offen offset:2048 sc1 lds
    s_add_u32 s26, s26, 147456
    v_mul_f32 v140, v40, v40
    v_mul_f32 v141, v41, v41
    v_mul_f32 v142, v42, v42
    v_mul_f32 v143, v43, v43
    v_mul_f32 v144, v44, v44
    v_mul_f32 v145, v45, v45
    v_mul_f32 v146, v46, v46
    v_mul_f32 v147, v47, v47
    v_fmaak_f32 v140, v80, v140, 0xc0135761
    v_fmaak_f32 v141, v80, v141, 0xc0135761
    v_fmaak_f32 v142, v80, v142, 0xc0135761
    v_fmaak_f32 v143, v80, v143, 0xc0135761
    v_fmaak_f32 v144, v80, v144, 0xc0135761
    v_fmaak_f32 v145, v80, v145, 0xc0135761
    v_fmaak_f32 v146, v80, v146, 0xc0135761
    v_fmaak_f32 v147, v80, v147, 0xc0135761
    v_mul_f32 v140, v40, v140
    v_mul_f32 v141, v41, v141
    v_mul_f32 v142, v42, v142
    v_mul_f32 v143, v43, v143
    v_mul_f32 v144, v44, v144
    v_mul_f32 v145, v45, v145
    v_mul_f32 v146, v46, v146
    v_mul_f32 v147, v47, v147
    v_exp_f32 v140, v140
    v_exp_f32 v141, v141
    v_exp_f32 v142, v142
    v_exp_f32 v143, v143
    v_exp_f32 v144, v144
    v_exp_f32 v145, v145
    v_exp_f32 v146, v146
    v_exp_f32 v147, v147
    v_add_f32 v140, 1.0, v140
    v_add_f32 v141, 1.0, v141
    v_add_f32 v142, 1.0, v142
    v_add_f32 v143, 1.0, v143
    v_add_f32 v144, 1.0, v144
    v_add_f32 v145, 1.0, v145
    v_add_f32 v146, 1.0, v146
    v_add_f32 v147, 1.0, v147
    v_rcp_f32 v140, v140
    v_rcp_f32 v141, v141
    v_rcp_f32 v142, v142
    v_rcp_f32 v143, v143
    v_rcp_f32 v144, v144
    v_rcp_f32 v145, v145
    v_rcp_f32 v146, v146
    v_rcp_f32 v147, v147
    v_mul_f32 v40, v40, v140
    v_mul_f32 v41, v41, v141
    v_mul_f32 v42, v42, v142
    v_mul_f32 v43, v43, v143
    v_mul_f32 v44, v44, v144
    v_mul_f32 v45, v45, v145
    v_mul_f32 v46, v46, v146
    v_mul_f32 v47, v47, v147
    v_mul_f32 v140, v48, v48
    v_mul_f32 v141, v49, v49
    v_mul_f32 v142, v50, v50
    v_mul_f32 v143, v51, v51
    v_mul_f32 v144, v52, v52
    v_mul_f32 v145, v53, v53
    v_mul_f32 v146, v54, v54
    v_mul_f32 v147, v55, v55
    v_fmaak_f32 v140, v80, v140, 0xc0135761
    v_fmaak_f32 v141, v80, v141, 0xc0135761
    v_fmaak_f32 v142, v80, v142, 0xc0135761
    v_fmaak_f32 v143, v80, v143, 0xc0135761
    v_fmaak_f32 v144, v80, v144, 0xc0135761
    v_fmaak_f32 v145, v80, v145, 0xc0135761
    v_fmaak_f32 v146, v80, v146, 0xc0135761
    v_fmaak_f32 v147, v80, v147, 0xc0135761
    v_mul_f32 v140, v48, v140
    v_mul_f32 v141, v49, v141
    v_mul_f32 v142, v50, v142
    v_mul_f32 v143, v51, v143
    v_mul_f32 v144, v52, v144
    v_mul_f32 v145, v53, v145
    v_mul_f32 v146, v54, v146
    v_mul_f32 v147, v55, v147
    v_exp_f32 v140, v140
    v_exp_f32 v141, v141
    v_exp_f32 v142, v142
    v_exp_f32 v143, v143
    v_exp_f32 v144, v144
    v_exp_f32 v145, v145
    v_exp_f32 v146, v146
    v_exp_f32 v147, v147
    v_add_f32 v140, 1.0, v140
    v_add_f32 v141, 1.0, v141
    v_add_f32 v142, 1.0, v142
    v_add_f32 v143, 1.0, v143
    v_add_f32 v144, 1.0, v144
    v_add_f32 v145, 1.0, v145
    v_add_f32 v146, 1.0, v146
    v_add_f32 v147, 1.0, v147
    v_rcp_f32 v140, v140
    v_rcp_f32 v141, v141
    v_rcp_f32 v142, v142
    v_rcp_f32 v143, v143
    v_rcp_f32 v144, v144
    v_rcp_f32 v145, v145
    v_rcp_f32 v146, v146
    v_rcp_f32 v147, v147
    v_mul_f32 v48, v48, v140
    v_mul_f32 v49, v49, v141
    v_mul_f32 v50, v50, v142
    v_mul_f32 v51, v51, v143
    v_mul_f32 v52, v52, v144
    v_mul_f32 v53, v53, v145
    v_mul_f32 v54, v54, v146
    v_mul_f32 v55, v55, v147
    v_mul_f32 v140, v56, v56
    v_mul_f32 v141, v57, v57
    v_mul_f32 v142, v58, v58
    v_mul_f32 v143, v59, v59
    v_mul_f32 v144, v60, v60
    v_mul_f32 v145, v61, v61
    v_mul_f32 v146, v62, v62
    v_mul_f32 v147, v63, v63
    v_fmaak_f32 v140, v80, v140, 0xc0135761
    v_fmaak_f32 v141, v80, v141, 0xc0135761
    v_fmaak_f32 v142, v80, v142, 0xc0135761
    v_fmaak_f32 v143, v80, v143, 0xc0135761
    v_fmaak_f32 v144, v80, v144, 0xc0135761
    v_fmaak_f32 v145, v80, v145, 0xc0135761
    v_fmaak_f32 v146, v80, v146, 0xc0135761
    v_fmaak_f32 v147, v80, v147, 0xc0135761
    v_mul_f32 v140, v56, v140
    v_mul_f32 v141, v57, v141
    v_mul_f32 v142, v58, v142
    v_mul_f32 v143, v59, v143
    v_mul_f32 v144, v60, v144
    v_mul_f32 v145, v61, v145
    v_mul_f32 v146, v62, v146
    v_mul_f32 v147, v63, v147
    v_exp_f32 v140, v140
    v_exp_f32 v141, v141
    v_exp_f32 v142, v142
    v_exp_f32 v143, v143
    v_exp_f32 v144, v144
    v_exp_f32 v145, v145
    v_exp_f32 v146, v146
    v_exp_f32 v147, v147
    v_add_f32 v140, 1.0, v140
    v_add_f32 v141, 1.0, v141
    v_add_f32 v142, 1.0, v142
    v_add_f32 v143, 1.0, v143
    v_add_f32 v144, 1.0, v144
    v_add_f32 v145, 1.0, v145
    v_add_f32 v146, 1.0, v146
    v_add_f32 v147, 1.0, v147
    v_rcp_f32 v140, v140
    v_rcp_f32 v141, v141
    v_rcp_f32 v142, v142
    v_rcp_f32 v143, v143
    v_rcp_f32 v144, v144
    v_rcp_f32 v145, v145
    v_rcp_f32 v146, v146
    v_rcp_f32 v147, v147
    v_mul_f32 v56, v56, v140
    v_mul_f32 v57, v57, v141
    v_mul_f32 v58, v58, v142
    v_mul_f32 v59, v59, v143
    v_mul_f32 v60, v60, v144
    v_mul_f32 v61, v61, v145
    v_mul_f32 v62, v62, v146
    v_mul_f32 v63, v63, v147
    v_mul_f32 v140, v64, v64
    v_mul_f32 v141, v65, v65
    v_mul_f32 v142, v66, v66
    v_mul_f32 v143, v67, v67
    v_mul_f32 v144, v68, v68
    v_mul_f32 v145, v69, v69
    v_mul_f32 v146, v70, v70
    v_mul_f32 v147, v71, v71
    v_fmaak_f32 v140, v80, v140, 0xc0135761
    v_fmaak_f32 v141, v80, v141, 0xc0135761
    v_fmaak_f32 v142, v80, v142, 0xc0135761
    v_fmaak_f32 v143, v80, v143, 0xc0135761
    v_fmaak_f32 v144, v80, v144, 0xc0135761
    v_fmaak_f32 v145, v80, v145, 0xc0135761
    v_fmaak_f32 v146, v80, v146, 0xc0135761
    v_fmaak_f32 v147, v80, v147, 0xc0135761
    v_mul_f32 v140, v64, v140
    v_mul_f32 v141, v65, v141
    v_mul_f32 v142, v66, v142
    v_mul_f32 v143, v67, v143
    v_mul_f32 v144, v68, v144
    v_mul_f32 v145, v69, v145
    v_mul_f32 v146, v70, v146
    v_mul_f32 v147, v71, v147
    v_exp_f32 v140, v140
    v_exp_f32 v141, v141
    v_exp_f32 v142, v142
    v_exp_f32 v143, v143
    v_exp_f32 v144, v144
    v_exp_f32 v145, v145
    v_exp_f32 v146, v146
    v_exp_f32 v147, v147
    v_add_f32 v140, 1.0, v140
    v_add_f32 v141, 1.0, v141
    v_add_f32 v142, 1.0, v142
    v_add_f32 v143, 1.0, v143
    v_add_f32 v144, 1.0, v144
    v_add_f32 v145, 1.0, v145
    v_add_f32 v146, 1.0, v146
    v_add_f32 v147, 1.0, v147
    v_rcp_f32 v140, v140
    v_rcp_f32 v141, v141
    v_rcp_f32 v142, v142
    v_rcp_f32 v143, v143
    v_rcp_f32 v144, v144
    v_rcp_f32 v145, v145
    v_rcp_f32 v146, v146
    v_rcp_f32 v147, v147
    v_mul_f32 v64, v64, v140
    v_mul_f32 v65, v65, v141
    v_mul_f32 v66, v66, v142
    v_mul_f32 v67, v67, v143
    v_mul_f32 v68, v68, v144
    v_mul_f32 v69, v69, v145
    v_mul_f32 v70, v70, v146
    v_mul_f32 v71, v71, v147
    v_mul_f32 v140, v72, v72
    v_mul_f32 v141, v73, v73
    v_mul_f32 v142, v74, v74
    v_mul_f32 v143, v75, v75
    v_mul_f32 v144, v76, v76
    v_mul_f32 v145, v77, v77
    v_mul_f32 v146, v78, v78
    v_mul_f32 v147, v79, v79
    v_fmaak_f32 v140, v80, v140, 0xc0135761
    v_fmaak_f32 v141, v80, v141, 0xc0135761
    v_fmaak_f32 v142, v80, v142, 0xc0135761
    v_fmaak_f32 v143, v80, v143, 0xc0135761
    v_fmaak_f32 v144, v80, v144, 0xc0135761
    v_fmaak_f32 v145, v80, v145, 0xc0135761
    v_fmaak_f32 v146, v80, v146, 0xc0135761
    v_fmaak_f32 v147, v80, v147, 0xc0135761
    v_mul_f32 v140, v72, v140
    v_mul_f32 v141, v73, v141
    v_mul_f32 v142, v74, v142
    v_mul_f32 v143, v75, v143
    v_mul_f32 v144, v76, v144
    v_mul_f32 v145, v77, v145
    v_mul_f32 v146, v78, v146
    v_mul_f32 v147, v79, v147
    v_exp_f32 v140, v140
    v_exp_f32 v141, v141
    v_exp_f32 v142, v142
    v_exp_f32 v143, v143
    v_exp_f32 v144, v144
    v_exp_f32 v145, v145
    v_exp_f32 v146, v146
    v_exp_f32 v147, v147
    v_add_f32 v140, 1.0, v140
    v_add_f32 v141, 1.0, v141
    v_add_f32 v142, 1.0, v142
    v_add_f32 v143, 1.0, v143
    v_add_f32 v144, 1.0, v144
    v_add_f32 v145, 1.0, v145
    v_add_f32 v146, 1.0, v146
    v_add_f32 v147, 1.0, v147
    v_rcp_f32 v140, v140
    v_rcp_f32 v141, v141
    v_rcp_f32 v142, v142
    v_rcp_f32 v143, v143
    v_rcp_f32 v144, v144
    v_rcp_f32 v145, v145
    v_rcp_f32 v146, v146
    v_rcp_f32 v147, v147
    v_mul_f32 v72, v72, v140
    v_mul_f32 v73, v73, v141
    v_mul_f32 v74, v74, v142
    v_mul_f32 v75, v75, v143
    v_mul_f32 v76, v76, v144
    v_mul_f32 v77, v77, v145
    v_mul_f32 v78, v78, v146
    v_mul_f32 v79, v79, v147
    v_cvt_pk_bf16_f32 v196, v8, v9
    v_cvt_pk_bf16_f32 v197, v10, v11
    v_cvt_pk_bf16_f32 v198, v12, v13
    v_cvt_pk_bf16_f32 v199, v14, v15
    v_cvt_pk_bf16_f32 v200, v16, v17
    v_cvt_pk_bf16_f32 v201, v18, v19
    v_cvt_pk_bf16_f32 v202, v20, v21
    v_cvt_pk_bf16_f32 v203, v22, v23
    v_cvt_pk_bf16_f32 v204, v24, v25
    v_cvt_pk_bf16_f32 v205, v26, v27
    v_cvt_pk_bf16_f32 v206, v28, v29
    v_cvt_pk_bf16_f32 v207, v30, v31
    v_cvt_pk_bf16_f32 v208, v32, v33
    v_cvt_pk_bf16_f32 v209, v34, v35
    v_cvt_pk_bf16_f32 v210, v36, v37
    v_cvt_pk_bf16_f32 v211, v38, v39
    v_cvt_pk_bf16_f32 v212, v40, v41
    v_cvt_pk_bf16_f32 v213, v42, v43
    v_cvt_pk_bf16_f32 v214, v44, v45
    v_cvt_pk_bf16_f32 v215, v46, v47
    v_cvt_pk_bf16_f32 v216, v48, v49
    v_cvt_pk_bf16_f32 v217, v50, v51
    v_cvt_pk_bf16_f32 v218, v52, v53
    v_cvt_pk_bf16_f32 v219, v54, v55
    v_cvt_pk_bf16_f32 v220, v56, v57
    v_cvt_pk_bf16_f32 v221, v58, v59
    v_cvt_pk_bf16_f32 v222, v60, v61
    v_cvt_pk_bf16_f32 v223, v62, v63
    v_cvt_pk_bf16_f32 v224, v64, v65
    v_cvt_pk_bf16_f32 v225, v66, v67
    v_cvt_pk_bf16_f32 v226, v68, v69
    v_cvt_pk_bf16_f32 v227, v70, v71
    v_cvt_pk_bf16_f32 v228, v72, v73
    v_cvt_pk_bf16_f32 v229, v74, v75
    v_cvt_pk_bf16_f32 v230, v76, v77
    v_cvt_pk_bf16_f32 v231, v78, v79
    v_mov_b32 v8, 0
    v_mov_b32 v9, 0
    v_mov_b32 v10, 0
    v_mov_b32 v11, 0
    v_mov_b32 v12, 0
    v_mov_b32 v13, 0
    v_mov_b32 v14, 0
    v_mov_b32 v15, 0
    v_mov_b32 v16, 0
    v_mov_b32 v17, 0
    v_mov_b32 v18, 0
    v_mov_b32 v19, 0
    v_mov_b32 v20, 0
    v_mov_b32 v21, 0
    v_mov_b32 v22, 0
    v_mov_b32 v23, 0
    v_mov_b32 v24, 0
    v_mov_b32 v25, 0
    v_mov_b32 v26, 0
    v_mov_b32 v27, 0
    v_mov_b32 v28, 0
    v_mov_b32 v29, 0
    v_mov_b32 v30, 0
    v_mov_b32 v31, 0
    v_mov_b32 v32, 0
    v_mov_b32 v33, 0
    v_mov_b32 v34, 0
    v_mov_b32 v35, 0
    v_mov_b32 v36, 0
    v_mov_b32 v37, 0
    v_mov_b32 v38, 0
    v_mov_b32 v39, 0
    v_mov_b32 v40, 0
    v_mov_b32 v41, 0
    v_mov_b32 v42, 0
    v_mov_b32 v43, 0
    v_mov_b32 v44, 0
    v_mov_b32 v45, 0
    v_mov_b32 v46, 0
    v_mov_b32 v47, 0
    v_mov_b32 v48, 0
    v_mov_b32 v49, 0
    v_mov_b32 v50, 0
    v_mov_b32 v51, 0
    v_mov_b32 v52, 0
    v_mov_b32 v53, 0
    v_mov_b32 v54, 0
    v_mov_b32 v55, 0
    v_mov_b32 v56, 0
    v_mov_b32 v57, 0
    v_mov_b32 v58, 0
    v_mov_b32 v59, 0
    v_mov_b32 v60, 0
    v_mov_b32 v61, 0
    v_mov_b32 v62, 0
    v_mov_b32 v63, 0
    v_mov_b32 v64, 0
    v_mov_b32 v65, 0
    v_mov_b32 v66, 0
    v_mov_b32 v67, 0
    v_mov_b32 v68, 0
    v_mov_b32 v69, 0
    v_mov_b32 v70, 0
    v_mov_b32 v71, 0
    v_mov_b32 v72, 0
    v_mov_b32 v73, 0
    v_mov_b32 v74, 0
    v_mov_b32 v75, 0
    v_mov_b32 v76, 0
    v_mov_b32 v77, 0
    v_mov_b32 v78, 0
    v_mov_b32 v79, 0
    s_setprio 1
    s_waitcnt vmcnt(6)
    s_barrier
    ds_read_b128 v[152:155], v191 offset:0
    ds_read_b128 v[156:159], v191 offset:2048
    ds_read_b128 v[160:163], v192 offset:0
    ds_read_b128 v[164:167], v192 offset:2048
    ds_read_b128 v[80:83], v193 offset:0
    ds_read_b128 v[84:87], v193 offset:256
    ds_read_b128 v[88:91], v193 offset:512
    ds_read_b128 v[92:95], v193 offset:768
    ds_read_b128 v[96:99], v193 offset:1024
    ds_read_b128 v[100:103], v193 offset:1280
    ds_read_b128 v[104:107], v193 offset:1536
    ds_read_b128 v[108:111], v193 offset:1792
    ds_read_b128 v[112:115], v193 offset:2048
    s_mov_b32 s30, 15
Lk_29:
    s_waitcnt vmcnt(10) lgkmcnt(0)
    s_barrier
    v_mfma_f32_16x16x32_bf16 v[8:11], v[80:83], v[152:155], v[8:11]
    ds_read_b128 v[116:119], v193 offset:9216
    s_add_u32 m0, s28, 0
    v_mfma_f32_16x16x32_bf16 v[44:47], v[80:83], v[156:159], v[44:47]
    buffer_load_dwordx4 v188, s[12:15], s26 offen sc1 lds
    ds_read_b128 v[120:123], v193 offset:9472
    v_mfma_f32_16x16x32_bf16 v[12:15], v[84:87], v[152:155], v[12:15]
    ds_read_b128 v[124:127], v193 offset:9728
    ds_read_b128 v[128:131], v193 offset:9984
    v_mfma_f32_16x16x32_bf16 v[48:51], v[84:87], v[156:159], v[48:51]
    buffer_load_dwordx4 v189, s[12:15], s26 offen offset:1024 sc1 lds
    ds_read_b128 v[132:135], v193 offset:10240
    v_mfma_f32_16x16x32_bf16 v[16:19], v[88:91], v[152:155], v[16:19]
    ds_read_b128 v[136:139], v193 offset:10496
    ds_read_b128 v[140:143], v193 offset:10752
    v_mfma_f32_16x16x32_bf16 v[52:55], v[88:91], v[156:159], v[52:55]
    buffer_load_dword v190, s[12:15], s26 offen offset:2048 sc1 lds
    s_add_u32 s26, s26, 147456
    v_mfma_f32_16x16x32_bf16 v[20:23], v[92:95], v[152:155], v[20:23]
    ds_read_b128 v[144:147], v193 offset:11008
    ds_read_b128 v[148:151], v193 offset:11264
    v_mfma_f32_16x16x32_bf16 v[56:59], v[92:95], v[156:159], v[56:59]
    s_add_u32 m0, s27, 0
    v_mfma_f32_16x16x32_bf16 v[24:27], v[96:99], v[152:155], v[24:27]
    buffer_load_dwordx4 v184, s[8:11], s25 offen lds
    v_mfma_f32_16x16x32_bf16 v[60:63], v[96:99], v[156:159], v[60:63]
    v_mfma_f32_16x16x32_bf16 v[28:31], v[100:103], v[152:155], v[28:31]
    buffer_load_dwordx4 v185, s[8:11], s25 offen offset:1024 lds
    v_mfma_f32_16x16x32_bf16 v[64:67], v[100:103], v[156:159], v[64:67]
    v_mfma_f32_16x16x32_bf16 v[32:35], v[104:107], v[152:155], v[32:35]
    v_mfma_f32_16x16x32_bf16 v[68:71], v[104:107], v[156:159], v[68:71]
    buffer_load_dwordx4 v186, s[8:11], s25 offen offset:2048 lds
    v_mfma_f32_16x16x32_bf16 v[36:39], v[108:111], v[152:155], v[36:39]
    v_mfma_f32_16x16x32_bf16 v[72:75], v[108:111], v[156:159], v[72:75]
    buffer_load_dwordx4 v187, s[8:11], s25 offen offset:3072 lds
    s_add_u32 s25, s25, 128
    v_mfma_f32_16x16x32_bf16 v[40:43], v[112:115], v[152:155], v[40:43]
    v_mfma_f32_16x16x32_bf16 v[76:79], v[112:115], v[156:159], v[76:79]
    s_waitcnt vmcnt(10) lgkmcnt(0)
    s_barrier
    v_mfma_f32_16x16x32_bf16 v[8:11], v[116:119], v[160:163], v[8:11]
    ds_read_b128 v[168:171], v191 offset:4096
    s_add_u32 m0, s28, 9216
    v_mfma_f32_16x16x32_bf16 v[44:47], v[116:119], v[164:167], v[44:47]
    buffer_load_dwordx4 v188, s[12:15], s26 offen sc1 lds
    ds_read_b128 v[172:175], v191 offset:6144
    v_mfma_f32_16x16x32_bf16 v[12:15], v[120:123], v[160:163], v[12:15]
    ds_read_b128 v[176:179], v192 offset:4096
    ds_read_b128 v[180:183], v192 offset:6144
    v_mfma_f32_16x16x32_bf16 v[48:51], v[120:123], v[164:167], v[48:51]
    ds_read_b128 v[80:83], v193 offset:18432
    ds_read_b128 v[84:87], v193 offset:18688
    v_mfma_f32_16x16x32_bf16 v[16:19], v[124:127], v[160:163], v[16:19]
    ds_read_b128 v[88:91], v193 offset:18944
    ds_read_b128 v[92:95], v193 offset:19200
    v_mfma_f32_16x16x32_bf16 v[52:55], v[124:127], v[164:167], v[52:55]
    ds_read_b128 v[96:99], v193 offset:19456
    ds_read_b128 v[100:103], v193 offset:19712
    v_mfma_f32_16x16x32_bf16 v[20:23], v[128:131], v[160:163], v[20:23]
    buffer_load_dwordx4 v189, s[12:15], s26 offen offset:1024 sc1 lds
    ds_read_b128 v[104:107], v193 offset:19968
    v_mfma_f32_16x16x32_bf16 v[56:59], v[128:131], v[164:167], v[56:59]
    ds_read_b128 v[108:111], v193 offset:20224
    ds_read_b128 v[112:115], v193 offset:20480
    v_mfma_f32_16x16x32_bf16 v[24:27], v[132:135], v[160:163], v[24:27]
    v_mfma_f32_16x16x32_bf16 v[60:63], v[132:135], v[164:167], v[60:63]
    v_mfma_f32_16x16x32_bf16 v[28:31], v[136:139], v[160:163], v[28:31]
    v_mfma_f32_16x16x32_bf16 v[64:67], v[136:139], v[164:167], v[64:67]
    v_mfma_f32_16x16x32_bf16 v[32:35], v[140:143], v[160:163], v[32:35]
    buffer_load_dword v190, s[12:15], s26 offen offset:2048 sc1 lds
    s_add_u32 s26, s26, 147456
    v_mfma_f32_16x16x32_bf16 v[68:71], v[140:143], v[164:167], v[68:71]
    v_mfma_f32_16x16x32_bf16 v[36:39], v[144:147], v[160:163], v[36:39]
    v_mfma_f32_16x16x32_bf16 v[72:75], v[144:147], v[164:167], v[72:75]
    v_mfma_f32_16x16x32_bf16 v[40:43], v[148:151], v[160:163], v[40:43]
    v_mfma_f32_16x16x32_bf16 v[76:79], v[148:151], v[164:167], v[76:79]
    s_waitcnt vmcnt(10) lgkmcnt(0)
    s_barrier
    v_mfma_f32_16x16x32_bf16 v[8:11], v[80:83], v[168:171], v[8:11]
    ds_read_b128 v[116:119], v193 offset:27648
    s_add_u32 m0, s28, 18432
    v_mfma_f32_16x16x32_bf16 v[44:47], v[80:83], v[172:175], v[44:47]
    buffer_load_dwordx4 v188, s[12:15], s26 offen sc1 lds
    ds_read_b128 v[120:123], v193 offset:27904
    v_mfma_f32_16x16x32_bf16 v[12:15], v[84:87], v[168:171], v[12:15]
    ds_read_b128 v[124:127], v193 offset:28160
    ds_read_b128 v[128:131], v193 offset:28416
    v_mfma_f32_16x16x32_bf16 v[48:51], v[84:87], v[172:175], v[48:51]
    buffer_load_dwordx4 v189, s[12:15], s26 offen offset:1024 sc1 lds
    ds_read_b128 v[132:135], v193 offset:28672
    v_mfma_f32_16x16x32_bf16 v[16:19], v[88:91], v[168:171], v[16:19]
    ds_read_b128 v[136:139], v193 offset:28928
    ds_read_b128 v[140:143], v193 offset:29184
    v_mfma_f32_16x16x32_bf16 v[52:55], v[88:91], v[172:175], v[52:55]
    buffer_load_dword v190, s[12:15], s26 offen offset:2048 sc1 lds
    s_add_u32 s26, s26, 147456
    v_mfma_f32_16x16x32_bf16 v[20:23], v[92:95], v[168:171], v[20:23]
    ds_read_b128 v[144:147], v193 offset:29440
    ds_read_b128 v[148:151], v193 offset:29696
    v_mfma_f32_16x16x32_bf16 v[56:59], v[92:95], v[172:175], v[56:59]
    s_add_u32 m0, s27, 4096
    v_mfma_f32_16x16x32_bf16 v[24:27], v[96:99], v[168:171], v[24:27]
    buffer_load_dwordx4 v184, s[8:11], s25 offen lds
    v_mfma_f32_16x16x32_bf16 v[60:63], v[96:99], v[172:175], v[60:63]
    v_mfma_f32_16x16x32_bf16 v[28:31], v[100:103], v[168:171], v[28:31]
    buffer_load_dwordx4 v185, s[8:11], s25 offen offset:1024 lds
    v_mfma_f32_16x16x32_bf16 v[64:67], v[100:103], v[172:175], v[64:67]
    v_mfma_f32_16x16x32_bf16 v[32:35], v[104:107], v[168:171], v[32:35]
    v_mfma_f32_16x16x32_bf16 v[68:71], v[104:107], v[172:175], v[68:71]
    buffer_load_dwordx4 v186, s[8:11], s25 offen offset:2048 lds
    v_mfma_f32_16x16x32_bf16 v[36:39], v[108:111], v[168:171], v[36:39]
    v_mfma_f32_16x16x32_bf16 v[72:75], v[108:111], v[172:175], v[72:75]
    buffer_load_dwordx4 v187, s[8:11], s25 offen offset:3072 lds
    s_add_u32 s25, s25, 128
    v_mfma_f32_16x16x32_bf16 v[40:43], v[112:115], v[168:171], v[40:43]
    v_mfma_f32_16x16x32_bf16 v[76:79], v[112:115], v[172:175], v[76:79]
    s_waitcnt vmcnt(10) lgkmcnt(0)
    s_barrier
    v_mfma_f32_16x16x32_bf16 v[8:11], v[116:119], v[176:179], v[8:11]
    ds_read_b128 v[152:155], v191 offset:0
    s_add_u32 m0, s28, 27648
    v_mfma_f32_16x16x32_bf16 v[44:47], v[116:119], v[180:183], v[44:47]
    buffer_load_dwordx4 v188, s[12:15], s26 offen sc1 lds
    ds_read_b128 v[156:159], v191 offset:2048
    v_mfma_f32_16x16x32_bf16 v[12:15], v[120:123], v[176:179], v[12:15]
    ds_read_b128 v[160:163], v192 offset:0
    ds_read_b128 v[164:167], v192 offset:2048
    v_mfma_f32_16x16x32_bf16 v[48:51], v[120:123], v[180:183], v[48:51]
    ds_read_b128 v[80:83], v193 offset:0
    ds_read_b128 v[84:87], v193 offset:256
    v_mfma_f32_16x16x32_bf16 v[16:19], v[124:127], v[176:179], v[16:19]
    ds_read_b128 v[88:91], v193 offset:512
    ds_read_b128 v[92:95], v193 offset:768
    v_mfma_f32_16x16x32_bf16 v[52:55], v[124:127], v[180:183], v[52:55]
    ds_read_b128 v[96:99], v193 offset:1024
    ds_read_b128 v[100:103], v193 offset:1280
    v_mfma_f32_16x16x32_bf16 v[20:23], v[128:131], v[176:179], v[20:23]
    buffer_load_dwordx4 v189, s[12:15], s26 offen offset:1024 sc1 lds
    ds_read_b128 v[104:107], v193 offset:1536
    v_mfma_f32_16x16x32_bf16 v[56:59], v[128:131], v[180:183], v[56:59]
    ds_read_b128 v[108:111], v193 offset:1792
    ds_read_b128 v[112:115], v193 offset:2048
    v_mfma_f32_16x16x32_bf16 v[24:27], v[132:135], v[176:179], v[24:27]
    v_mfma_f32_16x16x32_bf16 v[60:63], v[132:135], v[180:183], v[60:63]
    v_mfma_f32_16x16x32_bf16 v[28:31], v[136:139], v[176:179], v[28:31]
    v_mfma_f32_16x16x32_bf16 v[64:67], v[136:139], v[180:183], v[64:67]
    v_mfma_f32_16x16x32_bf16 v[32:35], v[140:143], v[176:179], v[32:35]
    buffer_load_dword v190, s[12:15], s26 offen offset:2048 sc1 lds
    s_add_u32 s26, s26, 147456
    v_mfma_f32_16x16x32_bf16 v[68:71], v[140:143], v[180:183], v[68:71]
    v_mfma_f32_16x16x32_bf16 v[36:39], v[144:147], v[176:179], v[36:39]
    v_mfma_f32_16x16x32_bf16 v[72:75], v[144:147], v[180:183], v[72:75]
    v_mfma_f32_16x16x32_bf16 v[40:43], v[148:151], v[176:179], v[40:43]
    v_mfma_f32_16x16x32_bf16 v[76:79], v[148:151], v[180:183], v[76:79]
    s_sub_u32 s30, s30, 1
    s_cmp_lg_u32 s30, 0
    s_cbranch_scc1 Lk_29
    s_waitcnt vmcnt(10) lgkmcnt(0)
    s_barrier
    v_mfma_f32_16x16x32_bf16 v[8:11], v[80:83], v[152:155], v[8:11]
    ds_read_b128 v[116:119], v193 offset:9216
    ds_read_b128 v[120:123], v193 offset:9472
    v_mfma_f32_16x16x32_bf16 v[44:47], v[80:83], v[156:159], v[44:47]
    ds_read_b128 v[124:127], v193 offset:9728
    ds_read_b128 v[128:131], v193 offset:9984
    v_mfma_f32_16x16x32_bf16 v[12:15], v[84:87], v[152:155], v[12:15]
    ds_read_b128 v[132:135], v193 offset:10240
    ds_read_b128 v[136:139], v193 offset:10496
    v_mfma_f32_16x16x32_bf16 v[48:51], v[84:87], v[156:159], v[48:51]
    ds_read_b128 v[140:143], v193 offset:10752
    ds_read_b128 v[144:147], v193 offset:11008
    v_mfma_f32_16x16x32_bf16 v[16:19], v[88:91], v[152:155], v[16:19]
    ds_read_b128 v[148:151], v193 offset:11264
    v_mfma_f32_16x16x32_bf16 v[52:55], v[88:91], v[156:159], v[52:55]
    v_mfma_f32_16x16x32_bf16 v[20:23], v[92:95], v[152:155], v[20:23]
    v_mfma_f32_16x16x32_bf16 v[56:59], v[92:95], v[156:159], v[56:59]
    v_mfma_f32_16x16x32_bf16 v[24:27], v[96:99], v[152:155], v[24:27]
    v_mfma_f32_16x16x32_bf16 v[60:63], v[96:99], v[156:159], v[60:63]
    v_mfma_f32_16x16x32_bf16 v[28:31], v[100:103], v[152:155], v[28:31]
    v_mfma_f32_16x16x32_bf16 v[64:67], v[100:103], v[156:159], v[64:67]
    v_mfma_f32_16x16x32_bf16 v[32:35], v[104:107], v[152:155], v[32:35]
    v_mfma_f32_16x16x32_bf16 v[68:71], v[104:107], v[156:159], v[68:71]
    v_mfma_f32_16x16x32_bf16 v[36:39], v[108:111], v[152:155], v[36:39]
    v_mfma_f32_16x16x32_bf16 v[72:75], v[108:111], v[156:159], v[72:75]
    v_mfma_f32_16x16x32_bf16 v[40:43], v[112:115], v[152:155], v[40:43]
    v_mfma_f32_16x16x32_bf16 v[76:79], v[112:115], v[156:159], v[76:79]
    s_waitcnt vmcnt(3) lgkmcnt(0)
    s_barrier
    v_mfma_f32_16x16x32_bf16 v[8:11], v[116:119], v[160:163], v[8:11]
    ds_read_b128 v[168:171], v191 offset:4096
    ds_read_b128 v[172:175], v191 offset:6144
    v_mfma_f32_16x16x32_bf16 v[44:47], v[116:119], v[164:167], v[44:47]
    ds_read_b128 v[176:179], v192 offset:4096
    ds_read_b128 v[180:183], v192 offset:6144
    v_mfma_f32_16x16x32_bf16 v[12:15], v[120:123], v[160:163], v[12:15]
    ds_read_b128 v[80:83], v193 offset:18432
    ds_read_b128 v[84:87], v193 offset:18688
    v_mfma_f32_16x16x32_bf16 v[48:51], v[120:123], v[164:167], v[48:51]
    ds_read_b128 v[88:91], v193 offset:18944
    ds_read_b128 v[92:95], v193 offset:19200
    v_mfma_f32_16x16x32_bf16 v[16:19], v[124:127], v[160:163], v[16:19]
    ds_read_b128 v[96:99], v193 offset:19456
    ds_read_b128 v[100:103], v193 offset:19712
    v_mfma_f32_16x16x32_bf16 v[52:55], v[124:127], v[164:167], v[52:55]
    ds_read_b128 v[104:107], v193 offset:19968
    ds_read_b128 v[108:111], v193 offset:20224
    v_mfma_f32_16x16x32_bf16 v[20:23], v[128:131], v[160:163], v[20:23]
    ds_read_b128 v[112:115], v193 offset:20480
    v_mfma_f32_16x16x32_bf16 v[56:59], v[128:131], v[164:167], v[56:59]
    v_mfma_f32_16x16x32_bf16 v[24:27], v[132:135], v[160:163], v[24:27]
    v_mfma_f32_16x16x32_bf16 v[60:63], v[132:135], v[164:167], v[60:63]
    v_mfma_f32_16x16x32_bf16 v[28:31], v[136:139], v[160:163], v[28:31]
    v_mfma_f32_16x16x32_bf16 v[64:67], v[136:139], v[164:167], v[64:67]
    v_mfma_f32_16x16x32_bf16 v[32:35], v[140:143], v[160:163], v[32:35]
    v_mfma_f32_16x16x32_bf16 v[68:71], v[140:143], v[164:167], v[68:71]
    v_mfma_f32_16x16x32_bf16 v[36:39], v[144:147], v[160:163], v[36:39]
    v_mfma_f32_16x16x32_bf16 v[72:75], v[144:147], v[164:167], v[72:75]
    v_mfma_f32_16x16x32_bf16 v[40:43], v[148:151], v[160:163], v[40:43]
    v_mfma_f32_16x16x32_bf16 v[76:79], v[148:151], v[164:167], v[76:79]
    s_waitcnt vmcnt(0) lgkmcnt(0)
    s_barrier
    v_mfma_f32_16x16x32_bf16 v[8:11], v[80:83], v[168:171], v[8:11]
    ds_read_b128 v[116:119], v193 offset:27648
    ds_read_b128 v[120:123], v193 offset:27904
    v_mfma_f32_16x16x32_bf16 v[44:47], v[80:83], v[172:175], v[44:47]
    ds_read_b128 v[124:127], v193 offset:28160
    ds_read_b128 v[128:131], v193 offset:28416
    v_mfma_f32_16x16x32_bf16 v[12:15], v[84:87], v[168:171], v[12:15]
    ds_read_b128 v[132:135], v193 offset:28672
    ds_read_b128 v[136:139], v193 offset:28928
    v_mfma_f32_16x16x32_bf16 v[48:51], v[84:87], v[172:175], v[48:51]
    ds_read_b128 v[140:143], v193 offset:29184
    ds_read_b128 v[144:147], v193 offset:29440
    v_mfma_f32_16x16x32_bf16 v[16:19], v[88:91], v[168:171], v[16:19]
    ds_read_b128 v[148:151], v193 offset:29696
    v_mfma_f32_16x16x32_bf16 v[52:55], v[88:91], v[172:175], v[52:55]
    v_mfma_f32_16x16x32_bf16 v[20:23], v[92:95], v[168:171], v[20:23]
    v_mfma_f32_16x16x32_bf16 v[56:59], v[92:95], v[172:175], v[56:59]
    v_mfma_f32_16x16x32_bf16 v[24:27], v[96:99], v[168:171], v[24:27]
    v_mfma_f32_16x16x32_bf16 v[60:63], v[96:99], v[172:175], v[60:63]
    v_mfma_f32_16x16x32_bf16 v[28:31], v[100:103], v[168:171], v[28:31]
    v_mfma_f32_16x16x32_bf16 v[64:67], v[100:103], v[172:175], v[64:67]
    v_mfma_f32_16x16x32_bf16 v[32:35], v[104:107], v[168:171], v[32:35]
    v_mfma_f32_16x16x32_bf16 v[68:71], v[104:107], v[172:175], v[68:71]
    v_mfma_f32_16x16x32_bf16 v[36:39], v[108:111], v[168:171], v[36:39]
    v_mfma_f32_16x16x32_bf16 v[72:75], v[108:111], v[172:175], v[72:75]
    v_mfma_f32_16x16x32_bf16 v[40:43], v[112:115], v[168:171], v[40:43]
    v_mfma_f32_16x16x32_bf16 v[76:79], v[112:115], v[172:175], v[76:79]
    s_waitcnt vmcnt(0) lgkmcnt(0)
    s_barrier
    v_mfma_f32_16x16x32_bf16 v[8:11], v[116:119], v[176:179], v[8:11]
    v_mfma_f32_16x16x32_bf16 v[44:47], v[116:119], v[180:183], v[44:47]
    v_mfma_f32_16x16x32_bf16 v[12:15], v[120:123], v[176:179], v[12:15]
    v_mfma_f32_16x16x32_bf16 v[48:51], v[120:123], v[180:183], v[48:51]
    v_mfma_f32_16x16x32_bf16 v[16:19], v[124:127], v[176:179], v[16:19]
    v_mfma_f32_16x16x32_bf16 v[52:55], v[124:127], v[180:183], v[52:55]
    v_mfma_f32_16x16x32_bf16 v[20:23], v[128:131], v[176:179], v[20:23]
    v_mfma_f32_16x16x32_bf16 v[56:59], v[128:131], v[180:183], v[56:59]
    v_mfma_f32_16x16x32_bf16 v[24:27], v[132:135], v[176:179], v[24:27]
    v_mfma_f32_16x16x32_bf16 v[60:63], v[132:135], v[180:183], v[60:63]
    v_mfma_f32_16x16x32_bf16 v[28:31], v[136:139], v[176:179], v[28:31]
    v_mfma_f32_16x16x32_bf16 v[64:67], v[136:139], v[180:183], v[64:67]
    v_mfma_f32_16x16x32_bf16 v[32:35], v[140:143], v[176:179], v[32:35]
    v_mfma_f32_16x16x32_bf16 v[68:71], v[140:143], v[180:183], v[68:71]
    v_mfma_f32_16x16x32_bf16 v[36:39], v[144:147], v[176:179], v[36:39]
    v_mfma_f32_16x16x32_bf16 v[72:75], v[144:147], v[180:183], v[72:75]
    v_mfma_f32_16x16x32_bf16 v[40:43], v[148:151], v[176:179], v[40:43]
    v_mfma_f32_16x16x32_bf16 v[76:79], v[148:151], v[180:183], v[76:79]
    v_and_b32 v2, 63, v0
    v_and_b32 v3, 15, v2
    s_lshl_b32 s4, s24, 5
    v_add_u32 v3, s4, v3
    v_lshlrev_b32 v3, 4, v3
    v_lshrrev_b32 v4, 5, v2
    v_lshl_add_u32 v3, v4, 15, v3
    v_bfe_u32 v4, v2, 4, 1
    v_lshl_add_u32 v80, v4, 16, v3
    v_lshl_add_u32 v81, v4, 3, v3
    s_add_u32 s16, s84, 26214400
    s_addc_u32 s17, s85, 0
    s_and_b32 s17, s17, 0xffff
    s_mov_b32 s18, 11796480
    s_mov_b32 s19, 0x20000
    v_sub_f32 v232, 1.0, v232
    v_lshlrev_b32 v234, 16, v234
    v_mul_f32 v234, v234, v232
    v_lshlrev_b32 v84, 16, v196
    v_and_b32 v85, 0xffff0000, v196
    v_lshlrev_b32 v86, 16, v197
    v_and_b32 v87, 0xffff0000, v197
    v_fma_f32 v8, v8, v232, v234
    v_fma_f32 v9, v9, v232, v234
    v_fma_f32 v10, v10, v232, v234
    v_fma_f32 v11, v11, v232, v234
    v_mul_f32 v8, v8, v84
    v_mul_f32 v9, v9, v85
    v_mul_f32 v10, v10, v86
    v_mul_f32 v11, v11, v87
    v_lshlrev_b32 v88, 16, v198
    v_and_b32 v89, 0xffff0000, v198
    v_lshlrev_b32 v90, 16, v199
    v_and_b32 v91, 0xffff0000, v199
    v_fma_f32 v12, v12, v232, v234
    v_fma_f32 v13, v13, v232, v234
    v_fma_f32 v14, v14, v232, v234
    v_fma_f32 v15, v15, v232, v234
    v_mul_f32 v12, v12, v88
    v_mul_f32 v13, v13, v89
    v_mul_f32 v14, v14, v90
    v_mul_f32 v15, v15, v91
    v_lshlrev_b32 v84, 16, v200
    v_and_b32 v85, 0xffff0000, v200
    v_lshlrev_b32 v86, 16, v201
    v_and_b32 v87, 0xffff0000, v201
    v_fma_f32 v16, v16, v232, v234
    v_fma_f32 v17, v17, v232, v234
    v_fma_f32 v18, v18, v232, v234
    v_fma_f32 v19, v19, v232, v234
    v_mul_f32 v16, v16, v84
    v_mul_f32 v17, v17, v85
    v_mul_f32 v18, v18, v86
    v_mul_f32 v19, v19, v87
    v_lshlrev_b32 v88, 16, v202
    v_and_b32 v89, 0xffff0000, v202
    v_lshlrev_b32 v90, 16, v203
    v_and_b32 v91, 0xffff0000, v203
    v_fma_f32 v20, v20, v232, v234
    v_fma_f32 v21, v21, v232, v234
    v_fma_f32 v22, v22, v232, v234
    v_fma_f32 v23, v23, v232, v234
    v_mul_f32 v20, v20, v88
    v_mul_f32 v21, v21, v89
    v_mul_f32 v22, v22, v90
    v_mul_f32 v23, v23, v91
    v_lshlrev_b32 v84, 16, v204
    v_and_b32 v85, 0xffff0000, v204
    v_lshlrev_b32 v86, 16, v205
    v_and_b32 v87, 0xffff0000, v205
    v_fma_f32 v24, v24, v232, v234
    v_fma_f32 v25, v25, v232, v234
    v_fma_f32 v26, v26, v232, v234
    v_fma_f32 v27, v27, v232, v234
    v_mul_f32 v24, v24, v84
    v_mul_f32 v25, v25, v85
    v_mul_f32 v26, v26, v86
    v_mul_f32 v27, v27, v87
    v_lshlrev_b32 v88, 16, v206
    v_and_b32 v89, 0xffff0000, v206
    v_lshlrev_b32 v90, 16, v207
    v_and_b32 v91, 0xffff0000, v207
    v_fma_f32 v28, v28, v232, v234
    v_fma_f32 v29, v29, v232, v234
    v_fma_f32 v30, v30, v232, v234
    v_fma_f32 v31, v31, v232, v234
    v_mul_f32 v28, v28, v88
    v_mul_f32 v29, v29, v89
    v_mul_f32 v30, v30, v90
    v_mul_f32 v31, v31, v91
    v_lshlrev_b32 v84, 16, v208
    v_and_b32 v85, 0xffff0000, v208
    v_lshlrev_b32 v86, 16, v209
    v_and_b32 v87, 0xffff0000, v209
    v_fma_f32 v32, v32, v232, v234
    v_fma_f32 v33, v33, v232, v234
    v_fma_f32 v34, v34, v232, v234
    v_fma_f32 v35, v35, v232, v234
    v_mul_f32 v32, v32, v84
    v_mul_f32 v33, v33, v85
    v_mul_f32 v34, v34, v86
    v_mul_f32 v35, v35, v87
    v_lshlrev_b32 v88, 16, v210
    v_and_b32 v89, 0xffff0000, v210
    v_lshlrev_b32 v90, 16, v211
    v_and_b32 v91, 0xffff0000, v211
    v_fma_f32 v36, v36, v232, v234
    v_fma_f32 v37, v37, v232, v234
    v_fma_f32 v38, v38, v232, v234
    v_fma_f32 v39, v39, v232, v234
    v_mul_f32 v36, v36, v88
    v_mul_f32 v37, v37, v89
    v_mul_f32 v38, v38, v90
    v_mul_f32 v39, v39, v91
    v_lshlrev_b32 v84, 16, v212
    v_and_b32 v85, 0xffff0000, v212
    v_lshlrev_b32 v86, 16, v213
    v_and_b32 v87, 0xffff0000, v213
    v_fma_f32 v40, v40, v232, v234
    v_fma_f32 v41, v41, v232, v234
    v_fma_f32 v42, v42, v232, v234
    v_fma_f32 v43, v43, v232, v234
    v_mul_f32 v40, v40, v84
    v_mul_f32 v41, v41, v85
    v_mul_f32 v42, v42, v86
    v_mul_f32 v43, v43, v87
    v_sub_f32 v236, 1.0, v236
    v_lshlrev_b32 v238, 16, v238
    v_mul_f32 v238, v238, v236
    v_lshlrev_b32 v84, 16, v214
    v_and_b32 v85, 0xffff0000, v214
    v_lshlrev_b32 v86, 16, v215
    v_and_b32 v87, 0xffff0000, v215
    v_fma_f32 v44, v44, v236, v238
    v_fma_f32 v45, v45, v236, v238
    v_fma_f32 v46, v46, v236, v238
    v_fma_f32 v47, v47, v236, v238
    v_mul_f32 v44, v44, v84
    v_mul_f32 v45, v45, v85
    v_mul_f32 v46, v46, v86
    v_mul_f32 v47, v47, v87
    v_lshlrev_b32 v88, 16, v216
    v_and_b32 v89, 0xffff0000, v216
    v_lshlrev_b32 v90, 16, v217
    v_and_b32 v91, 0xffff0000, v217
    v_fma_f32 v48, v48, v236, v238
    v_fma_f32 v49, v49, v236, v238
    v_fma_f32 v50, v50, v236, v238
    v_fma_f32 v51, v51, v236, v238
    v_mul_f32 v48, v48, v88
    v_mul_f32 v49, v49, v89
    v_mul_f32 v50, v50, v90
    v_mul_f32 v51, v51, v91
    v_lshlrev_b32 v84, 16, v218
    v_and_b32 v85, 0xffff0000, v218
    v_lshlrev_b32 v86, 16, v219
    v_and_b32 v87, 0xffff0000, v219
    v_fma_f32 v52, v52, v236, v238
    v_fma_f32 v53, v53, v236, v238
    v_fma_f32 v54, v54, v236, v238
    v_fma_f32 v55, v55, v236, v238
    v_mul_f32 v52, v52, v84
    v_mul_f32 v53, v53, v85
    v_mul_f32 v54, v54, v86
    v_mul_f32 v55, v55, v87
    v_lshlrev_b32 v88, 16, v220
    v_and_b32 v89, 0xffff0000, v220
    v_lshlrev_b32 v90, 16, v221
    v_and_b32 v91, 0xffff0000, v221
    v_fma_f32 v56, v56, v236, v238
    v_fma_f32 v57, v57, v236, v238
    v_fma_f32 v58, v58, v236, v238
    v_fma_f32 v59, v59, v236, v238
    v_mul_f32 v56, v56, v88
    v_mul_f32 v57, v57, v89
    v_mul_f32 v58, v58, v90
    v_mul_f32 v59, v59, v91
    v_lshlrev_b32 v84, 16, v222
    v_and_b32 v85, 0xffff0000, v222
    v_lshlrev_b32 v86, 16, v223
    v_and_b32 v87, 0xffff0000, v223
    v_fma_f32 v60, v60, v236, v238
    v_fma_f32 v61, v61, v236, v238
    v_fma_f32 v62, v62, v236, v238
    v_fma_f32 v63, v63, v236, v238
    v_mul_f32 v60, v60, v84
    v_mul_f32 v61, v61, v85
    v_mul_f32 v62, v62, v86
    v_mul_f32 v63, v63, v87
    v_lshlrev_b32 v88, 16, v224
    v_and_b32 v89, 0xffff0000, v224
    v_lshlrev_b32 v90, 16, v225
    v_and_b32 v91, 0xffff0000, v225
    v_fma_f32 v64, v64, v236, v238
    v_fma_f32 v65, v65, v236, v238
    v_fma_f32 v66, v66, v236, v238
    v_fma_f32 v67, v67, v236, v238
    v_mul_f32 v64, v64, v88
    v_mul_f32 v65, v65, v89
    v_mul_f32 v66, v66, v90
    v_mul_f32 v67, v67, v91
    v_lshlrev_b32 v84, 16, v226
    v_and_b32 v85, 0xffff0000, v226
    v_lshlrev_b32 v86, 16, v227
    v_and_b32 v87, 0xffff0000, v227
    v_fma_f32 v68, v68, v236, v238
    v_fma_f32 v69, v69, v236, v238
    v_fma_f32 v70, v70, v236, v238
    v_fma_f32 v71, v71, v236, v238
    v_mul_f32 v68, v68, v84
    v_mul_f32 v69, v69, v85
    v_mul_f32 v70, v70, v86
    v_mul_f32 v71, v71, v87
    v_lshlrev_b32 v88, 16, v228
    v_and_b32 v89, 0xffff0000, v228
    v_lshlrev_b32 v90, 16, v229
    v_and_b32 v91, 0xffff0000, v229
    v_fma_f32 v72, v72, v236, v238
    v_fma_f32 v73, v73, v236, v238
    v_fma_f32 v74, v74, v236, v238
    v_fma_f32 v75, v75, v236, v238
    v_mul_f32 v72, v72, v88
    v_mul_f32 v73, v73, v89
    v_mul_f32 v74, v74, v90
    v_mul_f32 v75, v75, v91
    v_lshlrev_b32 v84, 16, v230
    v_and_b32 v85, 0xffff0000, v230
    v_lshlrev_b32 v86, 16, v231
    v_and_b32 v87, 0xffff0000, v231
    v_fma_f32 v76, v76, v236, v238
    v_fma_f32 v77, v77, v236, v238
    v_fma_f32 v78, v78, v236, v238
    v_fma_f32 v79, v79, v236, v238
    v_mul_f32 v76, v76, v84
    v_mul_f32 v77, v77, v85
    v_mul_f32 v78, v78, v86
    v_mul_f32 v79, v79, v87
    s_mul_i32 s48, s47, 589824
    s_add_u32 s48, s48, 2359296
    s_lshl_b32 s49, s46, 11
    s_add_u32 s48, s48, s49
    v_cvt_pk_bf16_f32 v92, v8, v9
    v_cvt_pk_bf16_f32 v93, v10, v11
    v_cvt_pk_bf16_f32 v94, v12, v13
    v_cvt_pk_bf16_f32 v95, v14, v15
    s_nop 1
    v_permlane16_swap_b32 v92, v94
    v_permlane16_swap_b32 v93, v95
    buffer_store_dwordx4 v[92:95], v80, s[16:19], s48 offen offset:0 sc1
    v_cvt_pk_bf16_f32 v96, v44, v45
    v_cvt_pk_bf16_f32 v97, v46, v47
    v_cvt_pk_bf16_f32 v98, v48, v49
    v_cvt_pk_bf16_f32 v99, v50, v51
    s_nop 1
    v_permlane16_swap_b32 v96, v98
    v_permlane16_swap_b32 v97, v99
    buffer_store_dwordx4 v[96:99], v80, s[16:19], s48 offen offset:256 sc1
    s_add_u32 s48, s48, 131072
    v_cvt_pk_bf16_f32 v92, v16, v17
    v_cvt_pk_bf16_f32 v93, v18, v19
    v_cvt_pk_bf16_f32 v94, v20, v21
    v_cvt_pk_bf16_f32 v95, v22, v23
    s_nop 1
    v_permlane16_swap_b32 v92, v94
    v_permlane16_swap_b32 v93, v95
    buffer_store_dwordx4 v[92:95], v80, s[16:19], s48 offen offset:0 sc1
    v_cvt_pk_bf16_f32 v96, v52, v53
    v_cvt_pk_bf16_f32 v97, v54, v55
    v_cvt_pk_bf16_f32 v98, v56, v57
    v_cvt_pk_bf16_f32 v99, v58, v59
    s_nop 1
    v_permlane16_swap_b32 v96, v98
    v_permlane16_swap_b32 v97, v99
    buffer_store_dwordx4 v[96:99], v80, s[16:19], s48 offen offset:256 sc1
    s_add_u32 s48, s48, 131072
    v_cvt_pk_bf16_f32 v92, v24, v25
    v_cvt_pk_bf16_f32 v93, v26, v27
    v_cvt_pk_bf16_f32 v94, v28, v29
    v_cvt_pk_bf16_f32 v95, v30, v31
    s_nop 1
    v_permlane16_swap_b32 v92, v94
    v_permlane16_swap_b32 v93, v95
    buffer_store_dwordx4 v[92:95], v80, s[16:19], s48 offen offset:0 sc1
    v_cvt_pk_bf16_f32 v96, v60, v61
    v_cvt_pk_bf16_f32 v97, v62, v63
    v_cvt_pk_bf16_f32 v98, v64, v65
    v_cvt_pk_bf16_f32 v99, v66, v67
    s_nop 1
    v_permlane16_swap_b32 v96, v98
    v_permlane16_swap_b32 v97, v99
    buffer_store_dwordx4 v[96:99], v80, s[16:19], s48 offen offset:256 sc1
    s_add_u32 s48, s48, 131072
    v_cvt_pk_bf16_f32 v92, v32, v33
    v_cvt_pk_bf16_f32 v93, v34, v35
    v_cvt_pk_bf16_f32 v94, v36, v37
    v_cvt_pk_bf16_f32 v95, v38, v39
    s_nop 1
    v_permlane16_swap_b32 v92, v94
    v_permlane16_swap_b32 v93, v95
    buffer_store_dwordx4 v[92:95], v80, s[16:19], s48 offen offset:0 sc1
    v_cvt_pk_bf16_f32 v96, v68, v69
    v_cvt_pk_bf16_f32 v97, v70, v71
    v_cvt_pk_bf16_f32 v98, v72, v73
    v_cvt_pk_bf16_f32 v99, v74, v75
    s_nop 1
    v_permlane16_swap_b32 v96, v98
    v_permlane16_swap_b32 v97, v99
    buffer_store_dwordx4 v[96:99], v80, s[16:19], s48 offen offset:256 sc1
    s_add_u32 s48, s48, 131072
    v_cvt_pk_bf16_f32 v92, v40, v41
    v_cvt_pk_bf16_f32 v93, v42, v43
    buffer_store_dwordx2 v[92:93], v81, s[16:19], s48 offen offset:0 sc1
    v_cvt_pk_bf16_f32 v96, v76, v77
    v_cvt_pk_bf16_f32 v97, v78, v79
    buffer_store_dwordx2 v[96:97], v81, s[16:19], s48 offen offset:256 sc1
    s_lshl_b32 s53, s46, 4
    s_add_u32 s53, s53, s47
    s_cmp_ge_u32 s2, 240
    s_cbranch_scc1 Lnoout_8
    s_and_b32 s4, s2, 7
    s_mul_i32 s4, s4, 30
    s_lshr_b32 s5, s2, 3
    s_add_u32 s31, s4, s5
    s_cmp_ge_u32 s31, 234
    s_cbranch_scc1 Lnoout_8
    s_mul_hi_u32 s44, s31, 477218589
    s_mul_i32 s4, s44, 9
    s_sub_u32 s45, s31, s4
    s_add_u32 s8, s84, 26214400
    s_addc_u32 s9, s85, 0
    s_and_b32 s9, s9, 0xffff
    s_mov_b32 s10, 11796480
    s_mov_b32 s11, 0x20000
    s_mov_b32 s12, s90
    s_mov_b32 s13, s91
    s_and_b32 s13, s13, 0xffff
    s_mov_b32 s14, 663552
    s_mov_b32 s15, 0x20000
    s_mov_b32 s48, s92
    s_mov_b32 s49, s93
    s_and_b32 s49, s49, 0xffff
    s_mov_b32 s50, 2654208
    s_mov_b32 s51, 0x20000
    v_and_b32 v2, 63, v0
    s_lshl_b32 s4, s24, 16
    v_add_u32 v3, 0, v2
    v_cmp_le_u32 vcc, 80, v3
    v_subrev_u32 v4, 80, v3
    s_nop 0
    v_cndmask_b32 v3, v3, v4, vcc
    v_cndmask_b32 v5, 0, 1, vcc
    v_cmp_le_u32 vcc, 80, v3
    v_subrev_u32 v4, 80, v3
    s_nop 0
    v_cndmask_b32 v3, v3, v4, vcc
    v_lshlrev_b32 v5, 15, v5
    v_lshl_add_u32 v3, v3, 4, v5
    v_add_u32 v3, s4, v3
    v_mov_b32 v104, v3
    v_add_u32 v3, 64, v2
    v_cmp_le_u32 vcc, 80, v3
    v_subrev_u32 v4, 80, v3
    s_nop 0
    v_cndmask_b32 v3, v3, v4, vcc
    v_cndmask_b32 v5, 0, 1, vcc
    v_cmp_le_u32 vcc, 80, v3
    v_subrev_u32 v4, 80, v3
    s_nop 0
    v_cndmask_b32 v3, v3, v4, vcc
    v_lshlrev_b32 v5, 15, v5
    v_lshl_add_u32 v3, v3, 4, v5
    v_add_u32 v3, s4, v3
    v_subrev_u32 v105, 1024, v3
    v_add_u32 v3, 128, v2
    v_cmp_le_u32 vcc, 80, v3
    v_subrev_u32 v4, 80, v3
    s_nop 0
    v_cndmask_b32 v3, v3, v4, vcc
    v_cndmask_b32 v5, 0, 1, vcc
    v_cmp_le_u32 vcc, 80, v3
    v_subrev_u32 v4, 80, v3
    s_nop 0
    v_cndmask_b32 v3, v3, v4, vcc
    v_lshlrev_b32 v5, 15, v5
    v_lshl_add_u32 v3, v3, 4, v5
    v_add_u32 v3, s4, v3
    v_subrev_u32 v106, 2048, v3
    v_lshrrev_b32 v3, 3, v2
    v_bfe_u32 v4, v2, 4, 1
    v_bfe_u32 v5, v2, 1, 2
    v_and_b32 v6, 1, v2
    s_mov_b32 s5, 1152
    v_or_b32 v7, 0, v4
    v_xor_b32 v7, v7, v5
    v_lshlrev_b32 v7, 5, v7
    v_lshl_add_u32 v7, v6, 4, v7
    s_lshl_b32 s6, s24, 1
    s_add_u32 s6, s6, 0
    s_mul_i32 s7, s6, 18
    v_add_u32 v108, s7, v3
    v_mul_lo_u32 v108, v108, s5
    v_add_u32 v108, v108, v7
    s_mul_i32 s7, s6, 72
    s_add_u32 s7, s7, 16
    v_lshrrev_b32 v110, 1, v3
    v_mul_u32_u24 v110, 18, v110
    v_and_b32 v112, 1, v3
    v_add3_u32 v110, v110, v112, s7
    v_mul_lo_u32 v110, v110, s5
    v_add_u32 v110, v110, v7
    s_lshl_b32 s7, s6, 3
    v_add_u32 v112, s7, v3
    v_mul_lo_u32 v112, v112, s5
    v_add_u32 v112, v112, v7
    v_or_b32 v7, 2, v4
    v_xor_b32 v7, v7, v5
    v_lshlrev_b32 v7, 5, v7
    v_lshl_add_u32 v7, v6, 4, v7
    v_subrev_u32 v7, 1024, v7
    s_lshl_b32 s6, s24, 1
    s_add_u32 s6, s6, 1
    s_mul_i32 s7, s6, 18
    v_add_u32 v109, s7, v3
    v_mul_lo_u32 v109, v109, s5
    v_add_u32 v109, v109, v7
    s_mul_i32 s7, s6, 72
    s_add_u32 s7, s7, 16
    v_lshrrev_b32 v111, 1, v3
    v_mul_u32_u24 v111, 18, v111
    v_and_b32 v113, 1, v3
    v_add3_u32 v111, v111, v113, s7
    v_mul_lo_u32 v111, v111, s5
    v_add_u32 v111, v111, v7
    s_lshl_b32 s7, s6, 3
    v_add_u32 v113, s7, v3
    v_mul_lo_u32 v113, v113, s5
    v_add_u32 v113, v113, v7
    s_and_b32 s6, s24, 1
    s_lshr_b32 s7, s24, 1
    v_lshrrev_b32 v3, 5, v2
    s_lshl_b32 s4, s7, 1
    v_add_u32 v3, s4, v3
    v_mul_u32_u24 v3, 3072, v3
    v_bfe_u32 v4, v2, 4, 1
    v_mul_u32_u24 v4, 80, v4
    v_and_b32 v5, 15, v2
    v_add_u32 v4, v4, v5
    v_lshl_add_u32 v114, v4, 4, v3
    v_lshrrev_b32 v3, 4, v2
    v_bfe_u32 v4, v2, 2, 2
    v_lshl_add_u32 v5, v3, 3, v4
    s_lshl_b32 s4, s7, 5
    v_add_u32 v5, s4, v5
    v_lshlrev_b32 v5, 7, v5
    v_and_b32 v6, 3, v2
    v_lshl_add_u32 v5, v6, 3, v5
    v_add_u32 v5, 12288, v5
    v_lshrrev_b32 v4, 1, v4
    v_and_b32 v3, 1, v3
    v_lshl_or_b32 v4, v3, 1, v4
    s_lshl_b32 s4, s6, 1
    s_add_u32 s5, s4, 0
    v_xor_b32 v3, s5, v4
    v_lshl_add_u32 v118, v3, 5, v5
    s_add_u32 s5, s4, 1
    v_xor_b32 v3, s5, v4
    v_lshl_add_u32 v119, v3, 5, v5
    s_mul_i32 s27, s24, 3072
    s_lshl_b32 s28, s24, 11
    s_add_u32 s28, s28, 12288
    s_mul_i32 s25, s44, 1280
    s_add_u32 s25, s25, 2359296
    s_lshl_b32 s52, s45, 7
    s_mul_i32 s4, s44, 80
    s_add_u32 s5, s4, 79
    s_min_u32 s5, s5, 2047
    s_lshr_b32 s6, s4, 7
    s_lshr_b32 s7, s5, 7
    v_cmp_gt_u32 vcc, 32, v2
    v_mov_b32 v3, s7
    v_mov_b32 v4, s6
    v_cndmask_b32 v3, v3, v4, vcc
    v_and_b32 v4, 15, v2
    v_lshl_add_u32 v3, v3, 4, v4
    v_lshlrev_b32 v3, 2, v3
    v_add_u32 v116, 1024, v3
    s_lshr_b32 s6, s4, 8
    s_lshr_b32 s7, s5, 8
    v_mov_b32 v3, s7
    v_mov_b32 v4, s6
    v_cndmask_b32 v3, v3, v4, vcc
    v_and_b32 v4, 31, v2
    v_lshl_add_u32 v3, v3, 5, v4
    v_lshlrev_b32 v3, 2, v3
    v_add_u32 v117, 2048, v3
    s_mov_b32 s26, s52
    s_mov_b32 s54, -1
    s_mov_b32 s55, 0
    s_add_u32 m0, s28, 0
    s_nop 0
    buffer_load_dwordx4 v112, s[48:51], s26 offen lds
    buffer_load_dwordx4 v113, s[48:51], s26 offen offset:1024 lds
    s_add_u32 s26, s26, 73728
    s_add_u32 m0, s28, 20480
    s_nop 0
    buffer_load_dwordx4 v112, s[48:51], s26 offen lds
    buffer_load_dwordx4 v113, s[48:51], s26 offen offset:1024 lds
    s_add_u32 s26, s26, 73728
    s_add_u32 m0, s28, 40960
    s_nop 0
    buffer_load_dwordx4 v112, s[48:51], s26 offen lds
    buffer_load_dwordx4 v113, s[48:51], s26 offen offset:1024 lds
    s_add_u32 s26, s26, 73728
    s_add_u32 m0, s28, 61440
    s_nop 0
    buffer_load_dwordx4 v112, s[48:51], s26 offen lds
    buffer_load_dwordx4 v113, s[48:51], s26 offen offset:1024 lds
    s_add_u32 s26, s26, 73728
    v_mov_b32 v8, 0
    v_mov_b32 v9, 0
    v_mov_b32 v10, 0
    v_mov_b32 v11, 0
    v_mov_b32 v12, 0
    v_mov_b32 v13, 0
    v_mov_b32 v14, 0
    v_mov_b32 v15, 0
    v_mov_b32 v16, 0
    v_mov_b32 v17, 0
    v_mov_b32 v18, 0
    v_mov_b32 v19, 0
    v_mov_b32 v20, 0
    v_mov_b32 v21, 0
    v_mov_b32 v22, 0
    v_mov_b32 v23, 0
    v_mov_b32 v24, 0
    v_mov_b32 v25, 0
    v_mov_b32 v26, 0
    v_mov_b32 v27, 0
    v_mov_b32 v28, 0
    v_mov_b32 v29, 0
    v_mov_b32 v30, 0
    v_mov_b32 v31, 0
    v_mov_b32 v32, 0
    v_mov_b32 v33, 0
    v_mov_b32 v34, 0
    v_mov_b32 v35, 0
    v_mov_b32 v36, 0
    v_mov_b32 v37, 0
    v_mov_b32 v38, 0
    v_mov_b32 v39, 0
    v_mov_b32 v40, 0
    v_mov_b32 v41, 0
    v_mov_b32 v42, 0
    v_mov_b32 v43, 0
    v_mov_b32 v44, 0
    v_mov_b32 v45, 0
    v_mov_b32 v46, 0
    v_mov_b32 v47, 0
    s_waitcnt vmcnt(8)
    s_barrier
    s_cmp_lg_u32 s24, 0
    s_cbranch_scc1 Lpub_30
    s_lshl_b32 s4, s53, 2
    s_add_u32 s4, s4, 1024
    v_mov_b32 v2, 1
    buffer_store_dword v2, off, s[56:59], s4 sc1
Lpub_30:
    s_mov_b32 s16, s94
    s_mov_b32 s17, s95
    s_and_b32 s17, s17, 0xffff
    s_mov_b32 s18, 2359296
    s_mov_b32 s19, 0x20000
    s_cmp_lg_u32 s24, 0
    s_cbranch_scc1 Lpolled_32
    s_mov_b32 s5, 0
Lpoll_31:
    buffer_load_dword v120, v116, s[56:59], 0 offen sc1
    s_waitcnt vmcnt(0)
    v_cmp_eq_u32 s[6:7], 0, v120
    s_add_u32 s5, s5, 1
    s_nop 1
    s_cmp_eq_u64 s[6:7], 0
    s_cbranch_scc1 Lpolled_32
    s_sleep 16
    s_cmp_lt_u32 s5, 0x100000
    s_cbranch_scc1 Lpoll_31
Lpolled_32:
    s_barrier
    s_add_u32 m0, s27, 0
    s_nop 0
    buffer_load_dwordx4 v104, s[8:11], s25 offen sc1 lds
    buffer_load_dwordx4 v105, s[8:11], s25 offen offset:1024 sc1 lds
    s_mov_b64 exec, s[54:55]
    buffer_load_dwordx4 v106, s[8:11], s25 offen offset:2048 sc1 lds
    s_mov_b64 exec, -1
    s_add_u32 s25, s25, 262144
    s_add_u32 m0, s27, 20480
    s_nop 0
    buffer_load_dwordx4 v104, s[8:11], s25 offen sc1 lds
    buffer_load_dwordx4 v105, s[8:11], s25 offen offset:1024 sc1 lds
    s_mov_b64 exec, s[54:55]
    buffer_load_dwordx4 v106, s[8:11], s25 offen offset:2048 sc1 lds
    s_mov_b64 exec, -1
    s_add_u32 s25, s25, 262144
    s_add_u32 m0, s27, 40960
    s_nop 0
    buffer_load_dwordx4 v104, s[8:11], s25 offen sc1 lds
    buffer_load_dwordx4 v105, s[8:11], s25 offen offset:1024 sc1 lds
    s_mov_b64 exec, s[54:55]
    buffer_load_dwordx4 v106, s[8:11], s25 offen offset:2048 sc1 lds
    s_mov_b64 exec, -1
    s_add_u32 s25, s25, 262144
    s_add_u32 m0, s27, 61440
    s_nop 0
    buffer_load_dwordx4 v104, s[8:11], s25 offen sc1 lds
    buffer_load_dwordx4 v105, s[8:11], s25 offen offset:1024 sc1 lds
    s_mov_b64 exec, s[54:55]
    buffer_load_dwordx4 v106, s[8:11], s25 offen offset:2048 sc1 lds
    s_mov_b64 exec, -1
    s_add_u32 s25, s25, 262144
    s_waitcnt vmcnt(3)
    s_barrier
    ds_read_b128 v[48:51], v114 offset:0
    ds_read_b128 v[52:55], v114 offset:256
    ds_read_b128 v[56:59], v114 offset:512
    ds_read_b128 v[60:63], v114 offset:768
    ds_read_b128 v[64:67], v114 offset:1024
    ds_read_b64_tr_b16 v[88:89], v118 offset:0
    ds_read_b64_tr_b16 v[90:91], v118 offset:512
    ds_read_b64_tr_b16 v[92:93], v119 offset:0
    ds_read_b64_tr_b16 v[94:95], v119 offset:512
    s_mov_b32 s30, 7
Lout_33:
    s_waitcnt vmcnt(10) lgkmcnt(0)
    s_barrier
    v_mfma_f32_16x16x32_bf16 v[8:11], v[88:91], v[48:51], v[8:11]
    ds_read_b128 v[68:71], v114 offset:20480
    s_add_u32 m0, s27, 0
    v_mfma_f32_16x16x32_bf16 v[16:19], v[88:91], v[52:55], v[16:19]
    buffer_load_dwordx4 v104, s[8:11], s25 offen sc1 lds
    ds_read_b128 v[72:75], v114 offset:20736
    v_mfma_f32_16x16x32_bf16 v[24:27], v[88:91], v[56:59], v[24:27]
    buffer_load_dwordx4 v105, s[8:11], s25 offen offset:1024 sc1 lds
    ds_read_b128 v[76:79], v114 offset:20992
    v_mfma_f32_16x16x32_bf16 v[32:35], v[88:91], v[60:63], v[32:35]
    ds_read_b128 v[80:83], v114 offset:21248
    ds_read_b128 v[84:87], v114 offset:21504
    v_mfma_f32_16x16x32_bf16 v[40:43], v[88:91], v[64:67], v[40:43]
    s_mov_b64 exec, s[54:55]
    buffer_load_dwordx4 v106, s[8:11], s25 offen offset:2048 sc1 lds
    s_mov_b64 exec, -1
    s_add_u32 s25, s25, 262144
    v_mfma_f32_16x16x32_bf16 v[12:15], v[92:95], v[48:51], v[12:15]
    ds_read_b64_tr_b16 v[96:97], v118 offset:20480
    s_add_u32 m0, s28, 0
    v_mfma_f32_16x16x32_bf16 v[20:23], v[92:95], v[52:55], v[20:23]
    buffer_load_dwordx4 v112, s[48:51], s26 offen lds
    ds_read_b64_tr_b16 v[98:99], v118 offset:20992
    v_mfma_f32_16x16x32_bf16 v[28:31], v[92:95], v[56:59], v[28:31]
    ds_read_b64_tr_b16 v[100:101], v119 offset:20480
    ds_read_b64_tr_b16 v[102:103], v119 offset:20992
    v_mfma_f32_16x16x32_bf16 v[36:39], v[92:95], v[60:63], v[36:39]
    buffer_load_dwordx4 v113, s[48:51], s26 offen offset:1024 lds
    s_add_u32 s26, s26, 73728
    v_mfma_f32_16x16x32_bf16 v[44:47], v[92:95], v[64:67], v[44:47]
    s_waitcnt vmcnt(10) lgkmcnt(0)
    s_barrier
    v_mfma_f32_16x16x32_bf16 v[8:11], v[96:99], v[68:71], v[8:11]
    ds_read_b128 v[48:51], v114 offset:40960
    s_add_u32 m0, s27, 20480
    v_mfma_f32_16x16x32_bf16 v[16:19], v[96:99], v[72:75], v[16:19]
    buffer_load_dwordx4 v104, s[8:11], s25 offen sc1 lds
    ds_read_b128 v[52:55], v114 offset:41216
    v_mfma_f32_16x16x32_bf16 v[24:27], v[96:99], v[76:79], v[24:27]
    buffer_load_dwordx4 v105, s[8:11], s25 offen offset:1024 sc1 lds
    ds_read_b128 v[56:59], v114 offset:41472
    v_mfma_f32_16x16x32_bf16 v[32:35], v[96:99], v[80:83], v[32:35]
    ds_read_b128 v[60:63], v114 offset:41728
    ds_read_b128 v[64:67], v114 offset:41984
    v_mfma_f32_16x16x32_bf16 v[40:43], v[96:99], v[84:87], v[40:43]
    s_mov_b64 exec, s[54:55]
    buffer_load_dwordx4 v106, s[8:11], s25 offen offset:2048 sc1 lds
    s_mov_b64 exec, -1
    s_add_u32 s25, s25, 262144
    v_mfma_f32_16x16x32_bf16 v[12:15], v[100:103], v[68:71], v[12:15]
    ds_read_b64_tr_b16 v[88:89], v118 offset:40960
    s_add_u32 m0, s28, 20480
    v_mfma_f32_16x16x32_bf16 v[20:23], v[100:103], v[72:75], v[20:23]
    buffer_load_dwordx4 v112, s[48:51], s26 offen lds
    ds_read_b64_tr_b16 v[90:91], v118 offset:41472
    v_mfma_f32_16x16x32_bf16 v[28:31], v[100:103], v[76:79], v[28:31]
    ds_read_b64_tr_b16 v[92:93], v119 offset:40960
    ds_read_b64_tr_b16 v[94:95], v119 offset:41472
    v_mfma_f32_16x16x32_bf16 v[36:39], v[100:103], v[80:83], v[36:39]
    buffer_load_dwordx4 v113, s[48:51], s26 offen offset:1024 lds
    s_add_u32 s26, s26, 73728
    v_mfma_f32_16x16x32_bf16 v[44:47], v[100:103], v[84:87], v[44:47]
    s_waitcnt vmcnt(10) lgkmcnt(0)
    s_barrier
    v_mfma_f32_16x16x32_bf16 v[8:11], v[88:91], v[48:51], v[8:11]
    ds_read_b128 v[68:71], v114 offset:61440
    s_add_u32 m0, s27, 40960
    v_mfma_f32_16x16x32_bf16 v[16:19], v[88:91], v[52:55], v[16:19]
    buffer_load_dwordx4 v104, s[8:11], s25 offen sc1 lds
    ds_read_b128 v[72:75], v114 offset:61696
    v_mfma_f32_16x16x32_bf16 v[24:27], v[88:91], v[56:59], v[24:27]
    buffer_load_dwordx4 v105, s[8:11], s25 offen offset:1024 sc1 lds
    ds_read_b128 v[76:79], v114 offset:61952
    v_mfma_f32_16x16x32_bf16 v[32:35], v[88:91], v[60:63], v[32:35]
    ds_read_b128 v[80:83], v114 offset:62208
    ds_read_b128 v[84:87], v114 offset:62464
    v_mfma_f32_16x16x32_bf16 v[40:43], v[88:91], v[64:67], v[40:43]
    s_mov_b64 exec, s[54:55]
    buffer_load_dwordx4 v106, s[8:11], s25 offen offset:2048 sc1 lds
    s_mov_b64 exec, -1
    s_add_u32 s25, s25, 262144
    v_mfma_f32_16x16x32_bf16 v[12:15], v[92:95], v[48:51], v[12:15]
    ds_read_b64_tr_b16 v[96:97], v118 offset:61440
    s_add_u32 m0, s28, 40960
    v_mfma_f32_16x16x32_bf16 v[20:23], v[92:95], v[52:55], v[20:23]
    buffer_load_dwordx4 v112, s[48:51], s26 offen lds
    ds_read_b64_tr_b16 v[98:99], v118 offset:61952
    v_mfma_f32_16x16x32_bf16 v[28:31], v[92:95], v[56:59], v[28:31]
    ds_read_b64_tr_b16 v[100:101], v119 offset:61440
    ds_read_b64_tr_b16 v[102:103], v119 offset:61952
    v_mfma_f32_16x16x32_bf16 v[36:39], v[92:95], v[60:63], v[36:39]
    buffer_load_dwordx4 v113, s[48:51], s26 offen offset:1024 lds
    s_add_u32 s26, s26, 73728
    v_mfma_f32_16x16x32_bf16 v[44:47], v[92:95], v[64:67], v[44:47]
    s_waitcnt vmcnt(10) lgkmcnt(0)
    s_barrier
    v_mfma_f32_16x16x32_bf16 v[8:11], v[96:99], v[68:71], v[8:11]
    ds_read_b128 v[48:51], v114 offset:0
    s_add_u32 m0, s27, 61440
    v_mfma_f32_16x16x32_bf16 v[16:19], v[96:99], v[72:75], v[16:19]
    buffer_load_dwordx4 v104, s[8:11], s25 offen sc1 lds
    ds_read_b128 v[52:55], v114 offset:256
    v_mfma_f32_16x16x32_bf16 v[24:27], v[96:99], v[76:79], v[24:27]
    buffer_load_dwordx4 v105, s[8:11], s25 offen offset:1024 sc1 lds
    ds_read_b128 v[56:59], v114 offset:512
    v_mfma_f32_16x16x32_bf16 v[32:35], v[96:99], v[80:83], v[32:35]
    ds_read_b128 v[60:63], v114 offset:768
    ds_read_b128 v[64:67], v114 offset:1024
    v_mfma_f32_16x16x32_bf16 v[40:43], v[96:99], v[84:87], v[40:43]
    s_mov_b64 exec, s[54:55]
    buffer_load_dwordx4 v106, s[8:11], s25 offen offset:2048 sc1 lds
    s_mov_b64 exec, -1
    s_add_u32 s25, s25, 262144
    v_mfma_f32_16x16x32_bf16 v[12:15], v[100:103], v[68:71], v[12:15]
    ds_read_b64_tr_b16 v[88:89], v118 offset:0
    s_add_u32 m0, s28, 61440
    v_mfma_f32_16x16x32_bf16 v[20:23], v[100:103], v[72:75], v[20:23]
    buffer_load_dwordx4 v112, s[48:51], s26 offen lds
    ds_read_b64_tr_b16 v[90:91], v118 offset:512
    v_mfma_f32_16x16x32_bf16 v[28:31], v[100:103], v[76:79], v[28:31]
    ds_read_b64_tr_b16 v[92:93], v119 offset:0
    ds_read_b64_tr_b16 v[94:95], v119 offset:512
    v_mfma_f32_16x16x32_bf16 v[36:39], v[100:103], v[80:83], v[36:39]
    buffer_load_dwordx4 v113, s[48:51], s26 offen offset:1024 lds
    s_add_u32 s26, s26, 73728
    v_mfma_f32_16x16x32_bf16 v[44:47], v[100:103], v[84:87], v[44:47]
    s_sub_u32 s30, s30, 1
    s_cmp_lg_u32 s30, 0
    s_cbranch_scc1 Lout_33
    s_waitcnt vmcnt(10) lgkmcnt(0)
    s_barrier
    v_mfma_f32_16x16x32_bf16 v[8:11], v[88:91], v[48:51], v[8:11]
    ds_read_b128 v[68:71], v114 offset:20480
    s_add_u32 m0, s27, 0
    v_mfma_f32_16x16x32_bf16 v[16:19], v[88:91], v[52:55], v[16:19]
    buffer_load_dwordx4 v104, s[8:11], s25 offen sc1 lds
    ds_read_b128 v[72:75], v114 offset:20736
    v_mfma_f32_16x16x32_bf16 v[24:27], v[88:91], v[56:59], v[24:27]
    buffer_load_dwordx4 v105, s[8:11], s25 offen offset:1024 sc1 lds
    ds_read_b128 v[76:79], v114 offset:20992
    v_mfma_f32_16x16x32_bf16 v[32:35], v[88:91], v[60:63], v[32:35]
    ds_read_b128 v[80:83], v114 offset:21248
    ds_read_b128 v[84:87], v114 offset:21504
    v_mfma_f32_16x16x32_bf16 v[40:43], v[88:91], v[64:67], v[40:43]
    s_mov_b64 exec, s[54:55]
    buffer_load_dwordx4 v106, s[8:11], s25 offen offset:2048 sc1 lds
    s_mov_b64 exec, -1
    s_add_u32 s25, s25, 262144
    v_mfma_f32_16x16x32_bf16 v[12:15], v[92:95], v[48:51], v[12:15]
    ds_read_b64_tr_b16 v[96:97], v118 offset:20480
    s_add_u32 m0, s28, 0
    v_mfma_f32_16x16x32_bf16 v[20:23], v[92:95], v[52:55], v[20:23]
    buffer_load_dwordx4 v112, s[48:51], s26 offen lds
    ds_read_b64_tr_b16 v[98:99], v118 offset:20992
    v_mfma_f32_16x16x32_bf16 v[28:31], v[92:95], v[56:59], v[28:31]
    ds_read_b64_tr_b16 v[100:101], v119 offset:20480
    ds_read_b64_tr_b16 v[102:103], v119 offset:20992
    v_mfma_f32_16x16x32_bf16 v[36:39], v[92:95], v[60:63], v[36:39]
    buffer_load_dwordx4 v113, s[48:51], s26 offen offset:1024 lds
    s_add_u32 s26, s26, 73728
    v_mfma_f32_16x16x32_bf16 v[44:47], v[92:95], v[64:67], v[44:47]
    s_waitcnt vmcnt(10) lgkmcnt(0)
    s_barrier
    v_mfma_f32_16x16x32_bf16 v[8:11], v[96:99], v[68:71], v[8:11]
    ds_read_b128 v[48:51], v114 offset:40960
    s_add_u32 m0, s27, 20480
    v_mfma_f32_16x16x32_bf16 v[16:19], v[96:99], v[72:75], v[16:19]
    buffer_load_dwordx4 v104, s[8:11], s25 offen sc1 lds
    ds_read_b128 v[52:55], v114 offset:41216
    v_mfma_f32_16x16x32_bf16 v[24:27], v[96:99], v[76:79], v[24:27]
    buffer_load_dwordx4 v105, s[8:11], s25 offen offset:1024 sc1 lds
    ds_read_b128 v[56:59], v114 offset:41472
    v_mfma_f32_16x16x32_bf16 v[32:35], v[96:99], v[80:83], v[32:35]
    ds_read_b128 v[60:63], v114 offset:41728
    ds_read_b128 v[64:67], v114 offset:41984
    v_mfma_f32_16x16x32_bf16 v[40:43], v[96:99], v[84:87], v[40:43]
    s_mov_b64 exec, s[54:55]
    buffer_load_dwordx4 v106, s[8:11], s25 offen offset:2048 sc1 lds
    s_mov_b64 exec, -1
    s_add_u32 s25, s25, 262144
    v_mfma_f32_16x16x32_bf16 v[12:15], v[100:103], v[68:71], v[12:15]
    ds_read_b64_tr_b16 v[88:89], v118 offset:40960
    s_add_u32 m0, s28, 20480
    v_mfma_f32_16x16x32_bf16 v[20:23], v[100:103], v[72:75], v[20:23]
    buffer_load_dwordx4 v112, s[48:51], s26 offen lds
    ds_read_b64_tr_b16 v[90:91], v118 offset:41472
    v_mfma_f32_16x16x32_bf16 v[28:31], v[100:103], v[76:79], v[28:31]
    ds_read_b64_tr_b16 v[92:93], v119 offset:40960
    ds_read_b64_tr_b16 v[94:95], v119 offset:41472
    v_mfma_f32_16x16x32_bf16 v[36:39], v[100:103], v[80:83], v[36:39]
    buffer_load_dwordx4 v113, s[48:51], s26 offen offset:1024 lds
    s_add_u32 s26, s26, 73728
    v_mfma_f32_16x16x32_bf16 v[44:47], v[100:103], v[84:87], v[44:47]
    s_waitcnt vmcnt(10) lgkmcnt(0)
    s_barrier
    v_mfma_f32_16x16x32_bf16 v[8:11], v[88:91], v[48:51], v[8:11]
    ds_read_b128 v[68:71], v114 offset:61440
    s_add_u32 m0, s27, 40960
    v_mfma_f32_16x16x32_bf16 v[16:19], v[88:91], v[52:55], v[16:19]
    buffer_load_dwordx4 v104, s[8:11], s25 offen sc1 lds
    ds_read_b128 v[72:75], v114 offset:61696
    v_mfma_f32_16x16x32_bf16 v[24:27], v[88:91], v[56:59], v[24:27]
    buffer_load_dwordx4 v105, s[8:11], s25 offen offset:1024 sc1 lds
    ds_read_b128 v[76:79], v114 offset:61952
    v_mfma_f32_16x16x32_bf16 v[32:35], v[88:91], v[60:63], v[32:35]
    ds_read_b128 v[80:83], v114 offset:62208
    ds_read_b128 v[84:87], v114 offset:62464
    v_mfma_f32_16x16x32_bf16 v[40:43], v[88:91], v[64:67], v[40:43]
    s_mov_b64 exec, s[54:55]
    buffer_load_dwordx4 v106, s[8:11], s25 offen offset:2048 sc1 lds
    s_mov_b64 exec, -1
    s_add_u32 s25, s25, 262144
    v_mfma_f32_16x16x32_bf16 v[12:15], v[92:95], v[48:51], v[12:15]
    ds_read_b64_tr_b16 v[96:97], v118 offset:61440
    s_add_u32 m0, s28, 40960
    v_mfma_f32_16x16x32_bf16 v[20:23], v[92:95], v[52:55], v[20:23]
    buffer_load_dwordx4 v112, s[48:51], s26 offen lds
    ds_read_b64_tr_b16 v[98:99], v118 offset:61952
    v_mfma_f32_16x16x32_bf16 v[28:31], v[92:95], v[56:59], v[28:31]
    ds_read_b64_tr_b16 v[100:101], v119 offset:61440
    ds_read_b64_tr_b16 v[102:103], v119 offset:61952
    v_mfma_f32_16x16x32_bf16 v[36:39], v[92:95], v[60:63], v[36:39]
    buffer_load_dwordx4 v113, s[48:51], s26 offen offset:1024 lds
    s_add_u32 s26, s26, 73728
    v_mfma_f32_16x16x32_bf16 v[44:47], v[92:95], v[64:67], v[44:47]
    s_waitcnt vmcnt(10) lgkmcnt(0)
    s_barrier
    v_mfma_f32_16x16x32_bf16 v[8:11], v[96:99], v[68:71], v[8:11]
    ds_read_b128 v[48:51], v114 offset:0
    s_add_u32 m0, s27, 61440
    v_mfma_f32_16x16x32_bf16 v[16:19], v[96:99], v[72:75], v[16:19]
    buffer_load_dwordx4 v104, s[8:11], s25 offen sc1 lds
    ds_read_b128 v[52:55], v114 offset:256
    v_mfma_f32_16x16x32_bf16 v[24:27], v[96:99], v[76:79], v[24:27]
    buffer_load_dwordx4 v105, s[8:11], s25 offen offset:1024 sc1 lds
    ds_read_b128 v[56:59], v114 offset:512
    v_mfma_f32_16x16x32_bf16 v[32:35], v[96:99], v[80:83], v[32:35]
    ds_read_b128 v[60:63], v114 offset:768
    ds_read_b128 v[64:67], v114 offset:1024
    v_mfma_f32_16x16x32_bf16 v[40:43], v[96:99], v[84:87], v[40:43]
    s_mov_b64 exec, s[54:55]
    buffer_load_dwordx4 v106, s[8:11], s25 offen offset:2048 sc1 lds
    s_mov_b64 exec, -1
    s_mul_i32 s25, s44, 1280
    v_mfma_f32_16x16x32_bf16 v[12:15], v[100:103], v[68:71], v[12:15]
    ds_read_b64_tr_b16 v[88:89], v118 offset:0
    s_add_u32 m0, s28, 61440
    v_mfma_f32_16x16x32_bf16 v[20:23], v[100:103], v[72:75], v[20:23]
    buffer_load_dwordx4 v112, s[48:51], s26 offen lds
    ds_read_b64_tr_b16 v[90:91], v118 offset:512
    v_mfma_f32_16x16x32_bf16 v[28:31], v[100:103], v[76:79], v[28:31]
    ds_read_b64_tr_b16 v[92:93], v119 offset:0
    ds_read_b64_tr_b16 v[94:95], v119 offset:512
    v_mfma_f32_16x16x32_bf16 v[36:39], v[100:103], v[80:83], v[36:39]
    buffer_load_dwordx4 v113, s[48:51], s26 offen offset:1024 lds
    s_add_u32 s26, s52, 0
    v_mfma_f32_16x16x32_bf16 v[44:47], v[100:103], v[84:87], v[44:47]
    s_cmp_lg_u32 s24, 0
    s_cbranch_scc1 Lpolled_35
    s_mov_b32 s5, 0
Lpoll_34:
    buffer_load_dword v120, v117, s[56:59], 0 offen sc1
    s_waitcnt vmcnt(0)
    v_cmp_eq_u32 s[6:7], 0, v120
    s_add_u32 s5, s5, 1
    s_nop 1
    s_cmp_eq_u64 s[6:7], 0
    s_cbranch_scc1 Lpolled_35
    s_sleep 16
    s_cmp_lt_u32 s5, 0x100000
    s_cbranch_scc1 Lpoll_34
Lpolled_35:
    s_waitcnt vmcnt(10) lgkmcnt(0)
    s_barrier
    v_mfma_f32_16x16x32_bf16 v[8:11], v[88:91], v[48:51], v[8:11]
    ds_read_b128 v[68:71], v114 offset:20480
    s_add_u32 m0, s27, 0
    v_mfma_f32_16x16x32_bf16 v[16:19], v[88:91], v[52:55], v[16:19]
    buffer_load_dwordx4 v104, s[8:11], s25 offen sc1 lds
    ds_read_b128 v[72:75], v114 offset:20736
    v_mfma_f32_16x16x32_bf16 v[24:27], v[88:91], v[56:59], v[24:27]
    buffer_load_dwordx4 v105, s[8:11], s25 offen offset:1024 sc1 lds
    ds_read_b128 v[76:79], v114 offset:20992
    v_mfma_f32_16x16x32_bf16 v[32:35], v[88:91], v[60:63], v[32:35]
    ds_read_b128 v[80:83], v114 offset:21248
    ds_read_b128 v[84:87], v114 offset:21504
    v_mfma_f32_16x16x32_bf16 v[40:43], v[88:91], v[64:67], v[40:43]
    s_mov_b64 exec, s[54:55]
    buffer_load_dwordx4 v106, s[8:11], s25 offen offset:2048 sc1 lds
    s_mov_b64 exec, -1
    s_add_u32 s25, s25, 262144
    v_mfma_f32_16x16x32_bf16 v[12:15], v[92:95], v[48:51], v[12:15]
    ds_read_b64_tr_b16 v[96:97], v118 offset:20480
    s_add_u32 m0, s28, 0
    v_mfma_f32_16x16x32_bf16 v[20:23], v[92:95], v[52:55], v[20:23]
    buffer_load_dwordx4 v108, s[12:15], s26 offen lds
    ds_read_b64_tr_b16 v[98:99], v118 offset:20992
    v_mfma_f32_16x16x32_bf16 v[28:31], v[92:95], v[56:59], v[28:31]
    ds_read_b64_tr_b16 v[100:101], v119 offset:20480
    ds_read_b64_tr_b16 v[102:103], v119 offset:20992
    v_mfma_f32_16x16x32_bf16 v[36:39], v[92:95], v[60:63], v[36:39]
    buffer_load_dwordx4 v109, s[12:15], s26 offen offset:1024 lds
    s_add_u32 s26, s52, 165888
    v_mfma_f32_16x16x32_bf16 v[44:47], v[92:95], v[64:67], v[44:47]
    s_waitcnt vmcnt(10) lgkmcnt(0)
    s_barrier
    v_mfma_f32_16x16x32_bf16 v[8:11], v[96:99], v[68:71], v[8:11]
    ds_read_b128 v[48:51], v114 offset:40960
    s_add_u32 m0, s27, 20480
    v_mfma_f32_16x16x32_bf16 v[16:19], v[96:99], v[72:75], v[16:19]
    buffer_load_dwordx4 v104, s[8:11], s25 offen sc1 lds
    ds_read_b128 v[52:55], v114 offset:41216
    v_mfma_f32_16x16x32_bf16 v[24:27], v[96:99], v[76:79], v[24:27]
    buffer_load_dwordx4 v105, s[8:11], s25 offen offset:1024 sc1 lds
    ds_read_b128 v[56:59], v114 offset:41472
    v_mfma_f32_16x16x32_bf16 v[32:35], v[96:99], v[80:83], v[32:35]
    ds_read_b128 v[60:63], v114 offset:41728
    ds_read_b128 v[64:67], v114 offset:41984
    v_mfma_f32_16x16x32_bf16 v[40:43], v[96:99], v[84:87], v[40:43]
    s_mov_b64 exec, s[54:55]
    buffer_load_dwordx4 v106, s[8:11], s25 offen offset:2048 sc1 lds
    s_mov_b64 exec, -1
    s_add_u32 s25, s25, 262144
    v_mfma_f32_16x16x32_bf16 v[12:15], v[100:103], v[68:71], v[12:15]
    ds_read_b64_tr_b16 v[88:89], v118 offset:40960
    s_add_u32 m0, s28, 20480
    v_mfma_f32_16x16x32_bf16 v[20:23], v[100:103], v[72:75], v[20:23]
    buffer_load_dwordx4 v108, s[12:15], s26 offen lds
    ds_read_b64_tr_b16 v[90:91], v118 offset:41472
    v_mfma_f32_16x16x32_bf16 v[28:31], v[100:103], v[76:79], v[28:31]
    ds_read_b64_tr_b16 v[92:93], v119 offset:40960
    ds_read_b64_tr_b16 v[94:95], v119 offset:41472
    v_mfma_f32_16x16x32_bf16 v[36:39], v[100:103], v[80:83], v[36:39]
    buffer_load_dwordx4 v109, s[12:15], s26 offen offset:1024 lds
    s_add_u32 s26, s52, 331776
    v_mfma_f32_16x16x32_bf16 v[44:47], v[100:103], v[84:87], v[44:47]
    s_waitcnt vmcnt(10) lgkmcnt(0)
    s_barrier
    v_mfma_f32_16x16x32_bf16 v[8:11], v[88:91], v[48:51], v[8:11]
    ds_read_b128 v[68:71], v114 offset:61440
    s_add_u32 m0, s27, 40960
    v_mfma_f32_16x16x32_bf16 v[16:19], v[88:91], v[52:55], v[16:19]
    buffer_load_dwordx4 v104, s[8:11], s25 offen sc1 lds
    ds_read_b128 v[72:75], v114 offset:61696
    v_mfma_f32_16x16x32_bf16 v[24:27], v[88:91], v[56:59], v[24:27]
    buffer_load_dwordx4 v105, s[8:11], s25 offen offset:1024 sc1 lds
    ds_read_b128 v[76:79], v114 offset:61952
    v_mfma_f32_16x16x32_bf16 v[32:35], v[88:91], v[60:63], v[32:35]
    ds_read_b128 v[80:83], v114 offset:62208
    ds_read_b128 v[84:87], v114 offset:62464
    v_mfma_f32_16x16x32_bf16 v[40:43], v[88:91], v[64:67], v[40:43]
    s_mov_b64 exec, s[54:55]
    buffer_load_dwordx4 v106, s[8:11], s25 offen offset:2048 sc1 lds
    s_mov_b64 exec, -1
    s_add_u32 s25, s25, 262144
    v_mfma_f32_16x16x32_bf16 v[12:15], v[92:95], v[48:51], v[12:15]
    ds_read_b64_tr_b16 v[96:97], v118 offset:61440
    s_add_u32 m0, s28, 40960
    v_mfma_f32_16x16x32_bf16 v[20:23], v[92:95], v[52:55], v[20:23]
    buffer_load_dwordx4 v108, s[12:15], s26 offen lds
    ds_read_b64_tr_b16 v[98:99], v118 offset:61952
    v_mfma_f32_16x16x32_bf16 v[28:31], v[92:95], v[56:59], v[28:31]
    ds_read_b64_tr_b16 v[100:101], v119 offset:61440
    ds_read_b64_tr_b16 v[102:103], v119 offset:61952
    v_mfma_f32_16x16x32_bf16 v[36:39], v[92:95], v[60:63], v[36:39]
    buffer_load_dwordx4 v109, s[12:15], s26 offen offset:1024 lds
    s_add_u32 s26, s52, 497664
    v_mfma_f32_16x16x32_bf16 v[44:47], v[92:95], v[64:67], v[44:47]
    s_waitcnt vmcnt(10) lgkmcnt(0)
    s_barrier
    v_mfma_f32_16x16x32_bf16 v[8:11], v[96:99], v[68:71], v[8:11]
    ds_read_b128 v[48:51], v114 offset:0
    s_add_u32 m0, s27, 61440
    v_mfma_f32_16x16x32_bf16 v[16:19], v[96:99], v[72:75], v[16:19]
    buffer_load_dwordx4 v104, s[8:11], s25 offen sc1 lds
    ds_read_b128 v[52:55], v114 offset:256
    v_mfma_f32_16x16x32_bf16 v[24:27], v[96:99], v[76:79], v[24:27]
    buffer_load_dwordx4 v105, s[8:11], s25 offen offset:1024 sc1 lds
    ds_read_b128 v[56:59], v114 offset:512
    v_mfma_f32_16x16x32_bf16 v[32:35], v[96:99], v[80:83], v[32:35]
    ds_read_b128 v[60:63], v114 offset:768
    ds_read_b128 v[64:67], v114 offset:1024
    v_mfma_f32_16x16x32_bf16 v[40:43], v[96:99], v[84:87], v[40:43]
    s_mov_b64 exec, s[54:55]
    buffer_load_dwordx4 v106, s[8:11], s25 offen offset:2048 sc1 lds
    s_mov_b64 exec, -1
    s_add_u32 s25, s25, 262144
    v_mfma_f32_16x16x32_bf16 v[12:15], v[100:103], v[68:71], v[12:15]
    ds_read_b64_tr_b16 v[88:89], v118 offset:0
    s_add_u32 m0, s28, 61440
    v_mfma_f32_16x16x32_bf16 v[20:23], v[100:103], v[72:75], v[20:23]
    buffer_load_dwordx4 v108, s[12:15], s26 offen lds
    ds_read_b64_tr_b16 v[90:91], v118 offset:512
    v_mfma_f32_16x16x32_bf16 v[28:31], v[100:103], v[76:79], v[28:31]
    ds_read_b64_tr_b16 v[92:93], v119 offset:0
    ds_read_b64_tr_b16 v[94:95], v119 offset:512
    v_mfma_f32_16x16x32_bf16 v[36:39], v[100:103], v[80:83], v[36:39]
    buffer_load_dwordx4 v109, s[12:15], s26 offen offset:1024 lds
    s_add_u32 s26, s52, 9216
    v_mfma_f32_16x16x32_bf16 v[44:47], v[100:103], v[84:87], v[44:47]
    s_waitcnt vmcnt(10) lgkmcnt(0)
    s_barrier
    v_mfma_f32_16x16x32_bf16 v[8:11], v[88:91], v[48:51], v[8:11]
    ds_read_b128 v[68:71], v114 offset:20480
    s_add_u32 m0, s27, 0
    v_mfma_f32_16x16x32_bf16 v[16:19], v[88:91], v[52:55], v[16:19]
    buffer_load_dwordx4 v104, s[8:11], s25 offen sc1 lds
    ds_read_b128 v[72:75], v114 offset:20736
    v_mfma_f32_16x16x32_bf16 v[24:27], v[88:91], v[56:59], v[24:27]
    buffer_load_dwordx4 v105, s[8:11], s25 offen offset:1024 sc1 lds
    ds_read_b128 v[76:79], v114 offset:20992
    v_mfma_f32_16x16x32_bf16 v[32:35], v[88:91], v[60:63], v[32:35]
    ds_read_b128 v[80:83], v114 offset:21248
    ds_read_b128 v[84:87], v114 offset:21504
    v_mfma_f32_16x16x32_bf16 v[40:43], v[88:91], v[64:67], v[40:43]
    s_mov_b64 exec, s[54:55]
    buffer_load_dwordx4 v106, s[8:11], s25 offen offset:2048 sc1 lds
    s_mov_b64 exec, -1
    s_add_u32 s25, s25, 262144
    v_mfma_f32_16x16x32_bf16 v[12:15], v[92:95], v[48:51], v[12:15]
    ds_read_b64_tr_b16 v[96:97], v118 offset:20480
    s_add_u32 m0, s28, 0
    v_mfma_f32_16x16x32_bf16 v[20:23], v[92:95], v[52:55], v[20:23]
    buffer_load_dwordx4 v108, s[12:15], s26 offen lds
    ds_read_b64_tr_b16 v[98:99], v118 offset:20992
    v_mfma_f32_16x16x32_bf16 v[28:31], v[92:95], v[56:59], v[28:31]
    ds_read_b64_tr_b16 v[100:101], v119 offset:20480
    ds_read_b64_tr_b16 v[102:103], v119 offset:20992
    v_mfma_f32_16x16x32_bf16 v[36:39], v[92:95], v[60:63], v[36:39]
    buffer_load_dwordx4 v109, s[12:15], s26 offen offset:1024 lds
    s_add_u32 s26, s52, 175104
    v_mfma_f32_16x16x32_bf16 v[44:47], v[92:95], v[64:67], v[44:47]
    s_waitcnt vmcnt(10) lgkmcnt(0)
    s_barrier
    v_mfma_f32_16x16x32_bf16 v[8:11], v[96:99], v[68:71], v[8:11]
    ds_read_b128 v[48:51], v114 offset:40960
    s_add_u32 m0, s27, 20480
    v_mfma_f32_16x16x32_bf16 v[16:19], v[96:99], v[72:75], v[16:19]
    buffer_load_dwordx4 v104, s[8:11], s25 offen sc1 lds
    ds_read_b128 v[52:55], v114 offset:41216
    v_mfma_f32_16x16x32_bf16 v[24:27], v[96:99], v[76:79], v[24:27]
    buffer_load_dwordx4 v105, s[8:11], s25 offen offset:1024 sc1 lds
    ds_read_b128 v[56:59], v114 offset:41472
    v_mfma_f32_16x16x32_bf16 v[32:35], v[96:99], v[80:83], v[32:35]
    ds_read_b128 v[60:63], v114 offset:41728
    ds_read_b128 v[64:67], v114 offset:41984
    v_mfma_f32_16x16x32_bf16 v[40:43], v[96:99], v[84:87], v[40:43]
    s_mov_b64 exec, s[54:55]
    buffer_load_dwordx4 v106, s[8:11], s25 offen offset:2048 sc1 lds
    s_mov_b64 exec, -1
    s_add_u32 s25, s25, 262144
    v_mfma_f32_16x16x32_bf16 v[12:15], v[100:103], v[68:71], v[12:15]
    ds_read_b64_tr_b16 v[88:89], v118 offset:40960
    s_add_u32 m0, s28, 20480
    v_mfma_f32_16x16x32_bf16 v[20:23], v[100:103], v[72:75], v[20:23]
    buffer_load_dwordx4 v108, s[12:15], s26 offen lds
    ds_read_b64_tr_b16 v[90:91], v118 offset:41472
    v_mfma_f32_16x16x32_bf16 v[28:31], v[100:103], v[76:79], v[28:31]
    ds_read_b64_tr_b16 v[92:93], v119 offset:40960
    ds_read_b64_tr_b16 v[94:95], v119 offset:41472
    v_mfma_f32_16x16x32_bf16 v[36:39], v[100:103], v[80:83], v[36:39]
    buffer_load_dwordx4 v109, s[12:15], s26 offen offset:1024 lds
    s_add_u32 s26, s52, 340992
    v_mfma_f32_16x16x32_bf16 v[44:47], v[100:103], v[84:87], v[44:47]
    s_waitcnt vmcnt(10) lgkmcnt(0)
    s_barrier
    v_mfma_f32_16x16x32_bf16 v[8:11], v[88:91], v[48:51], v[8:11]
    ds_read_b128 v[68:71], v114 offset:61440
    s_add_u32 m0, s27, 40960
    v_mfma_f32_16x16x32_bf16 v[16:19], v[88:91], v[52:55], v[16:19]
    buffer_load_dwordx4 v104, s[8:11], s25 offen sc1 lds
    ds_read_b128 v[72:75], v114 offset:61696
    v_mfma_f32_16x16x32_bf16 v[24:27], v[88:91], v[56:59], v[24:27]
    buffer_load_dwordx4 v105, s[8:11], s25 offen offset:1024 sc1 lds
    ds_read_b128 v[76:79], v114 offset:61952
    v_mfma_f32_16x16x32_bf16 v[32:35], v[88:91], v[60:63], v[32:35]
    ds_read_b128 v[80:83], v114 offset:62208
    ds_read_b128 v[84:87], v114 offset:62464
    v_mfma_f32_16x16x32_bf16 v[40:43], v[88:91], v[64:67], v[40:43]
    s_mov_b64 exec, s[54:55]
    buffer_load_dwordx4 v106, s[8:11], s25 offen offset:2048 sc1 lds
    s_mov_b64 exec, -1
    s_add_u32 s25, s25, 262144
    v_mfma_f32_16x16x32_bf16 v[12:15], v[92:95], v[48:51], v[12:15]
    ds_read_b64_tr_b16 v[96:97], v118 offset:61440
    s_add_u32 m0, s28, 40960
    v_mfma_f32_16x16x32_bf16 v[20:23], v[92:95], v[52:55], v[20:23]
    buffer_load_dwordx4 v108, s[12:15], s26 offen lds
    ds_read_b64_tr_b16 v[98:99], v118 offset:61952
    v_mfma_f32_16x16x32_bf16 v[28:31], v[92:95], v[56:59], v[28:31]
    ds_read_b64_tr_b16 v[100:101], v119 offset:61440
    ds_read_b64_tr_b16 v[102:103], v119 offset:61952
    v_mfma_f32_16x16x32_bf16 v[36:39], v[92:95], v[60:63], v[36:39]
    buffer_load_dwordx4 v109, s[12:15], s26 offen offset:1024 lds
    s_add_u32 s26, s52, 506880
    v_mfma_f32_16x16x32_bf16 v[44:47], v[92:95], v[64:67], v[44:47]
    s_waitcnt vmcnt(10) lgkmcnt(0)
    s_barrier
    v_mfma_f32_16x16x32_bf16 v[8:11], v[96:99], v[68:71], v[8:11]
    ds_read_b128 v[48:51], v114 offset:0
    s_add_u32 m0, s27, 61440
    v_mfma_f32_16x16x32_bf16 v[16:19], v[96:99], v[72:75], v[16:19]
    buffer_load_dwordx4 v104, s[8:11], s25 offen sc1 lds
    ds_read_b128 v[52:55], v114 offset:256
    v_mfma_f32_16x16x32_bf16 v[24:27], v[96:99], v[76:79], v[24:27]
    buffer_load_dwordx4 v105, s[8:11], s25 offen offset:1024 sc1 lds
    ds_read_b128 v[56:59], v114 offset:512
    v_mfma_f32_16x16x32_bf16 v[32:35], v[96:99], v[80:83], v[32:35]
    ds_read_b128 v[60:63], v114 offset:768
    ds_read_b128 v[64:67], v114 offset:1024
    v_mfma_f32_16x16x32_bf16 v[40:43], v[96:99], v[84:87], v[40:43]
    s_mov_b64 exec, s[54:55]
    buffer_load_dwordx4 v106, s[8:11], s25 offen offset:2048 sc1 lds
    s_mov_b64 exec, -1
    s_add_u32 s25, s25, 262144
    v_mfma_f32_16x16x32_bf16 v[12:15], v[100:103], v[68:71], v[12:15]
    ds_read_b64_tr_b16 v[88:89], v118 offset:0
    s_add_u32 m0, s28, 61440
    v_mfma_f32_16x16x32_bf16 v[20:23], v[100:103], v[72:75], v[20:23]
    buffer_load_dwordx4 v108, s[12:15], s26 offen lds
    ds_read_b64_tr_b16 v[90:91], v118 offset:512
    v_mfma_f32_16x16x32_bf16 v[28:31], v[100:103], v[76:79], v[28:31]
    ds_read_b64_tr_b16 v[92:93], v119 offset:0
    ds_read_b64_tr_b16 v[94:95], v119 offset:512
    v_mfma_f32_16x16x32_bf16 v[36:39], v[100:103], v[80:83], v[36:39]
    buffer_load_dwordx4 v109, s[12:15], s26 offen offset:1024 lds
    s_add_u32 s26, s52, 0
    v_mfma_f32_16x16x32_bf16 v[44:47], v[100:103], v[84:87], v[44:47]
    s_waitcnt vmcnt(10) lgkmcnt(0)
    s_barrier
    v_mfma_f32_16x16x32_bf16 v[8:11], v[88:91], v[48:51], v[8:11]
    ds_read_b128 v[68:71], v114 offset:20480
    s_add_u32 m0, s27, 0
    v_mfma_f32_16x16x32_bf16 v[16:19], v[88:91], v[52:55], v[16:19]
    buffer_load_dwordx4 v104, s[8:11], s25 offen sc1 lds
    ds_read_b128 v[72:75], v114 offset:20736
    v_mfma_f32_16x16x32_bf16 v[24:27], v[88:91], v[56:59], v[24:27]
    buffer_load_dwordx4 v105, s[8:11], s25 offen offset:1024 sc1 lds
    ds_read_b128 v[76:79], v114 offset:20992
    v_mfma_f32_16x16x32_bf16 v[32:35], v[88:91], v[60:63], v[32:35]
    ds_read_b128 v[80:83], v114 offset:21248
    ds_read_b128 v[84:87], v114 offset:21504
    v_mfma_f32_16x16x32_bf16 v[40:43], v[88:91], v[64:67], v[40:43]
    s_mov_b64 exec, s[54:55]
    buffer_load_dwordx4 v106, s[8:11], s25 offen offset:2048 sc1 lds
    s_mov_b64 exec, -1
    s_add_u32 s25, s25, 262144
    v_mfma_f32_16x16x32_bf16 v[12:15], v[92:95], v[48:51], v[12:15]
    ds_read_b64_tr_b16 v[96:97], v118 offset:20480
    s_add_u32 m0, s28, 0
    v_mfma_f32_16x16x32_bf16 v[20:23], v[92:95], v[52:55], v[20:23]
    buffer_load_dwordx4 v110, s[12:15], s26 offen lds
    ds_read_b64_tr_b16 v[98:99], v118 offset:20992
    v_mfma_f32_16x16x32_bf16 v[28:31], v[92:95], v[56:59], v[28:31]
    ds_read_b64_tr_b16 v[100:101], v119 offset:20480
    ds_read_b64_tr_b16 v[102:103], v119 offset:20992
    v_mfma_f32_16x16x32_bf16 v[36:39], v[92:95], v[60:63], v[36:39]
    buffer_load_dwordx4 v111, s[12:15], s26 offen offset:1024 lds
    s_add_u32 s26, s52, 0
    v_mfma_f32_16x16x32_bf16 v[44:47], v[92:95], v[64:67], v[44:47]
    s_waitcnt vmcnt(10) lgkmcnt(0)
    s_barrier
    v_mfma_f32_16x16x32_bf16 v[8:11], v[96:99], v[68:71], v[8:11]
    ds_read_b128 v[48:51], v114 offset:40960
    ds_read_b128 v[52:55], v114 offset:41216
    v_mfma_f32_16x16x32_bf16 v[16:19], v[96:99], v[72:75], v[16:19]
    ds_read_b128 v[56:59], v114 offset:41472
    ds_read_b128 v[60:63], v114 offset:41728
    v_mfma_f32_16x16x32_bf16 v[24:27], v[96:99], v[76:79], v[24:27]
    ds_read_b128 v[64:67], v114 offset:41984
    ds_read_b64_tr_b16 v[88:89], v118 offset:40960
    v_mfma_f32_16x16x32_bf16 v[32:35], v[96:99], v[80:83], v[32:35]
    ds_read_b64_tr_b16 v[90:91], v118 offset:41472
    ds_read_b64_tr_b16 v[92:93], v119 offset:40960
    v_mfma_f32_16x16x32_bf16 v[40:43], v[96:99], v[84:87], v[40:43]
    ds_read_b64_tr_b16 v[94:95], v119 offset:41472
    v_mfma_f32_16x16x32_bf16 v[12:15], v[100:103], v[68:71], v[12:15]
    v_mfma_f32_16x16x32_bf16 v[20:23], v[100:103], v[72:75], v[20:23]
    v_mfma_f32_16x16x32_bf16 v[28:31], v[100:103], v[76:79], v[28:31]
    v_mfma_f32_16x16x32_bf16 v[36:39], v[100:103], v[80:83], v[36:39]
    v_mfma_f32_16x16x32_bf16 v[44:47], v[100:103], v[84:87], v[44:47]
    s_waitcnt vmcnt(5) lgkmcnt(0)
    s_barrier
    v_mfma_f32_16x16x32_bf16 v[8:11], v[88:91], v[48:51], v[8:11]
    ds_read_b128 v[68:71], v114 offset:61440
    ds_read_b128 v[72:75], v114 offset:61696
    v_mfma_f32_16x16x32_bf16 v[16:19], v[88:91], v[52:55], v[16:19]
    ds_read_b128 v[76:79], v114 offset:61952
    ds_read_b128 v[80:83], v114 offset:62208
    v_mfma_f32_16x16x32_bf16 v[24:27], v[88:91], v[56:59], v[24:27]
    ds_read_b128 v[84:87], v114 offset:62464
    ds_read_b64_tr_b16 v[96:97], v118 offset:61440
    v_mfma_f32_16x16x32_bf16 v[32:35], v[88:91], v[60:63], v[32:35]
    ds_read_b64_tr_b16 v[98:99], v118 offset:61952
    ds_read_b64_tr_b16 v[100:101], v119 offset:61440
    v_mfma_f32_16x16x32_bf16 v[40:43], v[88:91], v[64:67], v[40:43]
    ds_read_b64_tr_b16 v[102:103], v119 offset:61952
    v_mfma_f32_16x16x32_bf16 v[12:15], v[92:95], v[48:51], v[12:15]
    v_mfma_f32_16x16x32_bf16 v[20:23], v[92:95], v[52:55], v[20:23]
    v_mfma_f32_16x16x32_bf16 v[28:31], v[92:95], v[56:59], v[28:31]
    v_mfma_f32_16x16x32_bf16 v[36:39], v[92:95], v[60:63], v[36:39]
    v_mfma_f32_16x16x32_bf16 v[44:47], v[92:95], v[64:67], v[44:47]
    s_waitcnt vmcnt(0) lgkmcnt(0)
    s_barrier
    v_mfma_f32_16x16x32_bf16 v[8:11], v[96:99], v[68:71], v[8:11]
    ds_read_b128 v[48:51], v114 offset:0
    ds_read_b128 v[52:55], v114 offset:256
    v_mfma_f32_16x16x32_bf16 v[16:19], v[96:99], v[72:75], v[16:19]
    ds_read_b128 v[56:59], v114 offset:512
    ds_read_b128 v[60:63], v114 offset:768
    v_mfma_f32_16x16x32_bf16 v[24:27], v[96:99], v[76:79], v[24:27]
    ds_read_b128 v[64:67], v114 offset:1024
    ds_read_b64_tr_b16 v[88:89], v118 offset:0
    v_mfma_f32_16x16x32_bf16 v[32:35], v[96:99], v[80:83], v[32:35]
    ds_read_b64_tr_b16 v[90:91], v118 offset:512
    ds_read_b64_tr_b16 v[92:93], v119 offset:0
    v_mfma_f32_16x16x32_bf16 v[40:43], v[96:99], v[84:87], v[40:43]
    ds_read_b64_tr_b16 v[94:95], v119 offset:512
    v_mfma_f32_16x16x32_bf16 v[12:15], v[100:103], v[68:71], v[12:15]
    v_mfma_f32_16x16x32_bf16 v[20:23], v[100:103], v[72:75], v[20:23]
    v_mfma_f32_16x16x32_bf16 v[28:31], v[100:103], v[76:79], v[28:31]
    v_mfma_f32_16x16x32_bf16 v[36:39], v[100:103], v[80:83], v[36:39]
    v_mfma_f32_16x16x32_bf16 v[44:47], v[100:103], v[84:87], v[44:47]
    s_waitcnt vmcnt(0) lgkmcnt(0)
    s_barrier
    v_mfma_f32_16x16x32_bf16 v[8:11], v[88:91], v[48:51], v[8:11]
    v_mfma_f32_16x16x32_bf16 v[16:19], v[88:91], v[52:55], v[16:19]
    v_mfma_f32_16x16x32_bf16 v[24:27], v[88:91], v[56:59], v[24:27]
    v_mfma_f32_16x16x32_bf16 v[32:35], v[88:91], v[60:63], v[32:35]
    v_mfma_f32_16x16x32_bf16 v[40:43], v[88:91], v[64:67], v[40:43]
    v_mfma_f32_16x16x32_bf16 v[12:15], v[92:95], v[48:51], v[12:15]
    v_mfma_f32_16x16x32_bf16 v[20:23], v[92:95], v[52:55], v[20:23]
    v_mfma_f32_16x16x32_bf16 v[28:31], v[92:95], v[56:59], v[28:31]
    v_mfma_f32_16x16x32_bf16 v[36:39], v[92:95], v[60:63], v[36:39]
    v_mfma_f32_16x16x32_bf16 v[44:47], v[92:95], v[64:67], v[44:47]
    s_lshr_b32 s7, s24, 1
    s_and_b32 s6, s24, 1
    v_and_b32 v2, 63, v0
    s_mul_i32 s4, s6, 10240
    v_lshl_add_u32 v3, v2, 4, s4
    s_nop 7
    s_cmp_eq_u32 s7, 0
    s_cbranch_scc1 Lred_36
    ds_write_b128 v3, v[8:11] offset:0
    ds_write_b128 v3, v[12:15] offset:1024
    ds_write_b128 v3, v[16:19] offset:2048
    ds_write_b128 v3, v[20:23] offset:3072
    ds_write_b128 v3, v[24:27] offset:4096
    ds_write_b128 v3, v[28:31] offset:5120
    ds_write_b128 v3, v[32:35] offset:6144
    ds_write_b128 v3, v[36:39] offset:7168
    ds_write_b128 v3, v[40:43] offset:8192
    ds_write_b128 v3, v[44:47] offset:9216
    s_waitcnt lgkmcnt(0)
    s_barrier
    s_branch Loutend_37
Lred_36:
    s_barrier
    ds_read_b128 v[48:51], v3 offset:0
    ds_read_b128 v[52:55], v3 offset:1024
    ds_read_b128 v[56:59], v3 offset:2048
    ds_read_b128 v[60:63], v3 offset:3072
    ds_read_b128 v[64:67], v3 offset:4096
    ds_read_b128 v[68:71], v3 offset:5120
    ds_read_b128 v[72:75], v3 offset:6144
    ds_read_b128 v[76:79], v3 offset:7168
    ds_read_b128 v[80:83], v3 offset:8192
    ds_read_b128 v[84:87], v3 offset:9216
    v_and_b32 v4, 15, v2
    v_mul_u32_u24 v4, 1152, v4
    v_bfe_u32 v5, v2, 4, 1
    v_lshl_add_u32 v4, v5, 5, v4
    v_lshrrev_b32 v5, 5, v2
    v_lshl_add_u32 v4, v5, 4, v4
    s_mul_i32 s4, s44, 92160
    s_add_u32 s4, s4, s52
    s_lshl_b32 s5, s6, 6
    s_add_u32 s4, s4, s5
    s_waitcnt lgkmcnt(0)
    v_add_f32 v8, v8, v48
    v_add_f32 v9, v9, v49
    v_add_f32 v10, v10, v50
    v_add_f32 v11, v11, v51
    v_add_f32 v12, v12, v52
    v_add_f32 v13, v13, v53
    v_add_f32 v14, v14, v54
    v_add_f32 v15, v15, v55
    v_add_f32 v16, v16, v56
    v_add_f32 v17, v17, v57
    v_add_f32 v18, v18, v58
    v_add_f32 v19, v19, v59
    v_add_f32 v20, v20, v60
    v_add_f32 v21, v21, v61
    v_add_f32 v22, v22, v62
    v_add_f32 v23, v23, v63
    v_add_f32 v24, v24, v64
    v_add_f32 v25, v25, v65
    v_add_f32 v26, v26, v66
    v_add_f32 v27, v27, v67
    v_add_f32 v28, v28, v68
    v_add_f32 v29, v29, v69
    v_add_f32 v30, v30, v70
    v_add_f32 v31, v31, v71
    v_add_f32 v32, v32, v72
    v_add_f32 v33, v33, v73
    v_add_f32 v34, v34, v74
    v_add_f32 v35, v35, v75
    v_add_f32 v36, v36, v76
    v_add_f32 v37, v37, v77
    v_add_f32 v38, v38, v78
    v_add_f32 v39, v39, v79
    v_add_f32 v40, v40, v80
    v_add_f32 v41, v41, v81
    v_add_f32 v42, v42, v82
    v_add_f32 v43, v43, v83
    v_add_f32 v44, v44, v84
    v_add_f32 v45, v45, v85
    v_add_f32 v46, v46, v86
    v_add_f32 v47, v47, v87
    v_cvt_pk_bf16_f32 v96, v8, v9
    v_cvt_pk_bf16_f32 v97, v10, v11
    v_cvt_pk_bf16_f32 v98, v12, v13
    v_cvt_pk_bf16_f32 v99, v14, v15
    s_nop 1
    v_permlane16_swap_b32 v96, v98
    v_permlane16_swap_b32 v97, v99
    buffer_store_dwordx4 v[96:99], v4, s[16:19], s4 offen
    s_add_u32 s4, s4, 18432
    v_cvt_pk_bf16_f32 v100, v16, v17
    v_cvt_pk_bf16_f32 v101, v18, v19
    v_cvt_pk_bf16_f32 v102, v20, v21
    v_cvt_pk_bf16_f32 v103, v22, v23
    s_nop 1
    v_permlane16_swap_b32 v100, v102
    v_permlane16_swap_b32 v101, v103
    buffer_store_dwordx4 v[100:103], v4, s[16:19], s4 offen
    s_add_u32 s4, s4, 18432
    v_cvt_pk_bf16_f32 v96, v24, v25
    v_cvt_pk_bf16_f32 v97, v26, v27
    v_cvt_pk_bf16_f32 v98, v28, v29
    v_cvt_pk_bf16_f32 v99, v30, v31
    s_nop 1
    v_permlane16_swap_b32 v96, v98
    v_permlane16_swap_b32 v97, v99
    buffer_store_dwordx4 v[96:99], v4, s[16:19], s4 offen
    s_add_u32 s4, s4, 18432
    v_cvt_pk_bf16_f32 v100, v32, v33
    v_cvt_pk_bf16_f32 v101, v34, v35
    v_cvt_pk_bf16_f32 v102, v36, v37
    v_cvt_pk_bf16_f32 v103, v38, v39
    s_nop 1
    v_permlane16_swap_b32 v100, v102
    v_permlane16_swap_b32 v101, v103
    buffer_store_dwordx4 v[100:103], v4, s[16:19], s4 offen
    s_add_u32 s4, s4, 18432
    v_cvt_pk_bf16_f32 v96, v40, v41
    v_cvt_pk_bf16_f32 v97, v42, v43
    v_cvt_pk_bf16_f32 v98, v44, v45
    v_cvt_pk_bf16_f32 v99, v46, v47
    s_nop 1
    v_permlane16_swap_b32 v96, v98
    v_permlane16_swap_b32 v97, v99
    buffer_store_dwordx4 v[96:99], v4, s[16:19], s4 offen
Loutend_37:
    s_branch Lgend_9
Lnoout_8:
    s_waitcnt vmcnt(0)
    s_barrier
    s_cmp_lg_u32 s24, 0
    s_cbranch_scc1 Lpub_38
    s_lshl_b32 s4, s53, 2
    s_add_u32 s4, s4, 1024
    v_mov_b32 v2, 1
    buffer_store_dword v2, off, s[56:59], s4 sc1
Lpub_38:
Lgend_9:
    s_endpgm
LA_2:
    s_load_dwordx2 s[80:81], s[0:1], 0
    s_load_dwordx2 s[82:83], s[0:1], 32
    s_load_dwordx2 s[84:85], s[0:1], 8
    s_and_b32 s36, s2, 3
    s_bfe_u32 s37, s2, 0x10002
    s_sub_u32 s38, s2, 256
    s_lshr_b32 s38, s38, 3
    s_mul_i32 s38, s38, 88
    v_and_b32 v2, 63, v0
    s_waitcnt lgkmcnt(0)
    s_mov_b32 s8, s80
    s_mov_b32 s9, s81
    s_and_b32 s9, s9, 0xffff
    s_mov_b32 s10, 2359296
    s_mov_b32 s11, 0x20000
    s_mov_b32 s12, s82
    s_mov_b32 s13, s83
    s_and_b32 s13, s13, 0xffff
    s_mov_b32 s14, 5308416
    s_mov_b32 s15, 0x20000
    s_mov_b32 s20, s84
    s_mov_b32 s21, s85
    s_and_b32 s21, s21, 0xffff
    s_mov_b32 s22, 1990656
    s_mov_b32 s23, 0x20000
    s_lshl_b32 s4, s24, 6
    s_add_u32 s4, s4, 0
    v_add_u32 v3, s4, v2
    v_mul_u32_u24 v4, 11916, v3
    v_lshrrev_b32 v4, 20, v4
    v_mul_u32_u24 v5, 88, v4
    v_sub_u32 v5, v3, v5
    v_add_u32 v5, s38, v5
    v_lshrrev_b32 v6, 7, v5
    v_lshlrev_b32 v6, 2, v6
    v_add_u32 v6, s36, v6
    v_lshlrev_b32 v6, 7, v6
    v_and_b32 v8, 127, v5
    v_add_u32 v6, v6, v8
    v_mul_u32_u24 v6, 1152, v6
    v_lshl_add_u32 v6, v4, 7, v6
    s_mov_b32 s5, 512
    v_cmp_gt_u32 vcc, s5, v5
    v_mov_b32 v9, 0x7ffffff0
    s_mov_b32 s5, 9
    v_cndmask_b32 v6, v9, v6, vcc
    v_cmp_gt_u32 vcc, s5, v4
    s_nop 1
    v_cndmask_b32 v6, v9, v6, vcc
    buffer_load_dword v7, v6, s[8:11], 0 offen
    v_subrev_u32 v5, 512, v5
    v_mul_u32_u24 v8, 1821, v5
    v_lshrrev_b32 v8, 16, v8
    v_mul_u32_u24 v10, 36, v8
    v_sub_u32 v10, v5, v10
    v_lshl_add_u32 v8, v4, 6, v8
    s_mov_b32 s5, 2304
    v_cmp_gt_u32 s[6:7], s5, v5
    v_mul_u32_u24 v11, 9216, v8
    v_lshl_add_u32 v11, v10, 7, v11
    s_mul_i32 s5, s37, 2304
    s_add_u32 s5, s5, 4608
    v_cmp_gt_u32 vcc, 18, v10
    s_nop 1
    s_and_b64 vcc, vcc, s[6:7]
    v_cndmask_b32 v11, v9, v11, vcc
    buffer_load_dword v7, v11, s[12:15], s5 offen
    v_subrev_u32 v10, 18, v10
    v_mul_u32_u24 v11, 3456, v8
    v_lshl_add_u32 v11, v10, 7, v11
    s_mul_i32 s5, s37, 1152
    v_mov_b32 v12, s5
    v_mov_b32 v13, 1152
    v_cmp_gt_u32 vcc, 9, v10
    s_nop 1
    v_cndmask_b32 v12, v13, v12, vcc
    v_add_u32 v11, v11, v12
    v_cmp_gt_u32 vcc, 18, v10
    s_nop 1
    s_and_b64 vcc, vcc, s[6:7]
    v_cndmask_b32 v11, v9, v11, vcc
    buffer_load_dword v7, v11, s[20:23], 0 offen
    s_lshl_b32 s4, s24, 6
    s_add_u32 s4, s4, 256
    v_add_u32 v3, s4, v2
    v_mul_u32_u24 v4, 11916, v3
    v_lshrrev_b32 v4, 20, v4
    v_mul_u32_u24 v5, 88, v4
    v_sub_u32 v5, v3, v5
    v_add_u32 v5, s38, v5
    v_lshrrev_b32 v6, 7, v5
    v_lshlrev_b32 v6, 2, v6
    v_add_u32 v6, s36, v6
    v_lshlrev_b32 v6, 7, v6
    v_and_b32 v8, 127, v5
    v_add_u32 v6, v6, v8
    v_mul_u32_u24 v6, 1152, v6
    v_lshl_add_u32 v6, v4, 7, v6
    s_mov_b32 s5, 512
    v_cmp_gt_u32 vcc, s5, v5
    v_mov_b32 v9, 0x7ffffff0
    s_mov_b32 s5, 9
    v_cndmask_b32 v6, v9, v6, vcc
    v_cmp_gt_u32 vcc, s5, v4
    s_nop 1
    v_cndmask_b32 v6, v9, v6, vcc
    buffer_load_dword v7, v6, s[8:11], 0 offen
    v_subrev_u32 v5, 512, v5
    v_mul_u32_u24 v8, 1821, v5
    v_lshrrev_b32 v8, 16, v8
    v_mul_u32_u24 v10, 36, v8
    v_sub_u32 v10, v5, v10
    v_lshl_add_u32 v8, v4, 6, v8
    s_mov_b32 s5, 2304
    v_cmp_gt_u32 s[6:7], s5, v5
    v_mul_u32_u24 v11, 9216, v8
    v_lshl_add_u32 v11, v10, 7, v11
    s_mul_i32 s5, s37, 2304
    s_add_u32 s5, s5, 4608
    v_cmp_gt_u32 vcc, 18, v10
    s_nop 1
    s_and_b64 vcc, vcc, s[6:7]
    v_cndmask_b32 v11, v9, v11, vcc
    buffer_load_dword v7, v11, s[12:15], s5 offen
    v_subrev_u32 v10, 18, v10
    v_mul_u32_u24 v11, 3456, v8
    v_lshl_add_u32 v11, v10, 7, v11
    s_mul_i32 s5, s37, 1152
    v_mov_b32 v12, s5
    v_mov_b32 v13, 1152
    v_cmp_gt_u32 vcc, 9, v10
    s_nop 1
    v_cndmask_b32 v12, v13, v12, vcc
    v_add_u32 v11, v11, v12
    v_cmp_gt_u32 vcc, 18, v10
    s_nop 1
    s_and_b64 vcc, vcc, s[6:7]
    v_cndmask_b32 v11, v9, v11, vcc
    buffer_load_dword v7, v11, s[20:23], 0 offen
    s_lshl_b32 s4, s24, 6
    s_add_u32 s4, s4, 512
    v_add_u32 v3, s4, v2
    v_mul_u32_u24 v4, 11916, v3
    v_lshrrev_b32 v4, 20, v4
    v_mul_u32_u24 v5, 88, v4
    v_sub_u32 v5, v3, v5
    v_add_u32 v5, s38, v5
    v_lshrrev_b32 v6, 7, v5
    v_lshlrev_b32 v6, 2, v6
    v_add_u32 v6, s36, v6
    v_lshlrev_b32 v6, 7, v6
    v_and_b32 v8, 127, v5
    v_add_u32 v6, v6, v8
    v_mul_u32_u24 v6, 1152, v6
    v_lshl_add_u32 v6, v4, 7, v6
    s_mov_b32 s5, 512
    v_cmp_gt_u32 vcc, s5, v5
    v_mov_b32 v9, 0x7ffffff0
    s_mov_b32 s5, 9
    v_cndmask_b32 v6, v9, v6, vcc
    v_cmp_gt_u32 vcc, s5, v4
    s_nop 1
    v_cndmask_b32 v6, v9, v6, vcc
    buffer_load_dword v7, v6, s[8:11], 0 offen
    v_subrev_u32 v5, 512, v5
    v_mul_u32_u24 v8, 1821, v5
    v_lshrrev_b32 v8, 16, v8
    v_mul_u32_u24 v10, 36, v8
    v_sub_u32 v10, v5, v10
    v_lshl_add_u32 v8, v4, 6, v8
    s_mov_b32 s5, 2304
    v_cmp_gt_u32 s[6:7], s5, v5
    v_mul_u32_u24 v11, 9216, v8
    v_lshl_add_u32 v11, v10, 7, v11
    s_mul_i32 s5, s37, 2304
    s_add_u32 s5, s5, 4608
    v_cmp_gt_u32 vcc, 18, v10
    s_nop 1
    s_and_b64 vcc, vcc, s[6:7]
    v_cndmask_b32 v11, v9, v11, vcc
    buffer_load_dword v7, v11, s[12:15], s5 offen
    v_subrev_u32 v10, 18, v10
    v_mul_u32_u24 v11, 3456, v8
    v_lshl_add_u32 v11, v10, 7, v11
    s_mul_i32 s5, s37, 1152
    v_mov_b32 v12, s5
    v_mov_b32 v13, 1152
    v_cmp_gt_u32 vcc, 9, v10
    s_nop 1
    v_cndmask_b32 v12, v13, v12, vcc
    v_add_u32 v11, v11, v12
    v_cmp_gt_u32 vcc, 18, v10
    s_nop 1
    s_and_b64 vcc, vcc, s[6:7]
    v_cndmask_b32 v11, v9, v11, vcc
    buffer_load_dword v7, v11, s[20:23], 0 offen
    s_lshl_b32 s4, s24, 6
    s_add_u32 s4, s4, 768
    v_add_u32 v3, s4, v2
    v_mul_u32_u24 v4, 11916, v3
    v_lshrrev_b32 v4, 20, v4
    v_mul_u32_u24 v5, 88, v4
    v_sub_u32 v5, v3, v5
    v_add_u32 v5, s38, v5
    v_lshrrev_b32 v6, 7, v5
    v_lshlrev_b32 v6, 2, v6
    v_add_u32 v6, s36, v6
    v_lshlrev_b32 v6, 7, v6
    v_and_b32 v8, 127, v5
    v_add_u32 v6, v6, v8
    v_mul_u32_u24 v6, 1152, v6
    v_lshl_add_u32 v6, v4, 7, v6
    s_mov_b32 s5, 512
    v_cmp_gt_u32 vcc, s5, v5
    v_mov_b32 v9, 0x7ffffff0
    s_mov_b32 s5, 9
    v_cndmask_b32 v6, v9, v6, vcc
    v_cmp_gt_u32 vcc, s5, v4
    s_nop 1
    v_cndmask_b32 v6, v9, v6, vcc
    buffer_load_dword v7, v6, s[8:11], 0 offen
    v_subrev_u32 v5, 512, v5
    v_mul_u32_u24 v8, 1821, v5
    v_lshrrev_b32 v8, 16, v8
    v_mul_u32_u24 v10, 36, v8
    v_sub_u32 v10, v5, v10
    v_lshl_add_u32 v8, v4, 6, v8
    s_mov_b32 s5, 2304
    v_cmp_gt_u32 s[6:7], s5, v5
    v_mul_u32_u24 v11, 9216, v8
    v_lshl_add_u32 v11, v10, 7, v11
    s_mul_i32 s5, s37, 2304
    s_add_u32 s5, s5, 4608
    v_cmp_gt_u32 vcc, 18, v10
    s_nop 1
    s_and_b64 vcc, vcc, s[6:7]
    v_cndmask_b32 v11, v9, v11, vcc
    buffer_load_dword v7, v11, s[12:15], s5 offen
    v_subrev_u32 v10, 18, v10
    v_mul_u32_u24 v11, 3456, v8
    v_lshl_add_u32 v11, v10, 7, v11
    s_mul_i32 s5, s37, 1152
    v_mov_b32 v12, s5
    v_mov_b32 v13, 1152
    v_cmp_gt_u32 vcc, 9, v10
    s_nop 1
    v_cndmask_b32 v12, v13, v12, vcc
    v_add_u32 v11, v11, v12
    v_cmp_gt_u32 vcc, 18, v10
    s_nop 1
    s_and_b64 vcc, vcc, s[6:7]
    v_cndmask_b32 v11, v9, v11, vcc
    buffer_load_dword v7, v11, s[20:23], 0 offen
    s_cmp_lt_u32 s2, 384
    s_cbranch_scc1 Lqk_6
    s_load_dwordx2 s[94:95], s[0:1], 32
    s_sub_u32 s4, s2, 384
    s_lshl_b32 s4, s4, 2
    s_add_u32 s4, s4, s24
    v_and_b32 v2, 63, v0
    s_lshl_b32 s5, s4, 6
    v_add_u32 v3, s5, v2
    s_waitcnt lgkmcnt(0)
    s_mov_b32 s12, s94
    s_mov_b32 s13, s95
    s_and_b32 s13, s13, 0xffff
    s_mov_b32 s14, 5308416
    s_mov_b32 s15, 0x20000
    v_mul_u32_u24 v5, 58255, v3
    v_lshrrev_b32 v5, 21, v5
    v_mul_u32_u24 v6, 36, v5
    v_sub_u32 v6, v3, v6
    v_mul_u32_u24 v5, 9216, v5
    v_lshl_add_u32 v5, v6, 7, v5
    s_mov_b32 s5, 20736
    v_cmp_gt_u32 vcc, s5, v3
    v_mov_b32 v6, 0x7ffffff0
    s_nop 0
    v_cndmask_b32 v5, v6, v5, vcc
    buffer_load_dword v246, v5, s[12:15], 0 offen
    s_load_dwordx2 s[84:85], s[0:1], 88
    s_waitcnt lgkmcnt(0)
    s_add_u32 s56, s84, 39845888
    s_addc_u32 s57, s85, 0
    s_and_b32 s57, s57, 0xffff
    s_mov_b32 s58, 16384
    s_mov_b32 s59, 0x20000
    s_cmp_lg_u32 s24, 0
    s_cbranch_scc1 Lrdyok_40
    s_mov_b32 s20, s32
    s_mov_b32 s21, s33
    s_and_b32 s21, s21, 0xffff
    s_mov_b32 s22, 256
    s_mov_b32 s23, 0x20000
    s_mov_b32 s5, 0
Lrdy_39:
    buffer_load_dword v2, off, s[20:23], 0 sc1
    s_waitcnt vmcnt(0)
    v_readfirstlane_b32 s6, v2
    s_add_u32 s5, s5, 1
    s_nop 2
    s_cmp_lg_u32 s6, 0
    s_cbranch_scc1 Lrdyok_40
    s_sleep 8
    s_cmp_lt_u32 s5, 0x20000
    s_cbranch_scc1 Lrdy_39
Lrdyok_40:
    s_cmp_lt_u32 s2, 448
    s_cbranch_scc1 Lnobig_41
    s_load_dwordx2 s[88:89], s[0:1], 40
    s_load_dwordx2 s[90:91], s[0:1], 56
    s_load_dwordx2 s[92:93], s[0:1], 16
    s_sub_u32 s4, s2, 448
    s_lshl_b32 s4, s4, 2
    s_add_u32 s4, s4, s24
    s_lshl_b32 s4, s4, 6
    v_and_b32 v2, 63, v0
    v_add_u32 v3, s4, v2
    v_lshlrev_b32 v4, 7, v3
    s_waitcnt lgkmcnt(0)
    s_mov_b32 s8, s88
    s_mov_b32 s9, s89
    s_and_b32 s9, s9, 0xffff
    s_mov_b32 s10, 8388608
    s_mov_b32 s11, 0x20000
    v_add_u32 v5, 0, v3
    v_lshrrev_b32 v6, 5, v5
    v_and_b32 v5, 31, v5
    v_lshlrev_b32 v6, 12, v6
    v_lshl_add_u32 v5, v5, 7, v6
    buffer_load_dword v246, v5, s[8:11], 0 offen
    v_add_u32 v5, 16384, v3
    v_lshrrev_b32 v6, 5, v5
    v_and_b32 v5, 31, v5
    v_lshlrev_b32 v6, 12, v6
    v_lshl_add_u32 v5, v5, 7, v6
    buffer_load_dword v246, v5, s[8:11], 0 offen
    v_add_u32 v5, 32768, v3
    v_lshrrev_b32 v6, 5, v5
    v_and_b32 v5, 31, v5
    v_lshlrev_b32 v6, 12, v6
    v_lshl_add_u32 v5, v5, 7, v6
    buffer_load_dword v246, v5, s[8:11], 0 offen
    v_add_u32 v5, 49152, v3
    v_lshrrev_b32 v6, 5, v5
    v_and_b32 v5, 31, v5
    v_lshlrev_b32 v6, 12, v6
    v_lshl_add_u32 v5, v5, 7, v6
    buffer_load_dword v246, v5, s[8:11], 0 offen
Lnobig_41:
    s_branch Latt_7
Lqk_6:
    s_sub_u32 s31, s2, 256
    s_load_dwordx2 s[80:81], s[0:1], 0
    s_load_dwordx2 s[82:83], s[0:1], 8
    s_load_dwordx2 s[84:85], s[0:1], 88
    s_and_b32 s4, s31, 3
    s_lshr_b32 s5, s31, 3
    s_and_b32 s38, s5, 3
    s_lshl_b32 s6, s38, 2
    s_add_u32 s40, s4, s6
    s_bfe_u32 s6, s31, 0x10002
    s_lshl_b32 s6, s6, 2
    s_lshr_b32 s39, s5, 2
    s_add_u32 s41, s6, s39
    s_waitcnt lgkmcnt(0)
    s_mov_b32 s8, s80
    s_mov_b32 s9, s81
    s_and_b32 s9, s9, 0xffff
    s_mov_b32 s10, 2359296
    s_mov_b32 s11, 0x20000
    s_mov_b32 s12, s82
    s_mov_b32 s13, s83
    s_and_b32 s13, s13, 0xffff
    s_mov_b32 s14, 1990656
    s_mov_b32 s15, 0x20000
    s_add_u32 s16, s84, 18874368
    s_addc_u32 s17, s85, 0
    s_and_b32 s17, s17, 0xffff
    s_mov_b32 s18, 4194304
    s_mov_b32 s19, 0x20000
    s_add_u32 s20, s84, 23068672
    s_addc_u32 s21, s85, 0
    s_and_b32 s21, s21, 0xffff
    s_mov_b32 s22, 524288
    s_mov_b32 s23, 0x20000
    v_and_b32 v2, 63, v0
    v_lshrrev_b32 v3, 3, v2
    s_lshl_b32 s4, s24, 5
    v_add_u32 v3, s4, v3
    s_mov_b32 s5, 1152
    v_mul_lo_u32 v3, v3, s5
    v_lshrrev_b32 v4, 4, v2
    v_and_b32 v5, 7, v2
    v_xor_b32 v6, v5, v4
    v_lshlrev_b32 v6, 4, v6
    v_add_u32 v184, v3, v6
    v_xor_b32 v6, 64, v6
    v_add_u32 v185, v3, v6
    v_add_u32 v186, 16384, v184
    v_add_u32 v185, 8192, v185
    v_add_u32 v187, 16384, v185
    v_and_b32 v3, 15, v2
    v_lshrrev_b32 v5, 1, v3
    v_xor_b32 v5, v5, v4
    v_lshlrev_b32 v5, 4, v5
    v_lshlrev_b32 v3, 7, v3
    v_add_u32 v3, v3, v5
    s_lshl_b32 s4, s24, 13
    s_add_u32 s27, s4, 36864
    v_add_u32 v191, s27, v3
    v_xor_b32 v192, 64, v191
    v_and_b32 v2, 63, v0
    s_mul_i32 s28, s24, 2304
    s_lshl_b32 s4, s24, 3
    s_mov_b32 s5, 3456
    v_add_u32 v3, 0, v2
    v_mul_u32_u24 v4, 3641, v3
    v_lshrrev_b32 v4, 16, v4
    v_mul_u32_u24 v5, 18, v4
    v_sub_u32 v5, v3, v5
    v_add_u32 v4, s4, v4
    v_and_b32 v3, 4, v4
    v_lshlrev_b32 v3, 1, v3
    v_and_b32 v6, 8, v4
    v_lshrrev_b32 v6, 1, v6
    v_and_b32 v4, 0x33, v4
    v_or3_b32 v4, v4, v3, v6
    v_mul_lo_u32 v4, v4, s5
    v_lshl_add_u32 v4, v5, 4, v4
    v_mov_b32 v188, v4
    v_add_u32 v3, 64, v2
    v_mul_u32_u24 v4, 3641, v3
    v_lshrrev_b32 v4, 16, v4
    v_mul_u32_u24 v5, 18, v4
    v_sub_u32 v5, v3, v5
    v_add_u32 v4, s4, v4
    v_and_b32 v3, 4, v4
    v_lshlrev_b32 v3, 1, v3
    v_and_b32 v6, 8, v4
    v_lshrrev_b32 v6, 1, v6
    v_and_b32 v4, 0x33, v4
    v_or3_b32 v4, v4, v3, v6
    v_mul_lo_u32 v4, v4, s5
    v_lshl_add_u32 v4, v5, 4, v4
    v_subrev_u32 v189, 1024, v4
    v_lshrrev_b32 v3, 2, v2
    v_add_u32 v3, 128, v3
    v_mul_u32_u24 v4, 3641, v3
    v_lshrrev_b32 v4, 16, v4
    v_mul_u32_u24 v5, 18, v4
    v_sub_u32 v5, v3, v5
    v_add_u32 v4, s4, v4
    v_and_b32 v3, 4, v4
    v_lshlrev_b32 v3, 1, v3
    v_and_b32 v6, 8, v4
    v_lshrrev_b32 v6, 1, v6
    v_and_b32 v4, 0x33, v4
    v_or3_b32 v4, v4, v3, v6
    v_mul_lo_u32 v4, v4, s5
    v_lshl_add_u32 v4, v5, 4, v4
    v_and_b32 v5, 3, v2
    v_lshl_add_u32 v4, v5, 2, v4
    v_subrev_u32 v190, 2048, v4
    v_lshrrev_b32 v3, 5, v2
    v_lshlrev_b32 v3, 4, v3
    v_bfe_u32 v4, v2, 4, 1
    v_lshl_add_u32 v3, v4, 2, v3
    v_bfe_u32 v4, v2, 2, 2
    v_add_u32 v3, v3, v4
    v_mul_u32_u24 v3, 288, v3
    v_and_b32 v4, 3, v2
    v_lshl_add_u32 v193, v4, 3, v3
    s_mul_i32 s25, s40, 147456
    s_mul_i32 s26, s41, 288
    s_add_u32 m0, s28, 0
    s_nop 0
    buffer_load_dwordx4 v188, s[12:15], s26 offen lds
    buffer_load_dwordx4 v189, s[12:15], s26 offen offset:1024 lds
    buffer_load_dword v190, s[12:15], s26 offen offset:2048 lds
    s_add_u32 s26, s26, 110592
    s_add_u32 m0, s27, 0
    s_nop 0
    buffer_load_dwordx4 v184, s[8:11], s25 offen lds
    buffer_load_dwordx4 v185, s[8:11], s25 offen offset:1024 lds
    buffer_load_dwordx4 v186, s[8:11], s25 offen offset:2048 lds
    buffer_load_dwordx4 v187, s[8:11], s25 offen offset:3072 lds
    s_add_u32 s25, s25, 128
    s_add_u32 m0, s28, 9216
    s_nop 0
    buffer_load_dwordx4 v188, s[12:15], s26 offen lds
    buffer_load_dwordx4 v189, s[12:15], s26 offen offset:1024 lds
    buffer_load_dword v190, s[12:15], s26 offen offset:2048 lds
    s_add_u32 s26, s26, 110592
    s_add_u32 m0, s28, 18432
    s_nop 0
    buffer_load_dwordx4 v188, s[12:15], s26 offen lds
    buffer_load_dwordx4 v189, s[12:15], s26 offen offset:1024 lds
    buffer_load_dword v190, s[12:15], s26 offen offset:2048 lds
    s_add_u32 s26, s26, 110592
    s_add_u32 m0, s27, 4096
    s_nop 0
    buffer_load_dwordx4 v184, s[8:11], s25 offen lds
    buffer_load_dwordx4 v185, s[8:11], s25 offen offset:1024 lds
    buffer_load_dwordx4 v186, s[8:11], s25 offen offset:2048 lds
    buffer_load_dwordx4 v187, s[8:11], s25 offen offset:3072 lds
    s_add_u32 s25, s25, 128
    s_add_u32 m0, s28, 27648
    s_nop 0
    buffer_load_dwordx4 v188, s[12:15], s26 offen lds
    buffer_load_dwordx4 v189, s[12:15], s26 offen offset:1024 lds
    buffer_load_dword v190, s[12:15], s26 offen offset:2048 lds
    s_add_u32 s26, s26, 110592
    v_mov_b32 v8, 0
    v_mov_b32 v9, 0
    v_mov_b32 v10, 0
    v_mov_b32 v11, 0
    v_mov_b32 v12, 0
    v_mov_b32 v13, 0
    v_mov_b32 v14, 0
    v_mov_b32 v15, 0
    v_mov_b32 v16, 0
    v_mov_b32 v17, 0
    v_mov_b32 v18, 0
    v_mov_b32 v19, 0
    v_mov_b32 v20, 0
    v_mov_b32 v21, 0
    v_mov_b32 v22, 0
    v_mov_b32 v23, 0
    v_mov_b32 v24, 0
    v_mov_b32 v25, 0
    v_mov_b32 v26, 0
    v_mov_b32 v27, 0
    v_mov_b32 v28, 0
    v_mov_b32 v29, 0
    v_mov_b32 v30, 0
    v_mov_b32 v31, 0
    v_mov_b32 v32, 0
    v_mov_b32 v33, 0
    v_mov_b32 v34, 0
    v_mov_b32 v35, 0
    v_mov_b32 v36, 0
    v_mov_b32 v37, 0
    v_mov_b32 v38, 0
    v_mov_b32 v39, 0
    v_mov_b32 v40, 0
    v_mov_b32 v41, 0
    v_mov_b32 v42, 0
    v_mov_b32 v43, 0
    v_mov_b32 v44, 0
    v_mov_b32 v45, 0
    v_mov_b32 v46, 0
    v_mov_b32 v47, 0
    v_mov_b32 v48, 0
    v_mov_b32 v49, 0
    v_mov_b32 v50, 0
    v_mov_b32 v51, 0
    v_mov_b32 v52, 0
    v_mov_b32 v53, 0
    v_mov_b32 v54, 0
    v_mov_b32 v55, 0
    v_mov_b32 v56, 0
    v_mov_b32 v57, 0
    v_mov_b32 v58, 0
    v_mov_b32 v59, 0
    v_mov_b32 v60, 0
    v_mov_b32 v61, 0
    v_mov_b32 v62, 0
    v_mov_b32 v63, 0
    v_mov_b32 v64, 0
    v_mov_b32 v65, 0
    v_mov_b32 v66, 0
    v_mov_b32 v67, 0
    v_mov_b32 v68, 0
    v_mov_b32 v69, 0
    v_mov_b32 v70, 0
    v_mov_b32 v71, 0
    v_mov_b32 v72, 0
    v_mov_b32 v73, 0
    v_mov_b32 v74, 0
    v_mov_b32 v75, 0
    v_mov_b32 v76, 0
    v_mov_b32 v77, 0
    v_mov_b32 v78, 0
    v_mov_b32 v79, 0
    s_waitcnt vmcnt(13)
    s_barrier
    ds_read_b128 v[152:155], v191 offset:0
    ds_read_b128 v[156:159], v191 offset:2048
    ds_read_b128 v[160:163], v192 offset:0
    ds_read_b128 v[164:167], v192 offset:2048
    ds_read_b64_tr_b16 v[80:81], v193 offset:0
    ds_read_b64_tr_b16 v[82:83], v193 offset:2304
    ds_read_b64_tr_b16 v[84:85], v193 offset:32
    ds_read_b64_tr_b16 v[86:87], v193 offset:2336
    ds_read_b64_tr_b16 v[88:89], v193 offset:64
    ds_read_b64_tr_b16 v[90:91], v193 offset:2368
    ds_read_b64_tr_b16 v[92:93], v193 offset:96
    ds_read_b64_tr_b16 v[94:95], v193 offset:2400
    ds_read_b64_tr_b16 v[96:97], v193 offset:128
    ds_read_b64_tr_b16 v[98:99], v193 offset:2432
    ds_read_b64_tr_b16 v[100:101], v193 offset:160
    ds_read_b64_tr_b16 v[102:103], v193 offset:2464
    ds_read_b64_tr_b16 v[104:105], v193 offset:192
    ds_read_b64_tr_b16 v[106:107], v193 offset:2496
    ds_read_b64_tr_b16 v[108:109], v193 offset:224
    ds_read_b64_tr_b16 v[110:111], v193 offset:2528
    ds_read_b64_tr_b16 v[112:113], v193 offset:256
    ds_read_b64_tr_b16 v[114:115], v193 offset:2560
    s_mov_b32 s30, 3
Lk_42:
    s_waitcnt vmcnt(10) lgkmcnt(0)
    s_barrier
    v_mfma_f32_16x16x32_bf16 v[8:11], v[80:83], v[152:155], v[8:11]
    ds_read_b64_tr_b16 v[116:117], v193 offset:9216
    s_add_u32 m0, s28, 0
    v_mfma_f32_16x16x32_bf16 v[44:47], v[80:83], v[156:159], v[44:47]
    buffer_load_dwordx4 v188, s[12:15], s26 offen lds
    ds_read_b64_tr_b16 v[118:119], v193 offset:11520
    v_mfma_f32_16x16x32_bf16 v[12:15], v[84:87], v[152:155], v[12:15]
    ds_read_b64_tr_b16 v[120:121], v193 offset:9248
    ds_read_b64_tr_b16 v[122:123], v193 offset:11552
    v_mfma_f32_16x16x32_bf16 v[48:51], v[84:87], v[156:159], v[48:51]
    buffer_load_dwordx4 v189, s[12:15], s26 offen offset:1024 lds
    ds_read_b64_tr_b16 v[124:125], v193 offset:9280
    v_mfma_f32_16x16x32_bf16 v[16:19], v[88:91], v[152:155], v[16:19]
    ds_read_b64_tr_b16 v[126:127], v193 offset:11584
    ds_read_b64_tr_b16 v[128:129], v193 offset:9312
    v_mfma_f32_16x16x32_bf16 v[52:55], v[88:91], v[156:159], v[52:55]
    buffer_load_dword v190, s[12:15], s26 offen offset:2048 lds
    s_add_u32 s26, s26, 110592
    v_mfma_f32_16x16x32_bf16 v[20:23], v[92:95], v[152:155], v[20:23]
    ds_read_b64_tr_b16 v[130:131], v193 offset:11616
    ds_read_b64_tr_b16 v[132:133], v193 offset:9344
    v_mfma_f32_16x16x32_bf16 v[56:59], v[92:95], v[156:159], v[56:59]
    ds_read_b64_tr_b16 v[134:135], v193 offset:11648
    s_add_u32 m0, s27, 0
    v_mfma_f32_16x16x32_bf16 v[24:27], v[96:99], v[152:155], v[24:27]
    buffer_load_dwordx4 v184, s[8:11], s25 offen lds
    ds_read_b64_tr_b16 v[136:137], v193 offset:9376
    v_mfma_f32_16x16x32_bf16 v[60:63], v[96:99], v[156:159], v[60:63]
    ds_read_b64_tr_b16 v[138:139], v193 offset:11680
    ds_read_b64_tr_b16 v[140:141], v193 offset:9408
    v_mfma_f32_16x16x32_bf16 v[28:31], v[100:103], v[152:155], v[28:31]
    buffer_load_dwordx4 v185, s[8:11], s25 offen offset:1024 lds
    ds_read_b64_tr_b16 v[142:143], v193 offset:11712
    v_mfma_f32_16x16x32_bf16 v[64:67], v[100:103], v[156:159], v[64:67]
    ds_read_b64_tr_b16 v[144:145], v193 offset:9440
    ds_read_b64_tr_b16 v[146:147], v193 offset:11744
    v_mfma_f32_16x16x32_bf16 v[32:35], v[104:107], v[152:155], v[32:35]
    ds_read_b64_tr_b16 v[148:149], v193 offset:9472
    ds_read_b64_tr_b16 v[150:151], v193 offset:11776
    v_mfma_f32_16x16x32_bf16 v[68:71], v[104:107], v[156:159], v[68:71]
    buffer_load_dwordx4 v186, s[8:11], s25 offen offset:2048 lds
    v_mfma_f32_16x16x32_bf16 v[36:39], v[108:111], v[152:155], v[36:39]
    v_mfma_f32_16x16x32_bf16 v[72:75], v[108:111], v[156:159], v[72:75]
    buffer_load_dwordx4 v187, s[8:11], s25 offen offset:3072 lds
    s_add_u32 s25, s25, 128
    v_mfma_f32_16x16x32_bf16 v[40:43], v[112:115], v[152:155], v[40:43]
    v_mfma_f32_16x16x32_bf16 v[76:79], v[112:115], v[156:159], v[76:79]
    s_waitcnt vmcnt(10) lgkmcnt(0)
    s_barrier
    v_mfma_f32_16x16x32_bf16 v[8:11], v[116:119], v[160:163], v[8:11]
    ds_read_b128 v[168:171], v191 offset:4096
    s_add_u32 m0, s28, 9216
    v_mfma_f32_16x16x32_bf16 v[44:47], v[116:119], v[164:167], v[44:47]
    buffer_load_dwordx4 v188, s[12:15], s26 offen lds
    ds_read_b128 v[172:175], v191 offset:6144
    v_mfma_f32_16x16x32_bf16 v[12:15], v[120:123], v[160:163], v[12:15]
    ds_read_b128 v[176:179], v192 offset:4096
    ds_read_b128 v[180:183], v192 offset:6144
    v_mfma_f32_16x16x32_bf16 v[48:51], v[120:123], v[164:167], v[48:51]
    ds_read_b64_tr_b16 v[80:81], v193 offset:18432
    ds_read_b64_tr_b16 v[82:83], v193 offset:20736
    v_mfma_f32_16x16x32_bf16 v[16:19], v[124:127], v[160:163], v[16:19]
    ds_read_b64_tr_b16 v[84:85], v193 offset:18464
    ds_read_b64_tr_b16 v[86:87], v193 offset:20768
    v_mfma_f32_16x16x32_bf16 v[52:55], v[124:127], v[164:167], v[52:55]
    ds_read_b64_tr_b16 v[88:89], v193 offset:18496
    ds_read_b64_tr_b16 v[90:91], v193 offset:20800
    v_mfma_f32_16x16x32_bf16 v[20:23], v[128:131], v[160:163], v[20:23]
    buffer_load_dwordx4 v189, s[12:15], s26 offen offset:1024 lds
    ds_read_b64_tr_b16 v[92:93], v193 offset:18528
    v_mfma_f32_16x16x32_bf16 v[56:59], v[128:131], v[164:167], v[56:59]
    ds_read_b64_tr_b16 v[94:95], v193 offset:20832
    ds_read_b64_tr_b16 v[96:97], v193 offset:18560
    v_mfma_f32_16x16x32_bf16 v[24:27], v[132:135], v[160:163], v[24:27]
    ds_read_b64_tr_b16 v[98:99], v193 offset:20864
    ds_read_b64_tr_b16 v[100:101], v193 offset:18592
    v_mfma_f32_16x16x32_bf16 v[60:63], v[132:135], v[164:167], v[60:63]
    ds_read_b64_tr_b16 v[102:103], v193 offset:20896
    ds_read_b64_tr_b16 v[104:105], v193 offset:18624
    v_mfma_f32_16x16x32_bf16 v[28:31], v[136:139], v[160:163], v[28:31]
    ds_read_b64_tr_b16 v[106:107], v193 offset:20928
    ds_read_b64_tr_b16 v[108:109], v193 offset:18656
    v_mfma_f32_16x16x32_bf16 v[64:67], v[136:139], v[164:167], v[64:67]
    ds_read_b64_tr_b16 v[110:111], v193 offset:20960
    ds_read_b64_tr_b16 v[112:113], v193 offset:18688
    v_mfma_f32_16x16x32_bf16 v[32:35], v[140:143], v[160:163], v[32:35]
    buffer_load_dword v190, s[12:15], s26 offen offset:2048 lds
    s_add_u32 s26, s26, 110592
    v_mfma_f32_16x16x32_bf16 v[68:71], v[140:143], v[164:167], v[68:71]
    ds_read_b64_tr_b16 v[114:115], v193 offset:20992
    v_mfma_f32_16x16x32_bf16 v[36:39], v[144:147], v[160:163], v[36:39]
    v_mfma_f32_16x16x32_bf16 v[72:75], v[144:147], v[164:167], v[72:75]
    v_mfma_f32_16x16x32_bf16 v[40:43], v[148:151], v[160:163], v[40:43]
    v_mfma_f32_16x16x32_bf16 v[76:79], v[148:151], v[164:167], v[76:79]
    s_waitcnt vmcnt(10) lgkmcnt(0)
    s_barrier
    v_mfma_f32_16x16x32_bf16 v[8:11], v[80:83], v[168:171], v[8:11]
    ds_read_b64_tr_b16 v[116:117], v193 offset:27648
    s_add_u32 m0, s28, 18432
    v_mfma_f32_16x16x32_bf16 v[44:47], v[80:83], v[172:175], v[44:47]
    buffer_load_dwordx4 v188, s[12:15], s26 offen lds
    ds_read_b64_tr_b16 v[118:119], v193 offset:29952
    v_mfma_f32_16x16x32_bf16 v[12:15], v[84:87], v[168:171], v[12:15]
    ds_read_b64_tr_b16 v[120:121], v193 offset:27680
    ds_read_b64_tr_b16 v[122:123], v193 offset:29984
    v_mfma_f32_16x16x32_bf16 v[48:51], v[84:87], v[172:175], v[48:51]
    buffer_load_dwordx4 v189, s[12:15], s26 offen offset:1024 lds
    ds_read_b64_tr_b16 v[124:125], v193 offset:27712
    v_mfma_f32_16x16x32_bf16 v[16:19], v[88:91], v[168:171], v[16:19]
    ds_read_b64_tr_b16 v[126:127], v193 offset:30016
    ds_read_b64_tr_b16 v[128:129], v193 offset:27744
    v_mfma_f32_16x16x32_bf16 v[52:55], v[88:91], v[172:175], v[52:55]
    buffer_load_dword v190, s[12:15], s26 offen offset:2048 lds
    s_add_u32 s26, s26, 110592
    v_mfma_f32_16x16x32_bf16 v[20:23], v[92:95], v[168:171], v[20:23]
    ds_read_b64_tr_b16 v[130:131], v193 offset:30048
    ds_read_b64_tr_b16 v[132:133], v193 offset:27776
    v_mfma_f32_16x16x32_bf16 v[56:59], v[92:95], v[172:175], v[56:59]
    ds_read_b64_tr_b16 v[134:135], v193 offset:30080
    s_add_u32 m0, s27, 4096
    v_mfma_f32_16x16x32_bf16 v[24:27], v[96:99], v[168:171], v[24:27]
    buffer_load_dwordx4 v184, s[8:11], s25 offen lds
    ds_read_b64_tr_b16 v[136:137], v193 offset:27808
    v_mfma_f32_16x16x32_bf16 v[60:63], v[96:99], v[172:175], v[60:63]
    ds_read_b64_tr_b16 v[138:139], v193 offset:30112
    ds_read_b64_tr_b16 v[140:141], v193 offset:27840
    v_mfma_f32_16x16x32_bf16 v[28:31], v[100:103], v[168:171], v[28:31]
    buffer_load_dwordx4 v185, s[8:11], s25 offen offset:1024 lds
    ds_read_b64_tr_b16 v[142:143], v193 offset:30144
    v_mfma_f32_16x16x32_bf16 v[64:67], v[100:103], v[172:175], v[64:67]
    ds_read_b64_tr_b16 v[144:145], v193 offset:27872
    ds_read_b64_tr_b16 v[146:147], v193 offset:30176
    v_mfma_f32_16x16x32_bf16 v[32:35], v[104:107], v[168:171], v[32:35]
    ds_read_b64_tr_b16 v[148:149], v193 offset:27904
    ds_read_b64_tr_b16 v[150:151], v193 offset:30208
    v_mfma_f32_16x16x32_bf16 v[68:71], v[104:107], v[172:175], v[68:71]
    buffer_load_dwordx4 v186, s[8:11], s25 offen offset:2048 lds
    v_mfma_f32_16x16x32_bf16 v[36:39], v[108:111], v[168:171], v[36:39]
    v_mfma_f32_16x16x32_bf16 v[72:75], v[108:111], v[172:175], v[72:75]
    buffer_load_dwordx4 v187, s[8:11], s25 offen offset:3072 lds
    s_add_u32 s25, s25, 128
    v_mfma_f32_16x16x32_bf16 v[40:43], v[112:115], v[168:171], v[40:43]
    v_mfma_f32_16x16x32_bf16 v[76:79], v[112:115], v[172:175], v[76:79]
    s_waitcnt vmcnt(10) lgkmcnt(0)
    s_barrier
    v_mfma_f32_16x16x32_bf16 v[8:11], v[116:119], v[176:179], v[8:11]
    ds_read_b128 v[152:155], v191 offset:0
    s_add_u32 m0, s28, 27648
    v_mfma_f32_16x16x32_bf16 v[44:47], v[116:119], v[180:183], v[44:47]
    buffer_load_dwordx4 v188, s[12:15], s26 offen lds
    ds_read_b128 v[156:159], v191 offset:2048
    v_mfma_f32_16x16x32_bf16 v[12:15], v[120:123], v[176:179], v[12:15]
    ds_read_b128 v[160:163], v192 offset:0
    ds_read_b128 v[164:167], v192 offset:2048
    v_mfma_f32_16x16x32_bf16 v[48:51], v[120:123], v[180:183], v[48:51]
    ds_read_b64_tr_b16 v[80:81], v193 offset:0
    ds_read_b64_tr_b16 v[82:83], v193 offset:2304
    v_mfma_f32_16x16x32_bf16 v[16:19], v[124:127], v[176:179], v[16:19]
    ds_read_b64_tr_b16 v[84:85], v193 offset:32
    ds_read_b64_tr_b16 v[86:87], v193 offset:2336
    v_mfma_f32_16x16x32_bf16 v[52:55], v[124:127], v[180:183], v[52:55]
    ds_read_b64_tr_b16 v[88:89], v193 offset:64
    ds_read_b64_tr_b16 v[90:91], v193 offset:2368
    v_mfma_f32_16x16x32_bf16 v[20:23], v[128:131], v[176:179], v[20:23]
    buffer_load_dwordx4 v189, s[12:15], s26 offen offset:1024 lds
    ds_read_b64_tr_b16 v[92:93], v193 offset:96
    v_mfma_f32_16x16x32_bf16 v[56:59], v[128:131], v[180:183], v[56:59]
    ds_read_b64_tr_b16 v[94:95], v193 offset:2400
    ds_read_b64_tr_b16 v[96:97], v193 offset:128
    v_mfma_f32_16x16x32_bf16 v[24:27], v[132:135], v[176:179], v[24:27]
    ds_read_b64_tr_b16 v[98:99], v193 offset:2432
    ds_read_b64_tr_b16 v[100:101], v193 offset:160
    v_mfma_f32_16x16x32_bf16 v[60:63], v[132:135], v[180:183], v[60:63]
    ds_read_b64_tr_b16 v[102:103], v193 offset:2464
    ds_read_b64_tr_b16 v[104:105], v193 offset:192
    v_mfma_f32_16x16x32_bf16 v[28:31], v[136:139], v[176:179], v[28:31]
    ds_read_b64_tr_b16 v[106:107], v193 offset:2496
    ds_read_b64_tr_b16 v[108:109], v193 offset:224
    v_mfma_f32_16x16x32_bf16 v[64:67], v[136:139], v[180:183], v[64:67]
    ds_read_b64_tr_b16 v[110:111], v193 offset:2528
    ds_read_b64_tr_b16 v[112:113], v193 offset:256
    v_mfma_f32_16x16x32_bf16 v[32:35], v[140:143], v[176:179], v[32:35]
    buffer_load_dword v190, s[12:15], s26 offen offset:2048 lds
    s_add_u32 s26, s26, 110592
    v_mfma_f32_16x16x32_bf16 v[68:71], v[140:143], v[180:183], v[68:71]
    ds_read_b64_tr_b16 v[114:115], v193 offset:2560
    v_mfma_f32_16x16x32_bf16 v[36:39], v[144:147], v[176:179], v[36:39]
    v_mfma_f32_16x16x32_bf16 v[72:75], v[144:147], v[180:183], v[72:75]
    v_mfma_f32_16x16x32_bf16 v[40:43], v[148:151], v[176:179], v[40:43]
    v_mfma_f32_16x16x32_bf16 v[76:79], v[148:151], v[180:183], v[76:79]
    s_sub_u32 s30, s30, 1
    s_cmp_lg_u32 s30, 0
    s_cbranch_scc1 Lk_42
    s_waitcnt vmcnt(10) lgkmcnt(0)
    s_barrier
    v_mfma_f32_16x16x32_bf16 v[8:11], v[80:83], v[152:155], v[8:11]
    ds_read_b64_tr_b16 v[116:117], v193 offset:9216
    s_add_u32 m0, s28, 0
    v_mfma_f32_16x16x32_bf16 v[44:47], v[80:83], v[156:159], v[44:47]
    buffer_load_dwordx4 v188, s[12:15], s26 offen lds
    ds_read_b64_tr_b16 v[118:119], v193 offset:11520
    v_mfma_f32_16x16x32_bf16 v[12:15], v[84:87], v[152:155], v[12:15]
    ds_read_b64_tr_b16 v[120:121], v193 offset:9248
    ds_read_b64_tr_b16 v[122:123], v193 offset:11552
    v_mfma_f32_16x16x32_bf16 v[48:51], v[84:87], v[156:159], v[48:51]
    buffer_load_dwordx4 v189, s[12:15], s26 offen offset:1024 lds
    ds_read_b64_tr_b16 v[124:125], v193 offset:9280
    v_mfma_f32_16x16x32_bf16 v[16:19], v[88:91], v[152:155], v[16:19]
    ds_read_b64_tr_b16 v[126:127], v193 offset:11584
    ds_read_b64_tr_b16 v[128:129], v193 offset:9312
    v_mfma_f32_16x16x32_bf16 v[52:55], v[88:91], v[156:159], v[52:55]
    buffer_load_dword v190, s[12:15], s26 offen offset:2048 lds
    s_add_u32 s26, s26, 110592
    v_mfma_f32_16x16x32_bf16 v[20:23], v[92:95], v[152:155], v[20:23]
    ds_read_b64_tr_b16 v[130:131], v193 offset:11616
    ds_read_b64_tr_b16 v[132:133], v193 offset:9344
    v_mfma_f32_16x16x32_bf16 v[56:59], v[92:95], v[156:159], v[56:59]
    ds_read_b64_tr_b16 v[134:135], v193 offset:11648
    s_add_u32 m0, s27, 0
    v_mfma_f32_16x16x32_bf16 v[24:27], v[96:99], v[152:155], v[24:27]
    buffer_load_dwordx4 v184, s[8:11], s25 offen lds
    ds_read_b64_tr_b16 v[136:137], v193 offset:9376
    v_mfma_f32_16x16x32_bf16 v[60:63], v[96:99], v[156:159], v[60:63]
    ds_read_b64_tr_b16 v[138:139], v193 offset:11680
    ds_read_b64_tr_b16 v[140:141], v193 offset:9408
    v_mfma_f32_16x16x32_bf16 v[28:31], v[100:103], v[152:155], v[28:31]
    buffer_load_dwordx4 v185, s[8:11], s25 offen offset:1024 lds
    ds_read_b64_tr_b16 v[142:143], v193 offset:11712
    v_mfma_f32_16x16x32_bf16 v[64:67], v[100:103], v[156:159], v[64:67]
    ds_read_b64_tr_b16 v[144:145], v193 offset:9440
    ds_read_b64_tr_b16 v[146:147], v193 offset:11744
    v_mfma_f32_16x16x32_bf16 v[32:35], v[104:107], v[152:155], v[32:35]
    ds_read_b64_tr_b16 v[148:149], v193 offset:9472
    ds_read_b64_tr_b16 v[150:151], v193 offset:11776
    v_mfma_f32_16x16x32_bf16 v[68:71], v[104:107], v[156:159], v[68:71]
    buffer_load_dwordx4 v186, s[8:11], s25 offen offset:2048 lds
    v_mfma_f32_16x16x32_bf16 v[36:39], v[108:111], v[152:155], v[36:39]
    v_mfma_f32_16x16x32_bf16 v[72:75], v[108:111], v[156:159], v[72:75]
    buffer_load_dwordx4 v187, s[8:11], s25 offen offset:3072 lds
    s_add_u32 s25, s25, 128
    v_mfma_f32_16x16x32_bf16 v[40:43], v[112:115], v[152:155], v[40:43]
    v_mfma_f32_16x16x32_bf16 v[76:79], v[112:115], v[156:159], v[76:79]
    s_waitcnt vmcnt(10) lgkmcnt(0)
    s_barrier
    v_mfma_f32_16x16x32_bf16 v[8:11], v[116:119], v[160:163], v[8:11]
    ds_read_b128 v[168:171], v191 offset:4096
    s_add_u32 m0, s28, 9216
    v_mfma_f32_16x16x32_bf16 v[44:47], v[116:119], v[164:167], v[44:47]
    buffer_load_dwordx4 v188, s[12:15], s26 offen lds
    ds_read_b128 v[172:175], v191 offset:6144
    v_mfma_f32_16x16x32_bf16 v[12:15], v[120:123], v[160:163], v[12:15]
    ds_read_b128 v[176:179], v192 offset:4096
    ds_read_b128 v[180:183], v192 offset:6144
    v_mfma_f32_16x16x32_bf16 v[48:51], v[120:123], v[164:167], v[48:51]
    ds_read_b64_tr_b16 v[80:81], v193 offset:18432
    ds_read_b64_tr_b16 v[82:83], v193 offset:20736
    v_mfma_f32_16x16x32_bf16 v[16:19], v[124:127], v[160:163], v[16:19]
    ds_read_b64_tr_b16 v[84:85], v193 offset:18464
    ds_read_b64_tr_b16 v[86:87], v193 offset:20768
    v_mfma_f32_16x16x32_bf16 v[52:55], v[124:127], v[164:167], v[52:55]
    ds_read_b64_tr_b16 v[88:89], v193 offset:18496
    ds_read_b64_tr_b16 v[90:91], v193 offset:20800
    v_mfma_f32_16x16x32_bf16 v[20:23], v[128:131], v[160:163], v[20:23]
    buffer_load_dwordx4 v189, s[12:15], s26 offen offset:1024 lds
    ds_read_b64_tr_b16 v[92:93], v193 offset:18528
    v_mfma_f32_16x16x32_bf16 v[56:59], v[128:131], v[164:167], v[56:59]
    ds_read_b64_tr_b16 v[94:95], v193 offset:20832
    ds_read_b64_tr_b16 v[96:97], v193 offset:18560
    v_mfma_f32_16x16x32_bf16 v[24:27], v[132:135], v[160:163], v[24:27]
    ds_read_b64_tr_b16 v[98:99], v193 offset:20864
    ds_read_b64_tr_b16 v[100:101], v193 offset:18592
    v_mfma_f32_16x16x32_bf16 v[60:63], v[132:135], v[164:167], v[60:63]
    ds_read_b64_tr_b16 v[102:103], v193 offset:20896
    ds_read_b64_tr_b16 v[104:105], v193 offset:18624
    v_mfma_f32_16x16x32_bf16 v[28:31], v[136:139], v[160:163], v[28:31]
    ds_read_b64_tr_b16 v[106:107], v193 offset:20928
    ds_read_b64_tr_b16 v[108:109], v193 offset:18656
    v_mfma_f32_16x16x32_bf16 v[64:67], v[136:139], v[164:167], v[64:67]
    ds_read_b64_tr_b16 v[110:111], v193 offset:20960
    ds_read_b64_tr_b16 v[112:113], v193 offset:18688
    v_mfma_f32_16x16x32_bf16 v[32:35], v[140:143], v[160:163], v[32:35]
    buffer_load_dword v190, s[12:15], s26 offen offset:2048 lds
    s_add_u32 s26, s26, 110592
    v_mfma_f32_16x16x32_bf16 v[68:71], v[140:143], v[164:167], v[68:71]
    ds_read_b64_tr_b16 v[114:115], v193 offset:20992
    v_mfma_f32_16x16x32_bf16 v[36:39], v[144:147], v[160:163], v[36:39]
    v_mfma_f32_16x16x32_bf16 v[72:75], v[144:147], v[164:167], v[72:75]
    v_mfma_f32_16x16x32_bf16 v[40:43], v[148:151], v[160:163], v[40:43]
    v_mfma_f32_16x16x32_bf16 v[76:79], v[148:151], v[164:167], v[76:79]
    s_waitcnt vmcnt(10) lgkmcnt(0)
    s_barrier
    v_mfma_f32_16x16x32_bf16 v[8:11], v[80:83], v[168:171], v[8:11]
    ds_read_b64_tr_b16 v[116:117], v193 offset:27648
    ds_read_b64_tr_b16 v[118:119], v193 offset:29952
    v_mfma_f32_16x16x32_bf16 v[44:47], v[80:83], v[172:175], v[44:47]
    ds_read_b64_tr_b16 v[120:121], v193 offset:27680
    ds_read_b64_tr_b16 v[122:123], v193 offset:29984
    v_mfma_f32_16x16x32_bf16 v[12:15], v[84:87], v[168:171], v[12:15]
    ds_read_b64_tr_b16 v[124:125], v193 offset:27712
    ds_read_b64_tr_b16 v[126:127], v193 offset:30016
    v_mfma_f32_16x16x32_bf16 v[48:51], v[84:87], v[172:175], v[48:51]
    ds_read_b64_tr_b16 v[128:129], v193 offset:27744
    ds_read_b64_tr_b16 v[130:131], v193 offset:30048
    v_mfma_f32_16x16x32_bf16 v[16:19], v[88:91], v[168:171], v[16:19]
    ds_read_b64_tr_b16 v[132:133], v193 offset:27776
    ds_read_b64_tr_b16 v[134:135], v193 offset:30080
    v_mfma_f32_16x16x32_bf16 v[52:55], v[88:91], v[172:175], v[52:55]
    ds_read_b64_tr_b16 v[136:137], v193 offset:27808
    ds_read_b64_tr_b16 v[138:139], v193 offset:30112
    v_mfma_f32_16x16x32_bf16 v[20:23], v[92:95], v[168:171], v[20:23]
    ds_read_b64_tr_b16 v[140:141], v193 offset:27840
    ds_read_b64_tr_b16 v[142:143], v193 offset:30144
    v_mfma_f32_16x16x32_bf16 v[56:59], v[92:95], v[172:175], v[56:59]
    ds_read_b64_tr_b16 v[144:145], v193 offset:27872
    ds_read_b64_tr_b16 v[146:147], v193 offset:30176
    v_mfma_f32_16x16x32_bf16 v[24:27], v[96:99], v[168:171], v[24:27]
    ds_read_b64_tr_b16 v[148:149], v193 offset:27904
    ds_read_b64_tr_b16 v[150:151], v193 offset:30208
    v_mfma_f32_16x16x32_bf16 v[60:63], v[96:99], v[172:175], v[60:63]
    v_mfma_f32_16x16x32_bf16 v[28:31], v[100:103], v[168:171], v[28:31]
    v_mfma_f32_16x16x32_bf16 v[64:67], v[100:103], v[172:175], v[64:67]
    v_mfma_f32_16x16x32_bf16 v[32:35], v[104:107], v[168:171], v[32:35]
    v_mfma_f32_16x16x32_bf16 v[68:71], v[104:107], v[172:175], v[68:71]
    v_mfma_f32_16x16x32_bf16 v[36:39], v[108:111], v[168:171], v[36:39]
    v_mfma_f32_16x16x32_bf16 v[72:75], v[108:111], v[172:175], v[72:75]
    v_mfma_f32_16x16x32_bf16 v[40:43], v[112:115], v[168:171], v[40:43]
    v_mfma_f32_16x16x32_bf16 v[76:79], v[112:115], v[172:175], v[76:79]
    s_waitcnt vmcnt(3) lgkmcnt(0)
    s_barrier
    v_mfma_f32_16x16x32_bf16 v[8:11], v[116:119], v[176:179], v[8:11]
    ds_read_b128 v[152:155], v191 offset:0
    ds_read_b128 v[156:159], v191 offset:2048
    v_mfma_f32_16x16x32_bf16 v[44:47], v[116:119], v[180:183], v[44:47]
    ds_read_b128 v[160:163], v192 offset:0
    ds_read_b128 v[164:167], v192 offset:2048
    v_mfma_f32_16x16x32_bf16 v[12:15], v[120:123], v[176:179], v[12:15]
    ds_read_b64_tr_b16 v[80:81], v193 offset:0
    ds_read_b64_tr_b16 v[82:83], v193 offset:2304
    v_mfma_f32_16x16x32_bf16 v[48:51], v[120:123], v[180:183], v[48:51]
    ds_read_b64_tr_b16 v[84:85], v193 offset:32
    ds_read_b64_tr_b16 v[86:87], v193 offset:2336
    v_mfma_f32_16x16x32_bf16 v[16:19], v[124:127], v[176:179], v[16:19]
    ds_read_b64_tr_b16 v[88:89], v193 offset:64
    ds_read_b64_tr_b16 v[90:91], v193 offset:2368
    v_mfma_f32_16x16x32_bf16 v[52:55], v[124:127], v[180:183], v[52:55]
    ds_read_b64_tr_b16 v[92:93], v193 offset:96
    ds_read_b64_tr_b16 v[94:95], v193 offset:2400
    v_mfma_f32_16x16x32_bf16 v[20:23], v[128:131], v[176:179], v[20:23]
    ds_read_b64_tr_b16 v[96:97], v193 offset:128
    ds_read_b64_tr_b16 v[98:99], v193 offset:2432
    v_mfma_f32_16x16x32_bf16 v[56:59], v[128:131], v[180:183], v[56:59]
    ds_read_b64_tr_b16 v[100:101], v193 offset:160
    ds_read_b64_tr_b16 v[102:103], v193 offset:2464
    v_mfma_f32_16x16x32_bf16 v[24:27], v[132:135], v[176:179], v[24:27]
    ds_read_b64_tr_b16 v[104:105], v193 offset:192
    ds_read_b64_tr_b16 v[106:107], v193 offset:2496
    v_mfma_f32_16x16x32_bf16 v[60:63], v[132:135], v[180:183], v[60:63]
    ds_read_b64_tr_b16 v[108:109], v193 offset:224
    ds_read_b64_tr_b16 v[110:111], v193 offset:2528
    v_mfma_f32_16x16x32_bf16 v[28:31], v[136:139], v[176:179], v[28:31]
    ds_read_b64_tr_b16 v[112:113], v193 offset:256
    ds_read_b64_tr_b16 v[114:115], v193 offset:2560
    v_mfma_f32_16x16x32_bf16 v[64:67], v[136:139], v[180:183], v[64:67]
    v_mfma_f32_16x16x32_bf16 v[32:35], v[140:143], v[176:179], v[32:35]
    v_mfma_f32_16x16x32_bf16 v[68:71], v[140:143], v[180:183], v[68:71]
    v_mfma_f32_16x16x32_bf16 v[36:39], v[144:147], v[176:179], v[36:39]
    v_mfma_f32_16x16x32_bf16 v[72:75], v[144:147], v[180:183], v[72:75]
    v_mfma_f32_16x16x32_bf16 v[40:43], v[148:151], v[176:179], v[40:43]
    v_mfma_f32_16x16x32_bf16 v[76:79], v[148:151], v[180:183], v[76:79]
    s_waitcnt vmcnt(0) lgkmcnt(0)
    s_barrier
    v_mfma_f32_16x16x32_bf16 v[8:11], v[80:83], v[152:155], v[8:11]
    ds_read_b64_tr_b16 v[116:117], v193 offset:9216
    ds_read_b64_tr_b16 v[118:119], v193 offset:11520
    v_mfma_f32_16x16x32_bf16 v[44:47], v[80:83], v[156:159], v[44:47]
    ds_read_b64_tr_b16 v[120:121], v193 offset:9248
    ds_read_b64_tr_b16 v[122:123], v193 offset:11552
    v_mfma_f32_16x16x32_bf16 v[12:15], v[84:87], v[152:155], v[12:15]
    ds_read_b64_tr_b16 v[124:125], v193 offset:9280
    ds_read_b64_tr_b16 v[126:127], v193 offset:11584
    v_mfma_f32_16x16x32_bf16 v[48:51], v[84:87], v[156:159], v[48:51]
    ds_read_b64_tr_b16 v[128:129], v193 offset:9312
    ds_read_b64_tr_b16 v[130:131], v193 offset:11616
    v_mfma_f32_16x16x32_bf16 v[16:19], v[88:91], v[152:155], v[16:19]
    ds_read_b64_tr_b16 v[132:133], v193 offset:9344
    ds_read_b64_tr_b16 v[134:135], v193 offset:11648
    v_mfma_f32_16x16x32_bf16 v[52:55], v[88:91], v[156:159], v[52:55]
    ds_read_b64_tr_b16 v[136:137], v193 offset:9376
    ds_read_b64_tr_b16 v[138:139], v193 offset:11680
    v_mfma_f32_16x16x32_bf16 v[20:23], v[92:95], v[152:155], v[20:23]
    ds_read_b64_tr_b16 v[140:141], v193 offset:9408
    ds_read_b64_tr_b16 v[142:143], v193 offset:11712
    v_mfma_f32_16x16x32_bf16 v[56:59], v[92:95], v[156:159], v[56:59]
    ds_read_b64_tr_b16 v[144:145], v193 offset:9440
    ds_read_b64_tr_b16 v[146:147], v193 offset:11744
    v_mfma_f32_16x16x32_bf16 v[24:27], v[96:99], v[152:155], v[24:27]
    ds_read_b64_tr_b16 v[148:149], v193 offset:9472
    ds_read_b64_tr_b16 v[150:151], v193 offset:11776
    v_mfma_f32_16x16x32_bf16 v[60:63], v[96:99], v[156:159], v[60:63]
    v_mfma_f32_16x16x32_bf16 v[28:31], v[100:103], v[152:155], v[28:31]
    v_mfma_f32_16x16x32_bf16 v[64:67], v[100:103], v[156:159], v[64:67]
    v_mfma_f32_16x16x32_bf16 v[32:35], v[104:107], v[152:155], v[32:35]
    v_mfma_f32_16x16x32_bf16 v[68:71], v[104:107], v[156:159], v[68:71]
    v_mfma_f32_16x16x32_bf16 v[36:39], v[108:111], v[152:155], v[36:39]
    v_mfma_f32_16x16x32_bf16 v[72:75], v[108:111], v[156:159], v[72:75]
    v_mfma_f32_16x16x32_bf16 v[40:43], v[112:115], v[152:155], v[40:43]
    v_mfma_f32_16x16x32_bf16 v[76:79], v[112:115], v[156:159], v[76:79]
    s_waitcnt vmcnt(0) lgkmcnt(0)
    s_barrier
    v_mfma_f32_16x16x32_bf16 v[8:11], v[116:119], v[160:163], v[8:11]
    v_mfma_f32_16x16x32_bf16 v[44:47], v[116:119], v[164:167], v[44:47]
    v_mfma_f32_16x16x32_bf16 v[12:15], v[120:123], v[160:163], v[12:15]
    v_mfma_f32_16x16x32_bf16 v[48:51], v[120:123], v[164:167], v[48:51]
    v_mfma_f32_16x16x32_bf16 v[16:19], v[124:127], v[160:163], v[16:19]
    v_mfma_f32_16x16x32_bf16 v[52:55], v[124:127], v[164:167], v[52:55]
    v_mfma_f32_16x16x32_bf16 v[20:23], v[128:131], v[160:163], v[20:23]
    v_mfma_f32_16x16x32_bf16 v[56:59], v[128:131], v[164:167], v[56:59]
    v_mfma_f32_16x16x32_bf16 v[24:27], v[132:135], v[160:163], v[24:27]
    v_mfma_f32_16x16x32_bf16 v[60:63], v[132:135], v[164:167], v[60:63]
    v_mfma_f32_16x16x32_bf16 v[28:31], v[136:139], v[160:163], v[28:31]
    v_mfma_f32_16x16x32_bf16 v[64:67], v[136:139], v[164:167], v[64:67]
    v_mfma_f32_16x16x32_bf16 v[32:35], v[140:143], v[160:163], v[32:35]
    v_mfma_f32_16x16x32_bf16 v[68:71], v[140:143], v[164:167], v[68:71]
    v_mfma_f32_16x16x32_bf16 v[36:39], v[144:147], v[160:163], v[36:39]
    v_mfma_f32_16x16x32_bf16 v[72:75], v[144:147], v[164:167], v[72:75]
    v_mfma_f32_16x16x32_bf16 v[40:43], v[148:151], v[160:163], v[40:43]
    v_mfma_f32_16x16x32_bf16 v[76:79], v[148:151], v[164:167], v[76:79]
    v_and_b32 v2, 63, v0
    s_mul_i32 s4, s24, 9472
    v_and_b32 v3, 15, v2
    v_mul_u32_u24 v3, 296, v3
    v_lshrrev_b32 v4, 4, v2
    v_lshl_add_u32 v3, v4, 3, v3
    v_add_u32 v80, s4, v3
    v_and_b32 v3, 31, v2
    v_mul_u32_u24 v81, 296, v3
    v_add_u32 v81, s4, v81
    v_lshrrev_b32 v4, 5, v2
    s_lshl_b32 s5, s24, 5
    v_add_u32 v3, s5, v3
    v_lshlrev_b32 v82, 20, v4
    v_lshl_add_u32 v82, v3, 4, v82
    v_lshlrev_b32 v83, 13, v4
    v_lshl_add_u32 v83, v3, 2, v83
    v_mul_u32_u24 v3, 36, v4
    v_add_u32 v85, v81, v3
    v_lshl_add_u32 v81, v4, 4, v81
    s_cmp_lt_u32 s41, 4
    s_cselect_b32 s44, 0x3eae1a93, 1.0
    v_mul_f32 v8, s44, v8
    v_mul_f32 v9, s44, v9
    v_mul_f32 v10, s44, v10
    v_mul_f32 v11, s44, v11
    v_cvt_pk_bf16_f32 v88, v8, v9
    v_cvt_pk_bf16_f32 v89, v10, v11
    ds_write_b64 v80, v[88:89] offset:0
    v_mul_f32 v12, s44, v12
    v_mul_f32 v13, s44, v13
    v_mul_f32 v14, s44, v14
    v_mul_f32 v15, s44, v15
    v_cvt_pk_bf16_f32 v90, v12, v13
    v_cvt_pk_bf16_f32 v91, v14, v15
    ds_write_b64 v80, v[90:91] offset:32
    v_mul_f32 v16, s44, v16
    v_mul_f32 v17, s44, v17
    v_mul_f32 v18, s44, v18
    v_mul_f32 v19, s44, v19
    v_cvt_pk_bf16_f32 v92, v16, v17
    v_cvt_pk_bf16_f32 v93, v18, v19
    ds_write_b64 v80, v[92:93] offset:64
    v_mul_f32 v20, s44, v20
    v_mul_f32 v21, s44, v21
    v_mul_f32 v22, s44, v22
    v_mul_f32 v23, s44, v23
    v_cvt_pk_bf16_f32 v94, v20, v21
    v_cvt_pk_bf16_f32 v95, v22, v23
    ds_write_b64 v80, v[94:95] offset:96
    v_mul_f32 v24, s44, v24
    v_mul_f32 v25, s44, v25
    v_mul_f32 v26, s44, v26
    v_mul_f32 v27, s44, v27
    v_cvt_pk_bf16_f32 v88, v24, v25
    v_cvt_pk_bf16_f32 v89, v26, v27
    ds_write_b64 v80, v[88:89] offset:128
    v_mul_f32 v28, s44, v28
    v_mul_f32 v29, s44, v29
    v_mul_f32 v30, s44, v30
    v_mul_f32 v31, s44, v31
    v_cvt_pk_bf16_f32 v90, v28, v29
    v_cvt_pk_bf16_f32 v91, v30, v31
    ds_write_b64 v80, v[90:91] offset:160
    v_mul_f32 v32, s44, v32
    v_mul_f32 v33, s44, v33
    v_mul_f32 v34, s44, v34
    v_mul_f32 v35, s44, v35
    v_cvt_pk_bf16_f32 v92, v32, v33
    v_cvt_pk_bf16_f32 v93, v34, v35
    ds_write_b64 v80, v[92:93] offset:192
    v_mul_f32 v36, s44, v36
    v_mul_f32 v37, s44, v37
    v_mul_f32 v38, s44, v38
    v_mul_f32 v39, s44, v39
    v_cvt_pk_bf16_f32 v94, v36, v37
    v_cvt_pk_bf16_f32 v95, v38, v39
    ds_write_b64 v80, v[94:95] offset:224
    v_mul_f32 v40, s44, v40
    v_mul_f32 v41, s44, v41
    v_mul_f32 v42, s44, v42
    v_mul_f32 v43, s44, v43
    v_cvt_pk_bf16_f32 v88, v40, v41
    v_cvt_pk_bf16_f32 v89, v42, v43
    ds_write_b64 v80, v[88:89] offset:256
    v_mul_f32 v44, s44, v44
    v_mul_f32 v45, s44, v45
    v_mul_f32 v46, s44, v46
    v_mul_f32 v47, s44, v47
    v_cvt_pk_bf16_f32 v90, v44, v45
    v_cvt_pk_bf16_f32 v91, v46, v47
    ds_write_b64 v80, v[90:91] offset:4736
    v_mul_f32 v48, s44, v48
    v_mul_f32 v49, s44, v49
    v_mul_f32 v50, s44, v50
    v_mul_f32 v51, s44, v51
    v_cvt_pk_bf16_f32 v92, v48, v49
    v_cvt_pk_bf16_f32 v93, v50, v51
    ds_write_b64 v80, v[92:93] offset:4768
    v_mul_f32 v52, s44, v52
    v_mul_f32 v53, s44, v53
    v_mul_f32 v54, s44, v54
    v_mul_f32 v55, s44, v55
    v_cvt_pk_bf16_f32 v94, v52, v53
    v_cvt_pk_bf16_f32 v95, v54, v55
    ds_write_b64 v80, v[94:95] offset:4800
    v_mul_f32 v56, s44, v56
    v_mul_f32 v57, s44, v57
    v_mul_f32 v58, s44, v58
    v_mul_f32 v59, s44, v59
    v_cvt_pk_bf16_f32 v88, v56, v57
    v_cvt_pk_bf16_f32 v89, v58, v59
    ds_write_b64 v80, v[88:89] offset:4832
    v_mul_f32 v60, s44, v60
    v_mul_f32 v61, s44, v61
    v_mul_f32 v62, s44, v62
    v_mul_f32 v63, s44, v63
    v_cvt_pk_bf16_f32 v90, v60, v61
    v_cvt_pk_bf16_f32 v91, v62, v63
    ds_write_b64 v80, v[90:91] offset:4864
    v_mul_f32 v64, s44, v64
    v_mul_f32 v65, s44, v65
    v_mul_f32 v66, s44, v66
    v_mul_f32 v67, s44, v67
    v_cvt_pk_bf16_f32 v92, v64, v65
    v_cvt_pk_bf16_f32 v93, v66, v67
    ds_write_b64 v80, v[92:93] offset:4896
    v_mul_f32 v68, s44, v68
    v_mul_f32 v69, s44, v69
    v_mul_f32 v70, s44, v70
    v_mul_f32 v71, s44, v71
    v_cvt_pk_bf16_f32 v94, v68, v69
    v_cvt_pk_bf16_f32 v95, v70, v71
    ds_write_b64 v80, v[94:95] offset:4928
    v_mul_f32 v72, s44, v72
    v_mul_f32 v73, s44, v73
    v_mul_f32 v74, s44, v74
    v_mul_f32 v75, s44, v75
    v_cvt_pk_bf16_f32 v88, v72, v73
    v_cvt_pk_bf16_f32 v89, v74, v75
    ds_write_b64 v80, v[88:89] offset:4960
    v_mul_f32 v76, s44, v76
    v_mul_f32 v77, s44, v77
    v_mul_f32 v78, s44, v78
    v_mul_f32 v79, s44, v79
    v_cvt_pk_bf16_f32 v90, v76, v77
    v_cvt_pk_bf16_f32 v91, v78, v79
    ds_write_b64 v80, v[90:91] offset:4992
    s_lshr_b32 s45, s41, 2
    s_and_b32 s46, s41, 3
    s_lshl_b32 s46, s46, 3
    s_lshl_b32 s42, s45, 21
    s_lshl_b32 s47, s46, 15
    s_add_u32 s42, s42, s47
    s_lshl_b32 s47, s40, 11
    s_add_u32 s42, s42, s47
    s_lshl_b32 s43, s45, 5
    s_add_u32 s43, s43, s46
    s_lshl_b32 s43, s43, 13
    s_lshl_b32 s47, s40, 9
    s_add_u32 s43, s43, s47
    s_waitcnt lgkmcnt(0)
    ds_read2_b32 v[96:97], v81 offset0:0 offset1:1
    ds_read2_b32 v[98:99], v81 offset0:2 offset1:3
    ds_read2_b32 v[100:101], v81 offset0:9 offset1:10
    ds_read2_b32 v[102:103], v81 offset0:11 offset1:12
    ds_read2_b32 v[104:105], v81 offset0:18 offset1:19
    ds_read2_b32 v[106:107], v81 offset0:20 offset1:21
    ds_read2_b32 v[108:109], v81 offset0:27 offset1:28
    ds_read2_b32 v[110:111], v81 offset0:29 offset1:30
    ds_read2_b32 v[112:113], v81 offset0:36 offset1:37
    ds_read2_b32 v[114:115], v81 offset0:38 offset1:39
    ds_read2_b32 v[116:117], v81 offset0:45 offset1:46
    ds_read2_b32 v[118:119], v81 offset0:47 offset1:48
    ds_read2_b32 v[120:121], v81 offset0:54 offset1:55
    ds_read2_b32 v[122:123], v81 offset0:56 offset1:57
    ds_read2_b32 v[124:125], v81 offset0:63 offset1:64
    ds_read2_b32 v[126:127], v81 offset0:65 offset1:66
    ds_read_b32 v128, v85 offset:32
    ds_read_b32 v129, v85 offset:104
    ds_read_b32 v130, v85 offset:176
    ds_read_b32 v131, v85 offset:248
    s_waitcnt lgkmcnt(15)
    buffer_store_dwordx4 v[96:99], v82, s[16:19], s42 offen sc1
    s_add_u32 s42, s42, 32768
    s_waitcnt lgkmcnt(15)
    buffer_store_dwordx4 v[100:103], v82, s[16:19], s42 offen sc1
    s_add_u32 s42, s42, 32768
    s_waitcnt lgkmcnt(14)
    buffer_store_dwordx4 v[104:107], v82, s[16:19], s42 offen sc1
    s_add_u32 s42, s42, 32768
    s_waitcnt lgkmcnt(12)
    buffer_store_dwordx4 v[108:111], v82, s[16:19], s42 offen sc1
    s_add_u32 s42, s42, 32768
    s_waitcnt lgkmcnt(10)
    buffer_store_dwordx4 v[112:115], v82, s[16:19], s42 offen sc1
    s_add_u32 s42, s42, 32768
    s_waitcnt lgkmcnt(8)
    buffer_store_dwordx4 v[116:119], v82, s[16:19], s42 offen sc1
    s_add_u32 s42, s42, 32768
    s_waitcnt lgkmcnt(6)
    buffer_store_dwordx4 v[120:123], v82, s[16:19], s42 offen sc1
    s_add_u32 s42, s42, 32768
    s_waitcnt lgkmcnt(4)
    buffer_store_dwordx4 v[124:127], v82, s[16:19], s42 offen sc1
    s_waitcnt lgkmcnt(0)
    buffer_store_dword v128, v83, s[20:23], s43 offen sc1
    s_add_u32 s43, s43, 16384
    buffer_store_dword v129, v83, s[20:23], s43 offen sc1
    s_add_u32 s43, s43, 16384
    buffer_store_dword v130, v83, s[20:23], s43 offen sc1
    s_add_u32 s43, s43, 16384
    buffer_store_dword v131, v83, s[20:23], s43 offen sc1
    s_lshl_b32 s49, s41, 4
    s_add_u32 s49, s49, s40
    s_add_u32 s56, s84, 39845888
    s_addc_u32 s57, s85, 0
    s_and_b32 s57, s57, 0xffff
    s_mov_b32 s58, 16384
    s_mov_b32 s59, 0x20000
    s_cmp_lg_u32 s24, 0
    s_cbranch_scc1 Lrdyok_44
    s_mov_b32 s20, s32
    s_mov_b32 s21, s33
    s_and_b32 s21, s21, 0xffff
    s_mov_b32 s22, 256
    s_mov_b32 s23, 0x20000
    s_mov_b32 s5, 0
Lrdy_43:
    buffer_load_dword v2, off, s[20:23], 0 sc1
    s_waitcnt vmcnt(0)
    v_readfirstlane_b32 s6, v2
    s_add_u32 s5, s5, 1
    s_nop 2
    s_cmp_lg_u32 s6, 0
    s_cbranch_scc1 Lrdyok_44
    s_sleep 8
    s_cmp_lt_u32 s5, 0x20000
    s_cbranch_scc1 Lrdy_43
Lrdyok_44:
    s_waitcnt vmcnt(0)
    s_barrier
    s_cmp_lg_u32 s24, 0
    s_cbranch_scc1 Lpub_45
    s_lshl_b32 s4, s49, 2
    s_add_u32 s4, s4, 13312
    v_mov_b32 v2, 1
    buffer_store_dword v2, off, s[56:59], s4 sc1
Lpub_45:
Latt_7:
    s_sub_u32 s31, s2, 256
    s_setprio 3
    v_and_b32 v2, 15, v0
    v_min_u32 v2, 11, v2
    v_lshlrev_b32 v2, 2, v2
    s_lshr_b32 s4, s31, 4
    s_lshl_b32 s4, s4, 6
    s_add_u32 s4, s4, 12288
    v_add_u32 v2, s4, v2
    s_add_u32 s12, s84, 60817408
    s_addc_u32 s13, s85, 0
    s_and_b32 s13, s13, 0xffff
    s_mov_b32 s14, 9437184
    s_mov_b32 s15, 0x20000
    s_add_u32 s16, s84, 9437184
    s_addc_u32 s17, s85, 0
    s_and_b32 s17, s17, 0xffff
    s_mov_b32 s18, 9437184
    s_mov_b32 s19, 0x20000
    s_cmp_lg_u32 s24, 0
    s_cbranch_scc1 Lpolled_47
    s_mov_b32 s5, 0
Lpoll_46:
    buffer_load_dword v4, v2, s[56:59], 0 offen sc1
    s_waitcnt vmcnt(0)
    v_cmp_eq_u32 s[6:7], 0, v4
    s_add_u32 s5, s5, 1
    s_nop 1
    s_cmp_eq_u64 s[6:7], 0
    s_cbranch_scc1 Lpolled_47
    s_sleep 16
    s_cmp_lt_u32 s5, 0x100000
    s_cbranch_scc1 Lpoll_46
Lpolled_47:
    s_barrier
    s_add_u32 s20, s84, 71303168
    s_addc_u32 s21, s85, 0
    s_and_b32 s21, s21, 0xffff
    s_mov_b32 s22, 196608
    s_mov_b32 s23, 0x20000
    v_and_b32 v2, 63, v0
    v_lshrrev_b32 v3, 2, v2
    v_mul_u32_u24 v3, 16384, v3
    v_and_b32 v4, 3, v2
    v_lshl_add_u32 v3, v4, 4, v3
    s_lshl_b32 s4, s31, 6
    buffer_load_dwordx4 v[44:47], v3, s[20:23], s4 offen sc1
    v_lshlrev_b32 v5, 4, v2
    s_mul_i32 s53, s31, 36864
    s_mul_i32 s5, s24, 9216
    s_add_u32 s53, s53, s5
    buffer_load_dwordx4 v[8:11], v5, s[12:15], s53 offen sc1
    buffer_load_dwordx4 v[12:15], v5, s[12:15], s53 offen offset:1024 sc1
    buffer_load_dwordx4 v[16:19], v5, s[12:15], s53 offen offset:2048 sc1
    buffer_load_dwordx4 v[20:23], v5, s[12:15], s53 offen offset:3072 sc1
    s_add_u32 s53, s53, 4096
    buffer_load_dwordx4 v[24:27], v5, s[12:15], s53 offen sc1
    buffer_load_dwordx4 v[28:31], v5, s[12:15], s53 offen offset:1024 sc1
    buffer_load_dwordx4 v[32:35], v5, s[12:15], s53 offen offset:2048 sc1
    buffer_load_dwordx4 v[36:39], v5, s[12:15], s53 offen offset:3072 sc1
    s_add_u32 s53, s53, 4096
    buffer_load_dwordx4 v[40:43], v5, s[12:15], s53 offen sc1
    s_waitcnt vmcnt(0)
    s_nop 1
    v_add_f32_dpp v44, v44, v44 row_ror:4 row_mask:0xf bank_mask:0xf
    v_add_f32_dpp v45, v45, v45 row_ror:4 row_mask:0xf bank_mask:0xf
    v_add_f32_dpp v46, v46, v46 row_ror:4 row_mask:0xf bank_mask:0xf
    v_add_f32_dpp v47, v47, v47 row_ror:4 row_mask:0xf bank_mask:0xf
    s_nop 1
    v_add_f32_dpp v44, v44, v44 row_ror:8 row_mask:0xf bank_mask:0xf
    v_add_f32_dpp v45, v45, v45 row_ror:8 row_mask:0xf bank_mask:0xf
    v_add_f32_dpp v46, v46, v46 row_ror:8 row_mask:0xf bank_mask:0xf
    v_add_f32_dpp v47, v47, v47 row_ror:8 row_mask:0xf bank_mask:0xf
    v_mov_b32 v104, v44
    v_mov_b32 v105, v45
    v_mov_b32 v106, v46
    v_mov_b32 v107, v47
    s_nop 1
    v_permlane16_swap_b32 v44, v104
    v_permlane16_swap_b32 v45, v105
    v_permlane16_swap_b32 v46, v106
    v_permlane16_swap_b32 v47, v107
    s_nop 0
    v_add_f32 v44, v44, v104
    v_add_f32 v45, v45, v105
    v_add_f32 v46, v46, v106
    v_add_f32 v47, v47, v107
    v_mov_b32 v104, v44
    v_mov_b32 v105, v45
    v_mov_b32 v106, v46
    v_mov_b32 v107, v47
    s_nop 1
    v_permlane32_swap_b32 v44, v104
    v_permlane32_swap_b32 v45, v105
    v_permlane32_swap_b32 v46, v106
    v_permlane32_swap_b32 v47, v107
    s_nop 0
    v_add_f32 v44, v44, v104
    v_add_f32 v45, v45, v105
    v_add_f32 v46, v46, v106
    v_add_f32 v47, v47, v107
    v_mul_f32 v44, 0x39e38e39, v44
    v_mul_f32 v45, 0x39e38e39, v45
    v_fma_f32 v45, -v44, v44, v45
    v_max_f32 v45, 0, v45
    v_add_f32 v45, 0x3727c5ac, v45
    v_rsq_f32 v45, v45
    s_nop 0
    v_mul_f32 v44, v44, v45
    v_sub_f32 v44, 0, v44
    v_mul_f32 v46, 0x39e38e39, v46
    v_mul_f32 v47, 0x39e38e39, v47
    v_fma_f32 v47, -v46, v46, v47
    v_max_f32 v47, 0, v47
    v_add_f32 v47, 0x3727c5ac, v47
    v_rsq_f32 v47, v47
    s_nop 0
    v_mul_f32 v46, v46, v47
    v_sub_f32 v46, 0, v46
    s_nop 1
    v_mov_b32_dpp v88, v45 quad_perm:[0,0,0,0] row_mask:0xf bank_mask:0xf
    v_mov_b32_dpp v96, v44 quad_perm:[0,0,0,0] row_mask:0xf bank_mask:0xf
    v_mov_b32_dpp v89, v47 quad_perm:[0,0,0,0] row_mask:0xf bank_mask:0xf
    v_mov_b32_dpp v97, v46 quad_perm:[0,0,0,0] row_mask:0xf bank_mask:0xf
    v_mov_b32_dpp v90, v45 quad_perm:[1,1,1,1] row_mask:0xf bank_mask:0xf
    v_mov_b32_dpp v98, v44 quad_perm:[1,1,1,1] row_mask:0xf bank_mask:0xf
    v_mov_b32_dpp v91, v47 quad_perm:[1,1,1,1] row_mask:0xf bank_mask:0xf
    v_mov_b32_dpp v99, v46 quad_perm:[1,1,1,1] row_mask:0xf bank_mask:0xf
    v_mov_b32_dpp v92, v45 quad_perm:[2,2,2,2] row_mask:0xf bank_mask:0xf
    v_mov_b32_dpp v100, v44 quad_perm:[2,2,2,2] row_mask:0xf bank_mask:0xf
    v_mov_b32_dpp v93, v47 quad_perm:[2,2,2,2] row_mask:0xf bank_mask:0xf
    v_mov_b32_dpp v101, v46 quad_perm:[2,2,2,2] row_mask:0xf bank_mask:0xf
    v_mov_b32_dpp v94, v45 quad_perm:[3,3,3,3] row_mask:0xf bank_mask:0xf
    v_mov_b32_dpp v102, v44 quad_perm:[3,3,3,3] row_mask:0xf bank_mask:0xf
    v_mov_b32_dpp v95, v47 quad_perm:[3,3,3,3] row_mask:0xf bank_mask:0xf
    v_mov_b32_dpp v103, v46 quad_perm:[3,3,3,3] row_mask:0xf bank_mask:0xf
    s_mul_i32 s53, s31, 36864
    s_mul_i32 s5, s24, 9216
    s_add_u32 s53, s53, s5
    v_lshlrev_b32 v104, 16, v8
    v_and_b32 v105, 0xffff0000, v8
    v_fma_f32 v104, v104, v88, v96
    v_fma_f32 v105, v105, v89, v97
    v_cvt_pk_bf16_f32 v8, v104, v105
    v_lshlrev_b32 v106, 16, v9
    v_and_b32 v107, 0xffff0000, v9
    v_fma_f32 v106, v106, v90, v98
    v_fma_f32 v107, v107, v91, v99
    v_cvt_pk_bf16_f32 v9, v106, v107
    v_lshlrev_b32 v104, 16, v10
    v_and_b32 v105, 0xffff0000, v10
    v_fma_f32 v104, v104, v92, v100
    v_fma_f32 v105, v105, v93, v101
    v_cvt_pk_bf16_f32 v10, v104, v105
    v_lshlrev_b32 v106, 16, v11
    v_and_b32 v107, 0xffff0000, v11
    v_fma_f32 v106, v106, v94, v102
    v_fma_f32 v107, v107, v95, v103
    v_cvt_pk_bf16_f32 v11, v106, v107
    buffer_store_dwordx4 v[8:11], v5, s[16:19], s53 offen sc1
    v_lshlrev_b32 v104, 16, v12
    v_and_b32 v105, 0xffff0000, v12
    v_fma_f32 v104, v104, v88, v96
    v_fma_f32 v105, v105, v89, v97
    v_cvt_pk_bf16_f32 v12, v104, v105
    v_lshlrev_b32 v106, 16, v13
    v_and_b32 v107, 0xffff0000, v13
    v_fma_f32 v106, v106, v90, v98
    v_fma_f32 v107, v107, v91, v99
    v_cvt_pk_bf16_f32 v13, v106, v107
    v_lshlrev_b32 v104, 16, v14
    v_and_b32 v105, 0xffff0000, v14
    v_fma_f32 v104, v104, v92, v100
    v_fma_f32 v105, v105, v93, v101
    v_cvt_pk_bf16_f32 v14, v104, v105
    v_lshlrev_b32 v106, 16, v15
    v_and_b32 v107, 0xffff0000, v15
    v_fma_f32 v106, v106, v94, v102
    v_fma_f32 v107, v107, v95, v103
    v_cvt_pk_bf16_f32 v15, v106, v107
    buffer_store_dwordx4 v[12:15], v5, s[16:19], s53 offen offset:1024 sc1
    v_lshlrev_b32 v104, 16, v16
    v_and_b32 v105, 0xffff0000, v16
    v_fma_f32 v104, v104, v88, v96
    v_fma_f32 v105, v105, v89, v97
    v_cvt_pk_bf16_f32 v16, v104, v105
    v_lshlrev_b32 v106, 16, v17
    v_and_b32 v107, 0xffff0000, v17
    v_fma_f32 v106, v106, v90, v98
    v_fma_f32 v107, v107, v91, v99
    v_cvt_pk_bf16_f32 v17, v106, v107
    v_lshlrev_b32 v104, 16, v18
    v_and_b32 v105, 0xffff0000, v18
    v_fma_f32 v104, v104, v92, v100
    v_fma_f32 v105, v105, v93, v101
    v_cvt_pk_bf16_f32 v18, v104, v105
    v_lshlrev_b32 v106, 16, v19
    v_and_b32 v107, 0xffff0000, v19
    v_fma_f32 v106, v106, v94, v102
    v_fma_f32 v107, v107, v95, v103
    v_cvt_pk_bf16_f32 v19, v106, v107
    buffer_store_dwordx4 v[16:19], v5, s[16:19], s53 offen offset:2048 sc1
    v_lshlrev_b32 v104, 16, v20
    v_and_b32 v105, 0xffff0000, v20
    v_fma_f32 v104, v104, v88, v96
    v_fma_f32 v105, v105, v89, v97
    v_cvt_pk_bf16_f32 v20, v104, v105
    v_lshlrev_b32 v106, 16, v21
    v_and_b32 v107, 0xffff0000, v21
    v_fma_f32 v106, v106, v90, v98
    v_fma_f32 v107, v107, v91, v99
    v_cvt_pk_bf16_f32 v21, v106, v107
    v_lshlrev_b32 v104, 16, v22
    v_and_b32 v105, 0xffff0000, v22
    v_fma_f32 v104, v104, v92, v100
    v_fma_f32 v105, v105, v93, v101
    v_cvt_pk_bf16_f32 v22, v104, v105
    v_lshlrev_b32 v106, 16, v23
    v_and_b32 v107, 0xffff0000, v23
    v_fma_f32 v106, v106, v94, v102
    v_fma_f32 v107, v107, v95, v103
    v_cvt_pk_bf16_f32 v23, v106, v107
    buffer_store_dwordx4 v[20:23], v5, s[16:19], s53 offen offset:3072 sc1
    s_add_u32 s53, s53, 4096
    v_lshlrev_b32 v104, 16, v24
    v_and_b32 v105, 0xffff0000, v24
    v_fma_f32 v104, v104, v88, v96
    v_fma_f32 v105, v105, v89, v97
    v_cvt_pk_bf16_f32 v24, v104, v105
    v_lshlrev_b32 v106, 16, v25
    v_and_b32 v107, 0xffff0000, v25
    v_fma_f32 v106, v106, v90, v98
    v_fma_f32 v107, v107, v91, v99
    v_cvt_pk_bf16_f32 v25, v106, v107
    v_lshlrev_b32 v104, 16, v26
    v_and_b32 v105, 0xffff0000, v26
    v_fma_f32 v104, v104, v92, v100
    v_fma_f32 v105, v105, v93, v101
    v_cvt_pk_bf16_f32 v26, v104, v105
    v_lshlrev_b32 v106, 16, v27
    v_and_b32 v107, 0xffff0000, v27
    v_fma_f32 v106, v106, v94, v102
    v_fma_f32 v107, v107, v95, v103
    v_cvt_pk_bf16_f32 v27, v106, v107
    buffer_store_dwordx4 v[24:27], v5, s[16:19], s53 offen sc1
    v_lshlrev_b32 v104, 16, v28
    v_and_b32 v105, 0xffff0000, v28
    v_fma_f32 v104, v104, v88, v96
    v_fma_f32 v105, v105, v89, v97
    v_cvt_pk_bf16_f32 v28, v104, v105
    v_lshlrev_b32 v106, 16, v29
    v_and_b32 v107, 0xffff0000, v29
    v_fma_f32 v106, v106, v90, v98
    v_fma_f32 v107, v107, v91, v99
    v_cvt_pk_bf16_f32 v29, v106, v107
    v_lshlrev_b32 v104, 16, v30
    v_and_b32 v105, 0xffff0000, v30
    v_fma_f32 v104, v104, v92, v100
    v_fma_f32 v105, v105, v93, v101
    v_cvt_pk_bf16_f32 v30, v104, v105
    v_lshlrev_b32 v106, 16, v31
    v_and_b32 v107, 0xffff0000, v31
    v_fma_f32 v106, v106, v94, v102
    v_fma_f32 v107, v107, v95, v103
    v_cvt_pk_bf16_f32 v31, v106, v107
    buffer_store_dwordx4 v[28:31], v5, s[16:19], s53 offen offset:1024 sc1
    v_lshlrev_b32 v104, 16, v32
    v_and_b32 v105, 0xffff0000, v32
    v_fma_f32 v104, v104, v88, v96
    v_fma_f32 v105, v105, v89, v97
    v_cvt_pk_bf16_f32 v32, v104, v105
    v_lshlrev_b32 v106, 16, v33
    v_and_b32 v107, 0xffff0000, v33
    v_fma_f32 v106, v106, v90, v98
    v_fma_f32 v107, v107, v91, v99
    v_cvt_pk_bf16_f32 v33, v106, v107
    v_lshlrev_b32 v104, 16, v34
    v_and_b32 v105, 0xffff0000, v34
    v_fma_f32 v104, v104, v92, v100
    v_fma_f32 v105, v105, v93, v101
    v_cvt_pk_bf16_f32 v34, v104, v105
    v_lshlrev_b32 v106, 16, v35
    v_and_b32 v107, 0xffff0000, v35
    v_fma_f32 v106, v106, v94, v102
    v_fma_f32 v107, v107, v95, v103
    v_cvt_pk_bf16_f32 v35, v106, v107
    buffer_store_dwordx4 v[32:35], v5, s[16:19], s53 offen offset:2048 sc1
    v_lshlrev_b32 v104, 16, v36
    v_and_b32 v105, 0xffff0000, v36
    v_fma_f32 v104, v104, v88, v96
    v_fma_f32 v105, v105, v89, v97
    v_cvt_pk_bf16_f32 v36, v104, v105
    v_lshlrev_b32 v106, 16, v37
    v_and_b32 v107, 0xffff0000, v37
    v_fma_f32 v106, v106, v90, v98
    v_fma_f32 v107, v107, v91, v99
    v_cvt_pk_bf16_f32 v37, v106, v107
    v_lshlrev_b32 v104, 16, v38
    v_and_b32 v105, 0xffff0000, v38
    v_fma_f32 v104, v104, v92, v100
    v_fma_f32 v105, v105, v93, v101
    v_cvt_pk_bf16_f32 v38, v104, v105
    v_lshlrev_b32 v106, 16, v39
    v_and_b32 v107, 0xffff0000, v39
    v_fma_f32 v106, v106, v94, v102
    v_fma_f32 v107, v107, v95, v103
    v_cvt_pk_bf16_f32 v39, v106, v107
    buffer_store_dwordx4 v[36:39], v5, s[16:19], s53 offen offset:3072 sc1
    s_add_u32 s53, s53, 4096
    v_lshlrev_b32 v104, 16, v40
    v_and_b32 v105, 0xffff0000, v40
    v_fma_f32 v104, v104, v88, v96
    v_fma_f32 v105, v105, v89, v97
    v_cvt_pk_bf16_f32 v40, v104, v105
    v_lshlrev_b32 v106, 16, v41
    v_and_b32 v107, 0xffff0000, v41
    v_fma_f32 v106, v106, v90, v98
    v_fma_f32 v107, v107, v91, v99
    v_cvt_pk_bf16_f32 v41, v106, v107
    v_lshlrev_b32 v104, 16, v42
    v_and_b32 v105, 0xffff0000, v42
    v_fma_f32 v104, v104, v92, v100
    v_fma_f32 v105, v105, v93, v101
    v_cvt_pk_bf16_f32 v42, v104, v105
    v_lshlrev_b32 v106, 16, v43
    v_and_b32 v107, 0xffff0000, v43
    v_fma_f32 v106, v106, v94, v102
    v_fma_f32 v107, v107, v95, v103
    v_cvt_pk_bf16_f32 v43, v106, v107
    buffer_store_dwordx4 v[40:43], v5, s[16:19], s53 offen sc1
    s_waitcnt vmcnt(0)
    s_barrier
    s_cmp_lg_u32 s24, 0
    s_cbranch_scc1 Lpub_48
    v_and_b32 v2, 7, v0
    v_lshlrev_b32 v2, 10, v2
    s_lshl_b32 s4, s31, 2
    s_add_u32 s4, s4, 4096
    v_mov_b32 v3, 1
    buffer_store_dword v3, v2, s[56:59], s4 offen sc1
Lpub_48:
    s_setprio 3
    s_and_b32 s4, s31, 7
    s_lshl_b32 s4, s4, 2
    s_lshr_b32 s5, s31, 6
    s_add_u32 s4, s4, s5
    s_mul_i32 s6, s4, 18
    s_mul_hi_u32 s7, s6, 22369622
    s_add_u32 s6, s6, 17
    s_mul_hi_u32 s6, s6, 22369622
    s_lshr_b32 s4, s4, 3
    s_bfe_u32 s5, s31, 0x30003
    s_lshl_b32 s5, s5, 1
    v_and_b32 v2, 63, v0
    v_and_b32 v3, 15, v2
    v_lshrrev_b32 v4, 4, v2
    s_lshl_b32 s7, s7, 6
    s_add_u32 s7, s7, 13824
    s_lshl_b32 s6, s6, 6
    s_add_u32 s6, s6, 13824
    v_lshl_add_u32 v5, v3, 2, s7
    v_lshl_add_u32 v6, v3, 2, s6
    v_cmp_eq_u32 vcc, 2, v4
    s_nop 1
    v_cndmask_b32 v5, v5, v6, vcc
    s_add_u32 s6, s4, 4
    s_lshl_b32 s6, s6, 6
    s_add_u32 s6, s6, 13312
    v_lshl_add_u32 v6, v3, 2, s6
    v_cmp_eq_u32 vcc, 0, v4
    s_nop 1
    v_cndmask_b32 v5, v5, v6, vcc
    s_lshl_b32 s6, s4, 6
    s_lshl_b32 s5, s5, 2
    s_add_u32 s6, s6, s5
    s_add_u32 s6, s6, 13312
    v_and_b32 v3, 1, v2
    v_lshl_add_u32 v6, v3, 2, s6
    v_cmp_eq_u32 vcc, 3, v4
    s_nop 1
    v_cndmask_b32 v5, v5, v6, vcc
    s_cmp_lg_u32 s24, 0
    s_cbranch_scc1 Lpolled_50
    s_mov_b32 s5, 0
Lpoll_49:
    buffer_load_dword v96, v5, s[56:59], 0 offen sc1
    s_waitcnt vmcnt(0)
    v_cmp_eq_u32 s[6:7], 0, v96
    s_add_u32 s5, s5, 1
    s_nop 1
    s_cmp_eq_u64 s[6:7], 0
    s_cbranch_scc1 Lpolled_50
    s_sleep 16
    s_cmp_lt_u32 s5, 0x100000
    s_cbranch_scc1 Lpoll_49
Lpolled_50:
    v_and_b32 v5, 15, v0
    v_lshlrev_b32 v5, 2, v5
    v_add_u32 v5, 14336, v5
    s_cmp_lg_u32 s24, 0
    s_cbranch_scc1 Lpolled_52
    s_mov_b32 s5, 0
Lpoll_51:
    buffer_load_dword v96, v5, s[56:59], 0 offen sc1
    s_waitcnt vmcnt(0)
    v_cmp_eq_u32 s[6:7], 0, v96
    s_add_u32 s5, s5, 1
    s_nop 1
    s_cmp_eq_u64 s[6:7], 0
    s_cbranch_scc1 Lpolled_52
    s_sleep 16
    s_cmp_lt_u32 s5, 0x100000
    s_cbranch_scc1 Lpoll_51
Lpolled_52:
    s_barrier
    s_and_b32 s4, s31, 7
    s_lshr_b32 s5, s31, 3
    s_lshr_b32 s6, s5, 3
    s_lshl_b32 s4, s4, 2
    s_add_u32 s40, s4, s6
    s_and_b32 s41, s5, 7
    s_add_u32 s8, s84, 18874368
    s_addc_u32 s9, s85, 0
    s_and_b32 s9, s9, 0xffff
    s_mov_b32 s10, 7274560
    s_mov_b32 s11, 0x20000
    s_add_u32 s20, s84, 38797312
    s_addc_u32 s21, s85, 0
    s_and_b32 s21, s21, 0xffff
    s_mov_b32 s22, 8192
    s_mov_b32 s23, 0x20000
    v_and_b32 v2, 63, v0
    v_lshrrev_b32 v171, 5, v2
    s_lshl_b32 s4, s41, 8
    s_lshl_b32 s5, s24, 6
    s_add_u32 s4, s4, s5
    v_and_b32 v3, 31, v2
    v_add_u32 v170, s4, v3
    v_lshlrev_b32 v4, 20, v171
    v_lshl_add_u32 v4, v170, 4, v4
    s_lshl_b32 s5, s40, 15
    buffer_load_dwordx4 v[104:107], v4, s[8:11], s5 offen sc1
    buffer_load_dwordx4 v[108:111], v4, s[8:11], s5 offen offset:512 sc1
    v_lshlrev_b32 v5, 2, v170
    s_lshl_b32 s6, s40, 13
    s_add_u32 s6, s6, 4194304
    buffer_load_dword v112, v5, s[8:11], s6 offen sc1
    buffer_load_dword v116, v5, s[8:11], s6 offen offset:128 sc1
    buffer_load_dword v168, v5, s[20:23], 0 offen sc1
    buffer_load_dword v169, v5, s[20:23], 0 offen offset:128 sc1
    v_and_b32 v3, 31, v2
    v_and_b32 v4, 4, v3
    v_lshlrev_b32 v4, 1, v4
    v_and_b32 v5, 8, v3
    v_lshrrev_b32 v5, 1, v5
    v_and_b32 v3, 0x33, v3
    v_or3_b32 v3, v3, v4, v5
    v_lshlrev_b32 v4, 12, v171
    v_lshl_add_u32 v160, v3, 4, v4
    v_lshlrev_b32 v3, 2, v3
    v_add_u32 v161, 8192, v3
    v_and_b32 v3, 31, v2
    v_subrev_u32 v4, 16, v3
    v_cmp_lt_u32 vcc, 18, v3
    s_nop 1
    v_cndmask_b32 v3, v3, v4, vcc
    v_mul_u32_u24 v4, 304, v171
    v_lshl_add_u32 v3, v3, 4, v4
    v_add_u32 v162, 9216, v3
    v_mov_b32 v129, 0x3f803f80
    v_mov_b32 v130, 0x00003f80
    v_mov_b32 v131, 0
    v_mov_b32 v133, 0x3f803f80
    v_mov_b32 v134, 0x00003f80
    v_mov_b32 v135, 0
    s_lshl_b32 s32, s24, 10
    s_add_u32 s33, s32, 4096
    s_add_u32 s34, s32, 9216
    s_add_u32 s35, s32, 13312
    s_add_u32 s36, s32, 17408
    s_cmp_ge_u32 s24, 2
    s_cselect_b32 s36, 8192, s36
    s_mov_b32 s52, 0
    v_and_b32 v2, 63, v0
    s_lshl_b32 s4, s40, 15
    s_add_u32 s4, s4, 2097152
    s_lshl_b32 s5, s24, 10
    s_add_u32 s4, s4, s5
    v_lshl_add_u32 v152, v2, 4, s4
    v_add_u32 v153, 1048576, v152
    s_mul_i32 s6, s40, 288
    s_add_u32 s6, s6, 4718592
    s_add_u32 s4, s24, 0
    s_lshl_b32 s4, s4, 6
    v_add_u32 v3, s4, v2
    v_mul_u32_u24 v4, 3450, v3
    v_lshrrev_b32 v4, 16, v4
    v_mul_u32_u24 v5, 19, v4
    v_sub_u32 v5, v3, v5
    v_mul_u32_u24 v4, 9216, v4
    v_lshl_add_u32 v4, v5, 4, v4
    v_add_u32 v4, s6, v4
    v_cmp_gt_u32 vcc, 18, v5
    s_mov_b32 s7, 608
    v_cmp_gt_u32 s[54:55], s7, v3
    s_nop 1
    s_and_b64 vcc, vcc, s[54:55]
    v_mov_b32 v3, 7274496
    v_mov_b32 v5, 294912
    v_cndmask_b32 v154, v3, v4, vcc
    v_cndmask_b32 v157, 0, v5, vcc
    s_add_u32 s4, s24, 4
    s_lshl_b32 s4, s4, 6
    v_add_u32 v3, s4, v2
    v_mul_u32_u24 v4, 3450, v3
    v_lshrrev_b32 v4, 16, v4
    v_mul_u32_u24 v5, 19, v4
    v_sub_u32 v5, v3, v5
    v_mul_u32_u24 v4, 9216, v4
    v_lshl_add_u32 v4, v5, 4, v4
    v_add_u32 v4, s6, v4
    v_cmp_gt_u32 vcc, 18, v5
    s_mov_b32 s7, 608
    v_cmp_gt_u32 s[54:55], s7, v3
    s_nop 1
    s_and_b64 vcc, vcc, s[54:55]
    v_mov_b32 v3, 7274496
    v_mov_b32 v5, 294912
    v_cndmask_b32 v155, v3, v4, vcc
    v_cndmask_b32 v158, 0, v5, vcc
    s_add_u32 s4, s24, 8
    s_lshl_b32 s4, s4, 6
    v_add_u32 v3, s4, v2
    v_mul_u32_u24 v4, 3450, v3
    v_lshrrev_b32 v4, 16, v4
    v_mul_u32_u24 v5, 19, v4
    v_sub_u32 v5, v3, v5
    v_mul_u32_u24 v4, 9216, v4
    v_lshl_add_u32 v4, v5, 4, v4
    v_add_u32 v4, s6, v4
    v_cmp_gt_u32 vcc, 18, v5
    s_mov_b32 s7, 608
    v_cmp_gt_u32 s[54:55], s7, v3
    s_nop 1
    s_and_b64 vcc, vcc, s[54:55]
    v_mov_b32 v3, 7274496
    v_mov_b32 v5, 294912
    v_cndmask_b32 v156, v3, v4, vcc
    v_cndmask_b32 v159, 0, v5, vcc
    s_cmp_lt_u32 s24, 2
    s_cbranch_scc1 Lw01_53
    s_lshl_b32 s4, s40, 13
    s_add_u32 s4, s4, 4456448
    v_lshl_add_u32 v156, v2, 4, s4
    v_mov_b32 v159, 1024
Lw01_53:
    s_mov_b32 s51, 0
    s_add_u32 m0, s51, s32
    s_nop 0
    buffer_load_dwordx4 v152, s[8:11], 0 offen sc1 lds
    v_add_u32 v152, 4096, v152
    s_add_u32 m0, s51, s33
    s_nop 0
    buffer_load_dwordx4 v153, s[8:11], 0 offen sc1 lds
    v_add_u32 v153, 4096, v153
    s_add_u32 m0, s51, s34
    s_nop 0
    buffer_load_dwordx4 v154, s[8:11], 0 offen sc1 lds
    v_add_u32 v154, v157, v154
    s_add_u32 m0, s51, s35
    s_nop 0
    buffer_load_dwordx4 v155, s[8:11], 0 offen sc1 lds
    v_add_u32 v155, v158, v155
    s_add_u32 m0, s51, s36
    s_nop 0
    buffer_load_dwordx4 v156, s[8:11], 0 offen sc1 lds
    v_add_u32 v156, v159, v156
    s_mov_b32 s51, 19456
    s_add_u32 m0, s51, s32
    s_nop 0
    buffer_load_dwordx4 v152, s[8:11], 0 offen sc1 lds
    v_add_u32 v152, 4096, v152
    s_add_u32 m0, s51, s33
    s_nop 0
    buffer_load_dwordx4 v153, s[8:11], 0 offen sc1 lds
    v_add_u32 v153, 4096, v153
    s_add_u32 m0, s51, s34
    s_nop 0
    buffer_load_dwordx4 v154, s[8:11], 0 offen sc1 lds
    v_add_u32 v154, v157, v154
    s_add_u32 m0, s51, s35
    s_nop 0
    buffer_load_dwordx4 v155, s[8:11], 0 offen sc1 lds
    v_add_u32 v155, v158, v155
    s_add_u32 m0, s51, s36
    s_nop 0
    buffer_load_dwordx4 v156, s[8:11], 0 offen sc1 lds
    v_add_u32 v156, v159, v156
    s_mov_b32 s51, 38912
    s_waitcnt vmcnt(0)
    v_cmp_eq_u32 vcc, 0, v171
    s_nop 1
    v_cndmask_b32 v112, 0, v112, vcc
    v_mov_b32 v115, 0
    v_cndmask_b32 v116, 0, v116, vcc
    v_mov_b32 v119, 0
Latt_start_54:
    v_mov_b32 v163, v160
    v_mov_b32 v164, v161
    v_mov_b32 v165, v162
    s_mov_b32 s50, 19456
    v_mov_b32 v56, 0
    v_mov_b32 v57, 0
    v_mov_b32 v58, 0
    v_mov_b32 v59, 0
    v_mov_b32 v60, 0
    v_mov_b32 v61, 0
    v_mov_b32 v62, 0
    v_mov_b32 v63, 0
    v_mov_b32 v64, 0
    v_mov_b32 v65, 0
    v_mov_b32 v66, 0
    v_mov_b32 v67, 0
    v_mov_b32 v68, 0
    v_mov_b32 v69, 0
    v_mov_b32 v70, 0
    v_mov_b32 v71, 0
    v_mov_b32 v72, 0
    v_mov_b32 v73, 0
    v_mov_b32 v74, 0
    v_mov_b32 v75, 0
    v_mov_b32 v76, 0
    v_mov_b32 v77, 0
    v_mov_b32 v78, 0
    v_mov_b32 v79, 0
    v_mov_b32 v80, 0
    v_mov_b32 v81, 0
    v_mov_b32 v82, 0
    v_mov_b32 v83, 0
    v_mov_b32 v84, 0
    v_mov_b32 v85, 0
    v_mov_b32 v86, 0
    v_mov_b32 v87, 0
    v_mov_b32 v48, 0
    v_mov_b32 v49, 0
    v_mov_b32 v50, 0
    v_mov_b32 v51, 0
    v_mov_b32 v52, 0
    v_mov_b32 v53, 0
    v_mov_b32 v54, 0
    v_mov_b32 v55, 0
    v_mov_b32 v144, 0
    v_mov_b32 v145, 0
    v_mov_b32 v146, 0
    v_mov_b32 v147, 0
    v_mov_b32 v148, 0
    v_mov_b32 v149, 0
    v_mov_b32 v150, 0
    v_mov_b32 v151, 0
    s_waitcnt vmcnt(5)
    s_barrier
    ds_read_b128 v[120:123], v163 offset:0
    ds_read_b32 v128, v164 offset:0
    s_cmp_lg_u32 s52, 0
    s_cbranch_scc1 Lhavemax_55
    v_mov_b32 v113, 0
    v_mov_b32 v114, 0
    v_mov_b32 v117, 0
    v_mov_b32 v118, 0
    s_waitcnt lgkmcnt(0)
    v_mfma_f32_32x32x16_bf16 v[8:23], v[120:123], v[104:107], 0
    v_mfma_f32_32x32x16_bf16 v[8:23], v[128:131], v[112:115], v[8:23]
    v_mfma_f32_32x32x16_bf16 v[24:39], v[120:123], v[108:111], 0
    v_mfma_f32_32x32x16_bf16 v[24:39], v[128:131], v[116:119], v[24:39]
    s_nop 15
    v_max3_f32 v166, v8, v9, v9
    v_max3_f32 v166, v10, v11, v166
    v_max3_f32 v166, v12, v13, v166
    v_max3_f32 v166, v14, v15, v166
    v_max3_f32 v166, v16, v17, v166
    v_max3_f32 v166, v18, v19, v166
    v_max3_f32 v166, v20, v21, v166
    v_max3_f32 v166, v22, v23, v166
    v_max3_f32 v167, v24, v25, v25
    v_max3_f32 v167, v26, v27, v167
    v_max3_f32 v167, v28, v29, v167
    v_max3_f32 v167, v30, v31, v167
    v_max3_f32 v167, v32, v33, v167
    v_max3_f32 v167, v34, v35, v167
    v_max3_f32 v167, v36, v37, v167
    v_max3_f32 v167, v38, v39, v167
    v_mov_b32 v88, v166
    s_nop 1
    v_permlane32_swap_b32 v166, v88
    s_nop 0
    v_max_f32 v166, v166, v88
    v_mov_b32 v88, v167
    s_nop 1
    v_permlane32_swap_b32 v167, v88
    s_nop 0
    v_max_f32 v167, v167, v88
Lhavemax_55:
    v_cmp_eq_u32 vcc, 0, v171
    v_sub_f32 v88, 0, v166
    v_and_b32 v89, 0xffff0000, v88
    v_sub_f32 v88, v88, v89
    v_and_b32 v90, 0xffff0000, v88
    v_sub_f32 v88, v88, v90
    v_lshrrev_b32 v89, 16, v89
    v_or_b32 v89, v89, v90
    v_lshrrev_b32 v88, 16, v88
    v_cndmask_b32 v113, 0, v89, vcc
    v_cndmask_b32 v114, 0, v88, vcc
    v_sub_f32 v88, 0, v167
    v_and_b32 v89, 0xffff0000, v88
    v_sub_f32 v88, v88, v89
    v_and_b32 v90, 0xffff0000, v88
    v_sub_f32 v88, v88, v90
    v_lshrrev_b32 v89, 16, v89
    v_or_b32 v89, v89, v90
    v_lshrrev_b32 v88, 16, v88
    v_cndmask_b32 v117, 0, v89, vcc
    v_cndmask_b32 v118, 0, v88, vcc
    s_waitcnt lgkmcnt(0)
    s_nop 1
    v_mfma_f32_32x32x16_bf16 v[8:23], v[120:123], v[104:107], 0
    v_mfma_f32_32x32x16_bf16 v[8:23], v[128:131], v[112:115], v[8:23]
    s_nop 7
    s_nop 7
    s_cmp_lg_u32 s52, 0
    s_cbranch_scc1 Lnopre_56
    s_setprio 0
Lnopre_56:
    s_mov_b32 s53, 0
Latt_loop_57:
    v_mfma_f32_32x32x16_bf16 v[24:39], v[120:123], v[108:111], 0
    v_exp_f32 v8, v8
    ds_read_b128 v[124:127], v163 offset:512
    v_exp_f32 v9, v9
    ds_read_b32 v132, v164 offset:128
    v_exp_f32 v10, v10
    ds_read_b128 v[136:139], v165 offset:0
    v_exp_f32 v11, v11
    ds_read_b128 v[140:143], v165 offset:608
    v_mfma_f32_32x32x16_bf16 v[24:39], v[128:131], v[116:119], v[24:39]
    v_exp_f32 v12, v12
    v_exp_f32 v13, v13
    v_exp_f32 v14, v14
    v_exp_f32 v15, v15
    v_cvt_pk_bf16_f32 v40, v8, v9
    v_cvt_pk_bf16_f32 v41, v10, v11
    v_mfma_f32_32x32x16_bf16 v[72:87], v[144:147], v[48:51], v[72:87]
    v_exp_f32 v16, v16
    v_exp_f32 v17, v17
    v_exp_f32 v18, v18
    v_exp_f32 v19, v19
    v_cvt_pk_bf16_f32 v42, v12, v13
    v_cvt_pk_bf16_f32 v43, v14, v15
    v_mfma_f32_32x32x16_bf16 v[72:87], v[148:151], v[52:55], v[72:87]
    v_exp_f32 v20, v20
    v_exp_f32 v21, v21
    v_exp_f32 v22, v22
    v_exp_f32 v23, v23
    v_cvt_pk_bf16_f32 v44, v16, v17
    v_cvt_pk_bf16_f32 v45, v18, v19
    v_cvt_pk_bf16_f32 v46, v20, v21
    v_cvt_pk_bf16_f32 v47, v22, v23
    s_waitcnt lgkmcnt(0)
    v_mfma_f32_32x32x16_bf16 v[8:23], v[124:127], v[104:107], 0
    v_exp_f32 v24, v24
    v_exp_f32 v25, v25
    v_exp_f32 v26, v26
    v_exp_f32 v27, v27
    v_mfma_f32_32x32x16_bf16 v[8:23], v[132:135], v[112:115], v[8:23]
    v_exp_f32 v28, v28
    v_exp_f32 v29, v29
    v_exp_f32 v30, v30
    v_exp_f32 v31, v31
    v_cvt_pk_bf16_f32 v48, v24, v25
    v_cvt_pk_bf16_f32 v49, v26, v27
    v_mfma_f32_32x32x16_bf16 v[56:71], v[136:139], v[40:43], v[56:71]
    v_exp_f32 v32, v32
    v_exp_f32 v33, v33
    v_exp_f32 v34, v34
    v_exp_f32 v35, v35
    v_cvt_pk_bf16_f32 v50, v28, v29
    v_cvt_pk_bf16_f32 v51, v30, v31
    v_mfma_f32_32x32x16_bf16 v[56:71], v[140:143], v[44:47], v[56:71]
    v_exp_f32 v36, v36
    v_exp_f32 v37, v37
    v_exp_f32 v38, v38
    v_exp_f32 v39, v39
    v_cvt_pk_bf16_f32 v52, v32, v33
    v_cvt_pk_bf16_f32 v53, v34, v35
    v_cvt_pk_bf16_f32 v54, v36, v37
    v_cvt_pk_bf16_f32 v55, v38, v39
    v_mfma_f32_32x32x16_bf16 v[24:39], v[124:127], v[108:111], 0
    v_exp_f32 v8, v8
    ds_read_b128 v[120:123], v163 offset:1024
    v_exp_f32 v9, v9
    ds_read_b32 v128, v164 offset:256
    v_exp_f32 v10, v10
    ds_read_b128 v[144:147], v165 offset:1216
    v_exp_f32 v11, v11
    ds_read_b128 v[148:151], v165 offset:1824
    v_mfma_f32_32x32x16_bf16 v[24:39], v[132:135], v[116:119], v[24:39]
    v_exp_f32 v12, v12
    v_exp_f32 v13, v13
    v_exp_f32 v14, v14
    v_exp_f32 v15, v15
    v_cvt_pk_bf16_f32 v40, v8, v9
    v_cvt_pk_bf16_f32 v41, v10, v11
    v_mfma_f32_32x32x16_bf16 v[72:87], v[136:139], v[48:51], v[72:87]
    v_exp_f32 v16, v16
    v_exp_f32 v17, v17
    v_exp_f32 v18, v18
    v_exp_f32 v19, v19
    v_cvt_pk_bf16_f32 v42, v12, v13
    v_cvt_pk_bf16_f32 v43, v14, v15
    v_mfma_f32_32x32x16_bf16 v[72:87], v[140:143], v[52:55], v[72:87]
    v_exp_f32 v20, v20
    v_exp_f32 v21, v21
    v_exp_f32 v22, v22
    v_exp_f32 v23, v23
    v_cvt_pk_bf16_f32 v44, v16, v17
    v_cvt_pk_bf16_f32 v45, v18, v19
    v_cvt_pk_bf16_f32 v46, v20, v21
    v_cvt_pk_bf16_f32 v47, v22, v23
    s_waitcnt lgkmcnt(0)
    v_mfma_f32_32x32x16_bf16 v[8:23], v[120:123], v[104:107], 0
    v_exp_f32 v24, v24
    v_exp_f32 v25, v25
    v_exp_f32 v26, v26
    v_exp_f32 v27, v27
    v_mfma_f32_32x32x16_bf16 v[8:23], v[128:131], v[112:115], v[8:23]
    v_exp_f32 v28, v28
    v_exp_f32 v29, v29
    v_exp_f32 v30, v30
    v_exp_f32 v31, v31
    v_cvt_pk_bf16_f32 v48, v24, v25
    v_cvt_pk_bf16_f32 v49, v26, v27
    v_mfma_f32_32x32x16_bf16 v[56:71], v[144:147], v[40:43], v[56:71]
    v_exp_f32 v32, v32
    v_exp_f32 v33, v33
    v_exp_f32 v34, v34
    v_exp_f32 v35, v35
    v_cvt_pk_bf16_f32 v50, v28, v29
    v_cvt_pk_bf16_f32 v51, v30, v31
    v_mfma_f32_32x32x16_bf16 v[56:71], v[148:151], v[44:47], v[56:71]
    v_exp_f32 v36, v36
    v_exp_f32 v37, v37
    v_exp_f32 v38, v38
    v_exp_f32 v39, v39
    v_cvt_pk_bf16_f32 v52, v32, v33
    v_cvt_pk_bf16_f32 v53, v34, v35
    v_cvt_pk_bf16_f32 v54, v36, v37
    v_cvt_pk_bf16_f32 v55, v38, v39
    v_mfma_f32_32x32x16_bf16 v[24:39], v[120:123], v[108:111], 0
    v_exp_f32 v8, v8
    ds_read_b128 v[124:127], v163 offset:1536
    v_exp_f32 v9, v9
    ds_read_b32 v132, v164 offset:384
    v_exp_f32 v10, v10
    ds_read_b128 v[136:139], v165 offset:2432
    v_exp_f32 v11, v11
    ds_read_b128 v[140:143], v165 offset:3040
    v_mfma_f32_32x32x16_bf16 v[24:39], v[128:131], v[116:119], v[24:39]
    v_exp_f32 v12, v12
    v_exp_f32 v13, v13
    v_exp_f32 v14, v14
    v_exp_f32 v15, v15
    v_cvt_pk_bf16_f32 v40, v8, v9
    v_cvt_pk_bf16_f32 v41, v10, v11
    v_mfma_f32_32x32x16_bf16 v[72:87], v[144:147], v[48:51], v[72:87]
    v_exp_f32 v16, v16
    v_exp_f32 v17, v17
    v_exp_f32 v18, v18
    v_exp_f32 v19, v19
    v_cvt_pk_bf16_f32 v42, v12, v13
    v_cvt_pk_bf16_f32 v43, v14, v15
    v_mfma_f32_32x32x16_bf16 v[72:87], v[148:151], v[52:55], v[72:87]
    v_exp_f32 v20, v20
    v_exp_f32 v21, v21
    v_exp_f32 v22, v22
    v_exp_f32 v23, v23
    v_cvt_pk_bf16_f32 v44, v16, v17
    v_cvt_pk_bf16_f32 v45, v18, v19
    v_cvt_pk_bf16_f32 v46, v20, v21
    v_cvt_pk_bf16_f32 v47, v22, v23
    s_waitcnt lgkmcnt(0)
    v_mfma_f32_32x32x16_bf16 v[8:23], v[124:127], v[104:107], 0
    v_exp_f32 v24, v24
    v_exp_f32 v25, v25
    v_exp_f32 v26, v26
    v_exp_f32 v27, v27
    v_mfma_f32_32x32x16_bf16 v[8:23], v[132:135], v[112:115], v[8:23]
    v_exp_f32 v28, v28
    v_exp_f32 v29, v29
    v_exp_f32 v30, v30
    v_exp_f32 v31, v31
    v_cvt_pk_bf16_f32 v48, v24, v25
    v_cvt_pk_bf16_f32 v49, v26, v27
    v_mfma_f32_32x32x16_bf16 v[56:71], v[136:139], v[40:43], v[56:71]
    v_exp_f32 v32, v32
    v_exp_f32 v33, v33
    v_exp_f32 v34, v34
    v_exp_f32 v35, v35
    v_cvt_pk_bf16_f32 v50, v28, v29
    v_cvt_pk_bf16_f32 v51, v30, v31
    v_mfma_f32_32x32x16_bf16 v[56:71], v[140:143], v[44:47], v[56:71]
    v_exp_f32 v36, v36
    v_exp_f32 v37, v37
    v_exp_f32 v38, v38
    v_exp_f32 v39, v39
    v_cvt_pk_bf16_f32 v52, v32, v33
    v_cvt_pk_bf16_f32 v53, v34, v35
    v_cvt_pk_bf16_f32 v54, v36, v37
    v_cvt_pk_bf16_f32 v55, v38, v39
    v_mfma_f32_32x32x16_bf16 v[24:39], v[124:127], v[108:111], 0
    v_exp_f32 v8, v8
    ds_read_b128 v[120:123], v163 offset:2048
    v_exp_f32 v9, v9
    ds_read_b32 v128, v164 offset:512
    v_exp_f32 v10, v10
    ds_read_b128 v[144:147], v165 offset:3648
    v_exp_f32 v11, v11
    ds_read_b128 v[148:151], v165 offset:4256
    v_mfma_f32_32x32x16_bf16 v[24:39], v[132:135], v[116:119], v[24:39]
    v_exp_f32 v12, v12
    v_exp_f32 v13, v13
    v_exp_f32 v14, v14
    v_exp_f32 v15, v15
    v_cvt_pk_bf16_f32 v40, v8, v9
    v_cvt_pk_bf16_f32 v41, v10, v11
    v_mfma_f32_32x32x16_bf16 v[72:87], v[136:139], v[48:51], v[72:87]
    v_exp_f32 v16, v16
    v_exp_f32 v17, v17
    v_exp_f32 v18, v18
    v_exp_f32 v19, v19
    v_cvt_pk_bf16_f32 v42, v12, v13
    v_cvt_pk_bf16_f32 v43, v14, v15
    v_mfma_f32_32x32x16_bf16 v[72:87], v[140:143], v[52:55], v[72:87]
    v_exp_f32 v20, v20
    v_exp_f32 v21, v21
    v_exp_f32 v22, v22
    v_exp_f32 v23, v23
    v_cvt_pk_bf16_f32 v44, v16, v17
    v_cvt_pk_bf16_f32 v45, v18, v19
    v_cvt_pk_bf16_f32 v46, v20, v21
    v_cvt_pk_bf16_f32 v47, v22, v23
    s_waitcnt lgkmcnt(0)
    v_mfma_f32_32x32x16_bf16 v[8:23], v[120:123], v[104:107], 0
    v_exp_f32 v24, v24
    v_exp_f32 v25, v25
    v_exp_f32 v26, v26
    v_exp_f32 v27, v27
    v_mfma_f32_32x32x16_bf16 v[8:23], v[128:131], v[112:115], v[8:23]
    v_exp_f32 v28, v28
    v_exp_f32 v29, v29
    v_exp_f32 v30, v30
    v_exp_f32 v31, v31
    v_cvt_pk_bf16_f32 v48, v24, v25
    v_cvt_pk_bf16_f32 v49, v26, v27
    v_mfma_f32_32x32x16_bf16 v[56:71], v[144:147], v[40:43], v[56:71]
    v_exp_f32 v32, v32
    v_exp_f32 v33, v33
    v_exp_f32 v34, v34
    v_exp_f32 v35, v35
    v_cvt_pk_bf16_f32 v50, v28, v29
    v_cvt_pk_bf16_f32 v51, v30, v31
    v_mfma_f32_32x32x16_bf16 v[56:71], v[148:151], v[44:47], v[56:71]
    v_exp_f32 v36, v36
    v_exp_f32 v37, v37
    v_exp_f32 v38, v38
    v_exp_f32 v39, v39
    v_cvt_pk_bf16_f32 v52, v32, v33
    v_cvt_pk_bf16_f32 v53, v34, v35
    v_cvt_pk_bf16_f32 v54, v36, v37
    v_cvt_pk_bf16_f32 v55, v38, v39
    v_mfma_f32_32x32x16_bf16 v[24:39], v[120:123], v[108:111], 0
    v_exp_f32 v8, v8
    ds_read_b128 v[124:127], v163 offset:2560
    v_exp_f32 v9, v9
    ds_read_b32 v132, v164 offset:640
    v_exp_f32 v10, v10
    ds_read_b128 v[136:139], v165 offset:4864
    v_exp_f32 v11, v11
    ds_read_b128 v[140:143], v165 offset:5472
    v_mfma_f32_32x32x16_bf16 v[24:39], v[128:131], v[116:119], v[24:39]
    v_exp_f32 v12, v12
    v_exp_f32 v13, v13
    v_exp_f32 v14, v14
    v_exp_f32 v15, v15
    v_cvt_pk_bf16_f32 v40, v8, v9
    v_cvt_pk_bf16_f32 v41, v10, v11
    v_mfma_f32_32x32x16_bf16 v[72:87], v[144:147], v[48:51], v[72:87]
    v_exp_f32 v16, v16
    v_exp_f32 v17, v17
    v_exp_f32 v18, v18
    v_exp_f32 v19, v19
    v_cvt_pk_bf16_f32 v42, v12, v13
    v_cvt_pk_bf16_f32 v43, v14, v15
    v_mfma_f32_32x32x16_bf16 v[72:87], v[148:151], v[52:55], v[72:87]
    v_exp_f32 v20, v20
    v_exp_f32 v21, v21
    v_exp_f32 v22, v22
    v_exp_f32 v23, v23
    v_cvt_pk_bf16_f32 v44, v16, v17
    v_cvt_pk_bf16_f32 v45, v18, v19
    v_cvt_pk_bf16_f32 v46, v20, v21
    v_cvt_pk_bf16_f32 v47, v22, v23
    s_waitcnt lgkmcnt(0)
    v_mfma_f32_32x32x16_bf16 v[8:23], v[124:127], v[104:107], 0
    v_exp_f32 v24, v24
    v_exp_f32 v25, v25
    v_exp_f32 v26, v26
    v_exp_f32 v27, v27
    v_mfma_f32_32x32x16_bf16 v[8:23], v[132:135], v[112:115], v[8:23]
    v_exp_f32 v28, v28
    v_exp_f32 v29, v29
    v_exp_f32 v30, v30
    v_exp_f32 v31, v31
    v_cvt_pk_bf16_f32 v48, v24, v25
    v_cvt_pk_bf16_f32 v49, v26, v27
    v_mfma_f32_32x32x16_bf16 v[56:71], v[136:139], v[40:43], v[56:71]
    v_exp_f32 v32, v32
    v_exp_f32 v33, v33
    v_exp_f32 v34, v34
    v_exp_f32 v35, v35
    v_cvt_pk_bf16_f32 v50, v28, v29
    v_cvt_pk_bf16_f32 v51, v30, v31
    v_mfma_f32_32x32x16_bf16 v[56:71], v[140:143], v[44:47], v[56:71]
    v_exp_f32 v36, v36
    v_exp_f32 v37, v37
    v_exp_f32 v38, v38
    v_exp_f32 v39, v39
    v_cvt_pk_bf16_f32 v52, v32, v33
    v_cvt_pk_bf16_f32 v53, v34, v35
    v_cvt_pk_bf16_f32 v54, v36, v37
    v_cvt_pk_bf16_f32 v55, v38, v39
    v_mfma_f32_32x32x16_bf16 v[24:39], v[124:127], v[108:111], 0
    v_exp_f32 v8, v8
    ds_read_b128 v[120:123], v163 offset:3072
    v_exp_f32 v9, v9
    ds_read_b32 v128, v164 offset:768
    v_exp_f32 v10, v10
    ds_read_b128 v[144:147], v165 offset:6080
    v_exp_f32 v11, v11
    ds_read_b128 v[148:151], v165 offset:6688
    v_mfma_f32_32x32x16_bf16 v[24:39], v[132:135], v[116:119], v[24:39]
    v_exp_f32 v12, v12
    v_exp_f32 v13, v13
    v_exp_f32 v14, v14
    v_exp_f32 v15, v15
    v_cvt_pk_bf16_f32 v40, v8, v9
    v_cvt_pk_bf16_f32 v41, v10, v11
    v_mfma_f32_32x32x16_bf16 v[72:87], v[136:139], v[48:51], v[72:87]
    v_exp_f32 v16, v16
    v_exp_f32 v17, v17
    v_exp_f32 v18, v18
    v_exp_f32 v19, v19
    v_cvt_pk_bf16_f32 v42, v12, v13
    v_cvt_pk_bf16_f32 v43, v14, v15
    v_mfma_f32_32x32x16_bf16 v[72:87], v[140:143], v[52:55], v[72:87]
    v_exp_f32 v20, v20
    v_exp_f32 v21, v21
    v_exp_f32 v22, v22
    v_exp_f32 v23, v23
    v_cvt_pk_bf16_f32 v44, v16, v17
    v_cvt_pk_bf16_f32 v45, v18, v19
    v_cvt_pk_bf16_f32 v46, v20, v21
    v_cvt_pk_bf16_f32 v47, v22, v23
    s_waitcnt lgkmcnt(0)
    v_mfma_f32_32x32x16_bf16 v[8:23], v[120:123], v[104:107], 0
    v_exp_f32 v24, v24
    v_exp_f32 v25, v25
    v_exp_f32 v26, v26
    v_exp_f32 v27, v27
    v_mfma_f32_32x32x16_bf16 v[8:23], v[128:131], v[112:115], v[8:23]
    v_exp_f32 v28, v28
    v_exp_f32 v29, v29
    v_exp_f32 v30, v30
    v_exp_f32 v31, v31
    v_cvt_pk_bf16_f32 v48, v24, v25
    v_cvt_pk_bf16_f32 v49, v26, v27
    v_mfma_f32_32x32x16_bf16 v[56:71], v[144:147], v[40:43], v[56:71]
    v_exp_f32 v32, v32
    v_exp_f32 v33, v33
    v_exp_f32 v34, v34
    v_exp_f32 v35, v35
    v_cvt_pk_bf16_f32 v50, v28, v29
    v_cvt_pk_bf16_f32 v51, v30, v31
    v_mfma_f32_32x32x16_bf16 v[56:71], v[148:151], v[44:47], v[56:71]
    v_exp_f32 v36, v36
    v_exp_f32 v37, v37
    v_exp_f32 v38, v38
    v_exp_f32 v39, v39
    v_cvt_pk_bf16_f32 v52, v32, v33
    v_cvt_pk_bf16_f32 v53, v34, v35
    v_cvt_pk_bf16_f32 v54, v36, v37
    v_cvt_pk_bf16_f32 v55, v38, v39
    v_mfma_f32_32x32x16_bf16 v[24:39], v[120:123], v[108:111], 0
    v_exp_f32 v8, v8
    ds_read_b128 v[124:127], v163 offset:3584
    v_exp_f32 v9, v9
    ds_read_b32 v132, v164 offset:896
    v_exp_f32 v10, v10
    ds_read_b128 v[136:139], v165 offset:7296
    v_exp_f32 v11, v11
    ds_read_b128 v[140:143], v165 offset:7904
    v_mfma_f32_32x32x16_bf16 v[24:39], v[128:131], v[116:119], v[24:39]
    v_exp_f32 v12, v12
    v_exp_f32 v13, v13
    v_exp_f32 v14, v14
    v_exp_f32 v15, v15
    v_cvt_pk_bf16_f32 v40, v8, v9
    v_cvt_pk_bf16_f32 v41, v10, v11
    v_mfma_f32_32x32x16_bf16 v[72:87], v[144:147], v[48:51], v[72:87]
    v_exp_f32 v16, v16
    v_exp_f32 v17, v17
    v_exp_f32 v18, v18
    v_exp_f32 v19, v19
    v_cvt_pk_bf16_f32 v42, v12, v13
    v_cvt_pk_bf16_f32 v43, v14, v15
    v_mfma_f32_32x32x16_bf16 v[72:87], v[148:151], v[52:55], v[72:87]
    v_exp_f32 v20, v20
    v_exp_f32 v21, v21
    v_exp_f32 v22, v22
    v_exp_f32 v23, v23
    v_cvt_pk_bf16_f32 v44, v16, v17
    v_cvt_pk_bf16_f32 v45, v18, v19
    v_cvt_pk_bf16_f32 v46, v20, v21
    v_cvt_pk_bf16_f32 v47, v22, v23
    s_waitcnt lgkmcnt(0)
    v_mfma_f32_32x32x16_bf16 v[8:23], v[124:127], v[104:107], 0
    v_exp_f32 v24, v24
    v_exp_f32 v25, v25
    v_exp_f32 v26, v26
    v_exp_f32 v27, v27
    v_mfma_f32_32x32x16_bf16 v[8:23], v[132:135], v[112:115], v[8:23]
    v_exp_f32 v28, v28
    v_exp_f32 v29, v29
    v_exp_f32 v30, v30
    v_exp_f32 v31, v31
    v_cvt_pk_bf16_f32 v48, v24, v25
    v_cvt_pk_bf16_f32 v49, v26, v27
    v_mfma_f32_32x32x16_bf16 v[56:71], v[136:139], v[40:43], v[56:71]
    v_exp_f32 v32, v32
    v_exp_f32 v33, v33
    v_exp_f32 v34, v34
    v_exp_f32 v35, v35
    v_cvt_pk_bf16_f32 v50, v28, v29
    v_cvt_pk_bf16_f32 v51, v30, v31
    v_mfma_f32_32x32x16_bf16 v[56:71], v[140:143], v[44:47], v[56:71]
    v_exp_f32 v36, v36
    v_exp_f32 v37, v37
    v_exp_f32 v38, v38
    v_exp_f32 v39, v39
    v_cvt_pk_bf16_f32 v52, v32, v33
    v_cvt_pk_bf16_f32 v53, v34, v35
    v_cvt_pk_bf16_f32 v54, v36, v37
    v_cvt_pk_bf16_f32 v55, v38, v39
    s_waitcnt vmcnt(0)
    s_barrier
    v_add_u32 v163, s50, v160
    v_add_u32 v164, s50, v161
    v_mfma_f32_32x32x16_bf16 v[24:39], v[124:127], v[108:111], 0
    v_exp_f32 v8, v8
    ds_read_b128 v[120:123], v163 offset:0
    v_exp_f32 v9, v9
    ds_read_b32 v128, v164 offset:0
    v_exp_f32 v10, v10
    ds_read_b128 v[144:147], v165 offset:8512
    v_exp_f32 v11, v11
    ds_read_b128 v[148:151], v165 offset:9120
    v_mfma_f32_32x32x16_bf16 v[24:39], v[132:135], v[116:119], v[24:39]
    v_exp_f32 v12, v12
    v_add_u32 v165, s50, v162
    v_exp_f32 v13, v13
    v_exp_f32 v14, v14
    v_exp_f32 v15, v15
    v_cvt_pk_bf16_f32 v40, v8, v9
    v_cvt_pk_bf16_f32 v41, v10, v11
    v_mfma_f32_32x32x16_bf16 v[72:87], v[136:139], v[48:51], v[72:87]
    v_exp_f32 v16, v16
    v_exp_f32 v17, v17
    v_exp_f32 v18, v18
    v_exp_f32 v19, v19
    v_cvt_pk_bf16_f32 v42, v12, v13
    v_cvt_pk_bf16_f32 v43, v14, v15
    v_mfma_f32_32x32x16_bf16 v[72:87], v[140:143], v[52:55], v[72:87]
    v_exp_f32 v20, v20
    v_exp_f32 v21, v21
    v_exp_f32 v22, v22
    v_exp_f32 v23, v23
    v_cvt_pk_bf16_f32 v44, v16, v17
    v_cvt_pk_bf16_f32 v45, v18, v19
    v_cvt_pk_bf16_f32 v46, v20, v21
    v_cvt_pk_bf16_f32 v47, v22, v23
    s_cmp_ge_u32 s53, 6
    s_cbranch_scc1 Lnodma_58
    s_add_u32 m0, s51, s32
    s_nop 0
    buffer_load_dwordx4 v152, s[8:11], 0 offen sc1 lds
    v_add_u32 v152, 4096, v152
    s_add_u32 m0, s51, s33
    s_nop 0
    buffer_load_dwordx4 v153, s[8:11], 0 offen sc1 lds
    v_add_u32 v153, 4096, v153
    s_add_u32 m0, s51, s34
    s_nop 0
    buffer_load_dwordx4 v154, s[8:11], 0 offen sc1 lds
    v_add_u32 v154, v157, v154
    s_add_u32 m0, s51, s35
    s_nop 0
    buffer_load_dwordx4 v155, s[8:11], 0 offen sc1 lds
    v_add_u32 v155, v158, v155
    s_add_u32 m0, s51, s36
    s_nop 0
    buffer_load_dwordx4 v156, s[8:11], 0 offen sc1 lds
    v_add_u32 v156, v159, v156
Lnodma_58:
    s_cmp_lg_u32 s53, 4
    s_cbranch_scc1 Lnotouch_59
    s_load_dwordx2 s[90:91], s[0:1], 56
    s_load_dwordx2 s[92:93], s[0:1], 16
    s_lshl_b32 s4, s31, 2
    s_add_u32 s4, s4, s24
    s_lshl_b32 s4, s4, 5
    v_and_b32 v2, 31, v0
    v_add_u32 v3, s4, v2
    v_lshlrev_b32 v3, 7, v3
    s_waitcnt lgkmcnt(0)
    s_mov_b32 s12, s90
    s_mov_b32 s13, s91
    s_and_b32 s13, s13, 0xffff
    s_mov_b32 s14, 2654208
    s_mov_b32 s15, 0x20000
    s_mov_b32 s20, s92
    s_mov_b32 s21, s93
    s_and_b32 s21, s21, 0xffff
    s_mov_b32 s22, 663552
    s_mov_b32 s23, 0x20000
    buffer_load_dword v246, v3, s[12:15], 0 offen
    v_subrev_u32 v3, 2654208, v3
    buffer_load_dword v246, v3, s[20:23], 0 offen
Lnotouch_59:
    s_add_u32 s51, s51, 19456
    s_cmp_eq_u32 s51, 58368
    s_cselect_b32 s51, 0, s51
    s_add_u32 s50, s50, 19456
    s_cmp_eq_u32 s50, 58368
    s_cselect_b32 s50, 0, s50
    s_waitcnt lgkmcnt(0)
    v_mfma_f32_32x32x16_bf16 v[8:23], v[120:123], v[104:107], 0
    v_exp_f32 v24, v24
    v_exp_f32 v25, v25
    v_exp_f32 v26, v26
    v_exp_f32 v27, v27
    v_mfma_f32_32x32x16_bf16 v[8:23], v[128:131], v[112:115], v[8:23]
    v_exp_f32 v28, v28
    v_exp_f32 v29, v29
    v_exp_f32 v30, v30
    v_exp_f32 v31, v31
    v_cvt_pk_bf16_f32 v48, v24, v25
    v_cvt_pk_bf16_f32 v49, v26, v27
    v_mfma_f32_32x32x16_bf16 v[56:71], v[144:147], v[40:43], v[56:71]
    v_exp_f32 v32, v32
    v_exp_f32 v33, v33
    v_exp_f32 v34, v34
    v_exp_f32 v35, v35
    v_cvt_pk_bf16_f32 v50, v28, v29
    v_cvt_pk_bf16_f32 v51, v30, v31
    v_mfma_f32_32x32x16_bf16 v[56:71], v[148:151], v[44:47], v[56:71]
    v_exp_f32 v36, v36
    v_exp_f32 v37, v37
    v_exp_f32 v38, v38
    v_exp_f32 v39, v39
    v_cvt_pk_bf16_f32 v52, v32, v33
    v_cvt_pk_bf16_f32 v53, v34, v35
    v_cvt_pk_bf16_f32 v54, v36, v37
    v_cvt_pk_bf16_f32 v55, v38, v39
    s_add_u32 s53, s53, 1
    s_cmp_lt_u32 s53, 8
    s_cbranch_scc1 Latt_loop_57
    s_nop 1
    v_mfma_f32_32x32x16_bf16 v[72:87], v[144:147], v[48:51], v[72:87]
    v_mfma_f32_32x32x16_bf16 v[72:87], v[148:151], v[52:55], v[72:87]
    s_nop 15
    s_cmp_lg_u32 s52, 0
    s_cbranch_scc1 Latt_ok_60
    s_mov_b32 s4, 0x1f800000
    s_mov_b32 s5, 0x5f800000
    s_mov_b64 s[54:55], 0
    v_cmp_nle_f32 vcc, s4, v66
    s_nop 1
    s_or_b64 s[54:55], s[54:55], vcc
    v_cmp_nge_f32 vcc, s5, v66
    s_nop 1
    s_or_b64 s[54:55], s[54:55], vcc
    v_cmp_nle_f32 vcc, s4, v82
    s_nop 1
    s_or_b64 s[54:55], s[54:55], vcc
    v_cmp_nge_f32 vcc, s5, v82
    s_nop 1
    s_or_b64 s[54:55], s[54:55], vcc
    s_mov_b32 s55, 0
    v_mul_f32 v88, 0, v56
    v_fma_f32 v88, v57, 0, v88
    v_fma_f32 v88, v58, 0, v88
    v_fma_f32 v88, v59, 0, v88
    v_fma_f32 v88, v60, 0, v88
    v_fma_f32 v88, v61, 0, v88
    v_fma_f32 v88, v62, 0, v88
    v_fma_f32 v88, v63, 0, v88
    v_fma_f32 v88, v64, 0, v88
    v_fma_f32 v88, v65, 0, v88
    v_cmp_neq_f32 vcc, 0, v88
    s_nop 1
    s_or_b64 s[54:55], s[54:55], vcc
    v_mul_f32 v88, 0, v72
    v_fma_f32 v88, v73, 0, v88
    v_fma_f32 v88, v74, 0, v88
    v_fma_f32 v88, v75, 0, v88
    v_fma_f32 v88, v76, 0, v88
    v_fma_f32 v88, v77, 0, v88
    v_fma_f32 v88, v78, 0, v88
    v_fma_f32 v88, v79, 0, v88
    v_fma_f32 v88, v80, 0, v88
    v_fma_f32 v88, v81, 0, v88
    v_cmp_neq_f32 vcc, 0, v88
    s_nop 1
    s_or_b64 s[54:55], s[54:55], vcc
    s_cmp_lg_u64 s[54:55], 0
    s_cselect_b32 s4, 1, 0
    v_mov_b32 v88, s4
    s_lshl_b32 s5, s24, 2
    s_add_u32 s5, s5, 58368
    v_mov_b32 v89, s5
    ds_write_b32 v89, v88
    s_waitcnt lgkmcnt(0)
    s_barrier
    v_mov_b32 v89, 58368
    ds_read_b128 v[92:95], v89
    s_waitcnt lgkmcnt(0)
    v_or3_b32 v88, v92, v93, v94
    v_or_b32 v88, v88, v95
    s_nop 0
    v_readfirstlane_b32 s4, v88
    s_nop 3
    s_cmp_eq_u32 s4, 0
    s_cbranch_scc1 Latt_ok_60
    s_waitcnt vmcnt(0)
    v_and_b32 v2, 63, v0
    s_lshl_b32 s4, s40, 15
    s_add_u32 s4, s4, 2097152
    s_lshl_b32 s5, s24, 10
    s_add_u32 s4, s4, s5
    v_lshl_add_u32 v152, v2, 4, s4
    v_add_u32 v153, 1048576, v152
    s_mul_i32 s6, s40, 288
    s_add_u32 s6, s6, 4718592
    s_add_u32 s4, s24, 0
    s_lshl_b32 s4, s4, 6
    v_add_u32 v3, s4, v2
    v_mul_u32_u24 v4, 3450, v3
    v_lshrrev_b32 v4, 16, v4
    v_mul_u32_u24 v5, 19, v4
    v_sub_u32 v5, v3, v5
    v_mul_u32_u24 v4, 9216, v4
    v_lshl_add_u32 v4, v5, 4, v4
    v_add_u32 v4, s6, v4
    v_cmp_gt_u32 vcc, 18, v5
    s_mov_b32 s7, 608
    v_cmp_gt_u32 s[54:55], s7, v3
    s_nop 1
    s_and_b64 vcc, vcc, s[54:55]
    v_mov_b32 v3, 7274496
    v_mov_b32 v5, 294912
    v_cndmask_b32 v154, v3, v4, vcc
    v_cndmask_b32 v157, 0, v5, vcc
    s_add_u32 s4, s24, 4
    s_lshl_b32 s4, s4, 6
    v_add_u32 v3, s4, v2
    v_mul_u32_u24 v4, 3450, v3
    v_lshrrev_b32 v4, 16, v4
    v_mul_u32_u24 v5, 19, v4
    v_sub_u32 v5, v3, v5
    v_mul_u32_u24 v4, 9216, v4
    v_lshl_add_u32 v4, v5, 4, v4
    v_add_u32 v4, s6, v4
    v_cmp_gt_u32 vcc, 18, v5
    s_mov_b32 s7, 608
    v_cmp_gt_u32 s[54:55], s7, v3
    s_nop 1
    s_and_b64 vcc, vcc, s[54:55]
    v_mov_b32 v3, 7274496
    v_mov_b32 v5, 294912
    v_cndmask_b32 v155, v3, v4, vcc
    v_cndmask_b32 v158, 0, v5, vcc
    s_add_u32 s4, s24, 8
    s_lshl_b32 s4, s4, 6
    v_add_u32 v3, s4, v2
    v_mul_u32_u24 v4, 3450, v3
    v_lshrrev_b32 v4, 16, v4
    v_mul_u32_u24 v5, 19, v4
    v_sub_u32 v5, v3, v5
    v_mul_u32_u24 v4, 9216, v4
    v_lshl_add_u32 v4, v5, 4, v4
    v_add_u32 v4, s6, v4
    v_cmp_gt_u32 vcc, 18, v5
    s_mov_b32 s7, 608
    v_cmp_gt_u32 s[54:55], s7, v3
    s_nop 1
    s_and_b64 vcc, vcc, s[54:55]
    v_mov_b32 v3, 7274496
    v_mov_b32 v5, 294912
    v_cndmask_b32 v156, v3, v4, vcc
    v_cndmask_b32 v159, 0, v5, vcc
    s_cmp_lt_u32 s24, 2
    s_cbranch_scc1 Lw01_61
    s_lshl_b32 s4, s40, 13
    s_add_u32 s4, s4, 4456448
    v_lshl_add_u32 v156, v2, 4, s4
    v_mov_b32 v159, 1024
Lw01_61:
    v_mov_b32 v113, 0
    v_mov_b32 v114, 0
    v_mov_b32 v166, 0xff800000
    v_mov_b32 v117, 0
    v_mov_b32 v118, 0
    v_mov_b32 v167, 0xff800000
    v_mov_b32 v163, v160
    v_mov_b32 v164, v161
    s_mov_b32 s51, 0
    s_mov_b32 s53, 0
Lmaxc_62:
    s_barrier
    s_add_u32 m0, s51, s32
    s_nop 0
    buffer_load_dwordx4 v152, s[8:11], 0 offen sc1 lds
    v_add_u32 v152, 4096, v152
    s_add_u32 m0, s51, s33
    s_nop 0
    buffer_load_dwordx4 v153, s[8:11], 0 offen sc1 lds
    v_add_u32 v153, 4096, v153
    s_add_u32 m0, s51, s34
    s_nop 0
    buffer_load_dwordx4 v154, s[8:11], 0 offen sc1 lds
    v_add_u32 v154, v157, v154
    s_add_u32 m0, s51, s35
    s_nop 0
    buffer_load_dwordx4 v155, s[8:11], 0 offen sc1 lds
    v_add_u32 v155, v158, v155
    s_add_u32 m0, s51, s36
    s_nop 0
    buffer_load_dwordx4 v156, s[8:11], 0 offen sc1 lds
    v_add_u32 v156, v159, v156
    s_waitcnt vmcnt(0)
    s_barrier
    ds_read_b128 v[120:123], v163 offset:0
    ds_read_b32 v128, v164 offset:0
    s_waitcnt lgkmcnt(0)
    v_mfma_f32_32x32x16_bf16 v[8:23], v[120:123], v[104:107], 0
    v_mfma_f32_32x32x16_bf16 v[8:23], v[128:131], v[112:115], v[8:23]
    v_mfma_f32_32x32x16_bf16 v[24:39], v[120:123], v[108:111], 0
    v_mfma_f32_32x32x16_bf16 v[24:39], v[128:131], v[116:119], v[24:39]
    s_nop 15
    v_max3_f32 v166, v8, v9, v166
    v_max3_f32 v166, v10, v11, v166
    v_max3_f32 v166, v12, v13, v166
    v_max3_f32 v166, v14, v15, v166
    v_max3_f32 v166, v16, v17, v166
    v_max3_f32 v166, v18, v19, v166
    v_max3_f32 v166, v20, v21, v166
    v_max3_f32 v166, v22, v23, v166
    v_max3_f32 v167, v24, v25, v167
    v_max3_f32 v167, v26, v27, v167
    v_max3_f32 v167, v28, v29, v167
    v_max3_f32 v167, v30, v31, v167
    v_max3_f32 v167, v32, v33, v167
    v_max3_f32 v167, v34, v35, v167
    v_max3_f32 v167, v36, v37, v167
    v_max3_f32 v167, v38, v39, v167
    ds_read_b128 v[120:123], v163 offset:512
    ds_read_b32 v128, v164 offset:128
    s_waitcnt lgkmcnt(0)
    v_mfma_f32_32x32x16_bf16 v[8:23], v[120:123], v[104:107], 0
    v_mfma_f32_32x32x16_bf16 v[8:23], v[128:131], v[112:115], v[8:23]
    v_mfma_f32_32x32x16_bf16 v[24:39], v[120:123], v[108:111], 0
    v_mfma_f32_32x32x16_bf16 v[24:39], v[128:131], v[116:119], v[24:39]
    s_nop 15
    v_max3_f32 v166, v8, v9, v166
    v_max3_f32 v166, v10, v11, v166
    v_max3_f32 v166, v12, v13, v166
    v_max3_f32 v166, v14, v15, v166
    v_max3_f32 v166, v16, v17, v166
    v_max3_f32 v166, v18, v19, v166
    v_max3_f32 v166, v20, v21, v166
    v_max3_f32 v166, v22, v23, v166
    v_max3_f32 v167, v24, v25, v167
    v_max3_f32 v167, v26, v27, v167
    v_max3_f32 v167, v28, v29, v167
    v_max3_f32 v167, v30, v31, v167
    v_max3_f32 v167, v32, v33, v167
    v_max3_f32 v167, v34, v35, v167
    v_max3_f32 v167, v36, v37, v167
    v_max3_f32 v167, v38, v39, v167
    ds_read_b128 v[120:123], v163 offset:1024
    ds_read_b32 v128, v164 offset:256
    s_waitcnt lgkmcnt(0)
    v_mfma_f32_32x32x16_bf16 v[8:23], v[120:123], v[104:107], 0
    v_mfma_f32_32x32x16_bf16 v[8:23], v[128:131], v[112:115], v[8:23]
    v_mfma_f32_32x32x16_bf16 v[24:39], v[120:123], v[108:111], 0
    v_mfma_f32_32x32x16_bf16 v[24:39], v[128:131], v[116:119], v[24:39]
    s_nop 15
    v_max3_f32 v166, v8, v9, v166
    v_max3_f32 v166, v10, v11, v166
    v_max3_f32 v166, v12, v13, v166
    v_max3_f32 v166, v14, v15, v166
    v_max3_f32 v166, v16, v17, v166
    v_max3_f32 v166, v18, v19, v166
    v_max3_f32 v166, v20, v21, v166
    v_max3_f32 v166, v22, v23, v166
    v_max3_f32 v167, v24, v25, v167
    v_max3_f32 v167, v26, v27, v167
    v_max3_f32 v167, v28, v29, v167
    v_max3_f32 v167, v30, v31, v167
    v_max3_f32 v167, v32, v33, v167
    v_max3_f32 v167, v34, v35, v167
    v_max3_f32 v167, v36, v37, v167
    v_max3_f32 v167, v38, v39, v167
    ds_read_b128 v[120:123], v163 offset:1536
    ds_read_b32 v128, v164 offset:384
    s_waitcnt lgkmcnt(0)
    v_mfma_f32_32x32x16_bf16 v[8:23], v[120:123], v[104:107], 0
    v_mfma_f32_32x32x16_bf16 v[8:23], v[128:131], v[112:115], v[8:23]
    v_mfma_f32_32x32x16_bf16 v[24:39], v[120:123], v[108:111], 0
    v_mfma_f32_32x32x16_bf16 v[24:39], v[128:131], v[116:119], v[24:39]
    s_nop 15
    v_max3_f32 v166, v8, v9, v166
    v_max3_f32 v166, v10, v11, v166
    v_max3_f32 v166, v12, v13, v166
    v_max3_f32 v166, v14, v15, v166
    v_max3_f32 v166, v16, v17, v166
    v_max3_f32 v166, v18, v19, v166
    v_max3_f32 v166, v20, v21, v166
    v_max3_f32 v166, v22, v23, v166
    v_max3_f32 v167, v24, v25, v167
    v_max3_f32 v167, v26, v27, v167
    v_max3_f32 v167, v28, v29, v167
    v_max3_f32 v167, v30, v31, v167
    v_max3_f32 v167, v32, v33, v167
    v_max3_f32 v167, v34, v35, v167
    v_max3_f32 v167, v36, v37, v167
    v_max3_f32 v167, v38, v39, v167
    ds_read_b128 v[120:123], v163 offset:2048
    ds_read_b32 v128, v164 offset:512
    s_waitcnt lgkmcnt(0)
    v_mfma_f32_32x32x16_bf16 v[8:23], v[120:123], v[104:107], 0
    v_mfma_f32_32x32x16_bf16 v[8:23], v[128:131], v[112:115], v[8:23]
    v_mfma_f32_32x32x16_bf16 v[24:39], v[120:123], v[108:111], 0
    v_mfma_f32_32x32x16_bf16 v[24:39], v[128:131], v[116:119], v[24:39]
    s_nop 15
    v_max3_f32 v166, v8, v9, v166
    v_max3_f32 v166, v10, v11, v166
    v_max3_f32 v166, v12, v13, v166
    v_max3_f32 v166, v14, v15, v166
    v_max3_f32 v166, v16, v17, v166
    v_max3_f32 v166, v18, v19, v166
    v_max3_f32 v166, v20, v21, v166
    v_max3_f32 v166, v22, v23, v166
    v_max3_f32 v167, v24, v25, v167
    v_max3_f32 v167, v26, v27, v167
    v_max3_f32 v167, v28, v29, v167
    v_max3_f32 v167, v30, v31, v167
    v_max3_f32 v167, v32, v33, v167
    v_max3_f32 v167, v34, v35, v167
    v_max3_f32 v167, v36, v37, v167
    v_max3_f32 v167, v38, v39, v167
    ds_read_b128 v[120:123], v163 offset:2560
    ds_read_b32 v128, v164 offset:640
    s_waitcnt lgkmcnt(0)
    v_mfma_f32_32x32x16_bf16 v[8:23], v[120:123], v[104:107], 0
    v_mfma_f32_32x32x16_bf16 v[8:23], v[128:131], v[112:115], v[8:23]
    v_mfma_f32_32x32x16_bf16 v[24:39], v[120:123], v[108:111], 0
    v_mfma_f32_32x32x16_bf16 v[24:39], v[128:131], v[116:119], v[24:39]
    s_nop 15
    v_max3_f32 v166, v8, v9, v166
    v_max3_f32 v166, v10, v11, v166
    v_max3_f32 v166, v12, v13, v166
    v_max3_f32 v166, v14, v15, v166
    v_max3_f32 v166, v16, v17, v166
    v_max3_f32 v166, v18, v19, v166
    v_max3_f32 v166, v20, v21, v166
    v_max3_f32 v166, v22, v23, v166
    v_max3_f32 v167, v24, v25, v167
    v_max3_f32 v167, v26, v27, v167
    v_max3_f32 v167, v28, v29, v167
    v_max3_f32 v167, v30, v31, v167
    v_max3_f32 v167, v32, v33, v167
    v_max3_f32 v167, v34, v35, v167
    v_max3_f32 v167, v36, v37, v167
    v_max3_f32 v167, v38, v39, v167
    ds_read_b128 v[120:123], v163 offset:3072
    ds_read_b32 v128, v164 offset:768
    s_waitcnt lgkmcnt(0)
    v_mfma_f32_32x32x16_bf16 v[8:23], v[120:123], v[104:107], 0
    v_mfma_f32_32x32x16_bf16 v[8:23], v[128:131], v[112:115], v[8:23]
    v_mfma_f32_32x32x16_bf16 v[24:39], v[120:123], v[108:111], 0
    v_mfma_f32_32x32x16_bf16 v[24:39], v[128:131], v[116:119], v[24:39]
    s_nop 15
    v_max3_f32 v166, v8, v9, v166
    v_max3_f32 v166, v10, v11, v166
    v_max3_f32 v166, v12, v13, v166
    v_max3_f32 v166, v14, v15, v166
    v_max3_f32 v166, v16, v17, v166
    v_max3_f32 v166, v18, v19, v166
    v_max3_f32 v166, v20, v21, v166
    v_max3_f32 v166, v22, v23, v166
    v_max3_f32 v167, v24, v25, v167
    v_max3_f32 v167, v26, v27, v167
    v_max3_f32 v167, v28, v29, v167
    v_max3_f32 v167, v30, v31, v167
    v_max3_f32 v167, v32, v33, v167
    v_max3_f32 v167, v34, v35, v167
    v_max3_f32 v167, v36, v37, v167
    v_max3_f32 v167, v38, v39, v167
    ds_read_b128 v[120:123], v163 offset:3584
    ds_read_b32 v128, v164 offset:896
    s_waitcnt lgkmcnt(0)
    v_mfma_f32_32x32x16_bf16 v[8:23], v[120:123], v[104:107], 0
    v_mfma_f32_32x32x16_bf16 v[8:23], v[128:131], v[112:115], v[8:23]
    v_mfma_f32_32x32x16_bf16 v[24:39], v[120:123], v[108:111], 0
    v_mfma_f32_32x32x16_bf16 v[24:39], v[128:131], v[116:119], v[24:39]
    s_nop 15
    v_max3_f32 v166, v8, v9, v166
    v_max3_f32 v166, v10, v11, v166
    v_max3_f32 v166, v12, v13, v166
    v_max3_f32 v166, v14, v15, v166
    v_max3_f32 v166, v16, v17, v166
    v_max3_f32 v166, v18, v19, v166
    v_max3_f32 v166, v20, v21, v166
    v_max3_f32 v166, v22, v23, v166
    v_max3_f32 v167, v24, v25, v167
    v_max3_f32 v167, v26, v27, v167
    v_max3_f32 v167, v28, v29, v167
    v_max3_f32 v167, v30, v31, v167
    v_max3_f32 v167, v32, v33, v167
    v_max3_f32 v167, v34, v35, v167
    v_max3_f32 v167, v36, v37, v167
    v_max3_f32 v167, v38, v39, v167
    s_add_u32 s53, s53, 1
    s_cmp_lt_u32 s53, 8
    s_cbranch_scc1 Lmaxc_62
    v_mov_b32 v88, v166
    s_nop 1
    v_permlane32_swap_b32 v166, v88
    s_nop 0
    v_max_f32 v166, v166, v88
    v_mov_b32 v88, v167
    s_nop 1
    v_permlane32_swap_b32 v167, v88
    s_nop 0
    v_max_f32 v167, v167, v88
    s_mov_b32 s52, 1
    s_barrier
    v_and_b32 v2, 63, v0
    s_lshl_b32 s4, s40, 15
    s_add_u32 s4, s4, 2097152
    s_lshl_b32 s5, s24, 10
    s_add_u32 s4, s4, s5
    v_lshl_add_u32 v152, v2, 4, s4
    v_add_u32 v153, 1048576, v152
    s_mul_i32 s6, s40, 288
    s_add_u32 s6, s6, 4718592
    s_add_u32 s4, s24, 0
    s_lshl_b32 s4, s4, 6
    v_add_u32 v3, s4, v2
    v_mul_u32_u24 v4, 3450, v3
    v_lshrrev_b32 v4, 16, v4
    v_mul_u32_u24 v5, 19, v4
    v_sub_u32 v5, v3, v5
    v_mul_u32_u24 v4, 9216, v4
    v_lshl_add_u32 v4, v5, 4, v4
    v_add_u32 v4, s6, v4
    v_cmp_gt_u32 vcc, 18, v5
    s_mov_b32 s7, 608
    v_cmp_gt_u32 s[54:55], s7, v3
    s_nop 1
    s_and_b64 vcc, vcc, s[54:55]
    v_mov_b32 v3, 7274496
    v_mov_b32 v5, 294912
    v_cndmask_b32 v154, v3, v4, vcc
    v_cndmask_b32 v157, 0, v5, vcc
    s_add_u32 s4, s24, 4
    s_lshl_b32 s4, s4, 6
    v_add_u32 v3, s4, v2
    v_mul_u32_u24 v4, 3450, v3
    v_lshrrev_b32 v4, 16, v4
    v_mul_u32_u24 v5, 19, v4
    v_sub_u32 v5, v3, v5
    v_mul_u32_u24 v4, 9216, v4
    v_lshl_add_u32 v4, v5, 4, v4
    v_add_u32 v4, s6, v4
    v_cmp_gt_u32 vcc, 18, v5
    s_mov_b32 s7, 608
    v_cmp_gt_u32 s[54:55], s7, v3
    s_nop 1
    s_and_b64 vcc, vcc, s[54:55]
    v_mov_b32 v3, 7274496
    v_mov_b32 v5, 294912
    v_cndmask_b32 v155, v3, v4, vcc
    v_cndmask_b32 v158, 0, v5, vcc
    s_add_u32 s4, s24, 8
    s_lshl_b32 s4, s4, 6
    v_add_u32 v3, s4, v2
    v_mul_u32_u24 v4, 3450, v3
    v_lshrrev_b32 v4, 16, v4
    v_mul_u32_u24 v5, 19, v4
    v_sub_u32 v5, v3, v5
    v_mul_u32_u24 v4, 9216, v4
    v_lshl_add_u32 v4, v5, 4, v4
    v_add_u32 v4, s6, v4
    v_cmp_gt_u32 vcc, 18, v5
    s_mov_b32 s7, 608
    v_cmp_gt_u32 s[54:55], s7, v3
    s_nop 1
    s_and_b64 vcc, vcc, s[54:55]
    v_mov_b32 v3, 7274496
    v_mov_b32 v5, 294912
    v_cndmask_b32 v156, v3, v4, vcc
    v_cndmask_b32 v159, 0, v5, vcc
    s_cmp_lt_u32 s24, 2
    s_cbranch_scc1 Lw01_63
    s_lshl_b32 s4, s40, 13
    s_add_u32 s4, s4, 4456448
    v_lshl_add_u32 v156, v2, 4, s4
    v_mov_b32 v159, 1024
Lw01_63:
    s_mov_b32 s51, 0
    s_add_u32 m0, s51, s32
    s_nop 0
    buffer_load_dwordx4 v152, s[8:11], 0 offen sc1 lds
    v_add_u32 v152, 4096, v152
    s_add_u32 m0, s51, s33
    s_nop 0
    buffer_load_dwordx4 v153, s[8:11], 0 offen sc1 lds
    v_add_u32 v153, 4096, v153
    s_add_u32 m0, s51, s34
    s_nop 0
    buffer_load_dwordx4 v154, s[8:11], 0 offen sc1 lds
    v_add_u32 v154, v157, v154
    s_add_u32 m0, s51, s35
    s_nop 0
    buffer_load_dwordx4 v155, s[8:11], 0 offen sc1 lds
    v_add_u32 v155, v158, v155
    s_add_u32 m0, s51, s36
    s_nop 0
    buffer_load_dwordx4 v156, s[8:11], 0 offen sc1 lds
    v_add_u32 v156, v159, v156
    s_mov_b32 s51, 19456
    s_add_u32 m0, s51, s32
    s_nop 0
    buffer_load_dwordx4 v152, s[8:11], 0 offen sc1 lds
    v_add_u32 v152, 4096, v152
    s_add_u32 m0, s51, s33
    s_nop 0
    buffer_load_dwordx4 v153, s[8:11], 0 offen sc1 lds
    v_add_u32 v153, 4096, v153
    s_add_u32 m0, s51, s34
    s_nop 0
    buffer_load_dwordx4 v154, s[8:11], 0 offen sc1 lds
    v_add_u32 v154, v157, v154
    s_add_u32 m0, s51, s35
    s_nop 0
    buffer_load_dwordx4 v155, s[8:11], 0 offen sc1 lds
    v_add_u32 v155, v158, v155
    s_add_u32 m0, s51, s36
    s_nop 0
    buffer_load_dwordx4 v156, s[8:11], 0 offen sc1 lds
    v_add_u32 v156, v159, v156
    s_mov_b32 s51, 38912
    s_branch Latt_start_54
Latt_ok_60:
    s_add_u32 s16, s84, 26214400
    s_addc_u32 s17, s85, 0
    s_and_b32 s17, s17, 0xffff
    s_mov_b32 s18, 11796480
    s_mov_b32 s19, 0x20000
    v_lshlrev_b32 v4, 20, v171
    v_lshl_add_u32 v4, v170, 4, v4
    s_lshl_b32 s4, s40, 15
    v_lshlrev_b32 v5, 4, v170
    v_cmp_eq_u32 vcc, 0, v171
    v_mov_b32 v6, 0x7ffffff0
    s_nop 0
    v_cndmask_b32 v5, v6, v5, vcc
    s_lshr_b32 s5, s40, 2
    s_add_u32 s5, s5, 64
    s_lshl_b32 s5, s5, 15
    s_and_b32 s6, s40, 3
    s_lshl_b32 s6, s6, 2
    s_add_u32 s5, s5, s6
    v_mov_b32 v88, v66
    v_mov_b32 v89, v66
    s_nop 1
    v_permlane32_swap_b32 v88, v89
    s_nop 0
    v_rcp_f32 v88, v88
    s_nop 0
    v_mul_f32 v88, v88, v168
    v_mul_f32 v56, v56, v88
    v_mul_f32 v57, v57, v88
    v_mul_f32 v58, v58, v88
    v_mul_f32 v59, v59, v88
    v_mul_f32 v60, v60, v88
    v_mul_f32 v61, v61, v88
    v_mul_f32 v62, v62, v88
    v_mul_f32 v63, v63, v88
    v_mul_f32 v64, v64, v88
    v_mul_f32 v65, v65, v88
    v_cvt_pk_bf16_f32 v92, v56, v57
    v_cvt_pk_bf16_f32 v93, v58, v59
    v_cvt_pk_bf16_f32 v94, v60, v61
    v_cvt_pk_bf16_f32 v95, v62, v63
    v_cvt_pk_bf16_f32 v96, v64, v65
    s_nop 0
    v_permlane32_swap_b32 v92, v94
    v_permlane32_swap_b32 v93, v95
    buffer_store_dwordx4 v[92:95], v4, s[16:19], s4 offen offset:0 sc1
    buffer_store_dword v96, v5, s[16:19], s5 offen offset:0 sc1
    s_nop 1
    v_mov_b32 v88, v82
    v_mov_b32 v89, v82
    s_nop 1
    v_permlane32_swap_b32 v88, v89
    s_nop 0
    v_rcp_f32 v88, v88
    s_nop 0
    v_mul_f32 v88, v88, v169
    v_mul_f32 v72, v72, v88
    v_mul_f32 v73, v73, v88
    v_mul_f32 v74, v74, v88
    v_mul_f32 v75, v75, v88
    v_mul_f32 v76, v76, v88
    v_mul_f32 v77, v77, v88
    v_mul_f32 v78, v78, v88
    v_mul_f32 v79, v79, v88
    v_mul_f32 v80, v80, v88
    v_mul_f32 v81, v81, v88
    v_cvt_pk_bf16_f32 v92, v72, v73
    v_cvt_pk_bf16_f32 v93, v74, v75
    v_cvt_pk_bf16_f32 v94, v76, v77
    v_cvt_pk_bf16_f32 v95, v78, v79
    v_cvt_pk_bf16_f32 v96, v80, v81
    s_nop 0
    v_permlane32_swap_b32 v92, v94
    v_permlane32_swap_b32 v93, v95
    buffer_store_dwordx4 v[92:95], v4, s[16:19], s4 offen offset:512 sc1
    buffer_store_dword v96, v5, s[16:19], s5 offen offset:512 sc1
    s_nop 1
    s_lshl_b32 s42, s41, 5
    s_add_u32 s42, s42, s40
    s_waitcnt vmcnt(0)
    s_barrier
    s_cmp_lg_u32 s24, 0
    s_cbranch_scc1 Lpub_64
    s_lshl_b32 s4, s42, 2
    s_add_u32 s4, s4, 2048
    v_mov_b32 v2, 1
    buffer_store_dword v2, off, s[56:59], s4 sc1
Lpub_64:
    s_sub_u32 s2, s2, 256
Ldone_1:
    s_endpgm
.section .rodata,"a"
.p2align 6
.amdhsa_kernel fused_kernel
  .amdhsa_next_free_vgpr 247
  .amdhsa_next_free_sgpr 100
  .amdhsa_accum_offset 248
  .amdhsa_group_segment_fixed_size 0
  .amdhsa_kernarg_size 96
  .amdhsa_user_sgpr_count 2
  .amdhsa_user_sgpr_kernarg_segment_ptr 1
  .amdhsa_system_sgpr_workgroup_id_x 1
  .amdhsa_float_denorm_mode_32 3
.end_amdhsa_kernel
```
